```python
import torch

def _softmax(x, axis=-1):
    return torch.softmax(x, dim=axis)
def _gelu(x):
    return torch.nn.functional.gelu(x, approximate="tanh")
def _silu(x):
    return torch.nn.functional.silu(x)
def _sigmoid(x):
    return torch.sigmoid(x)
def _layernorm(x, axis=-1, eps=1e-5):
    m = x.mean(dim=axis, keepdim=True)
    v = x.var(dim=axis, keepdim=True, unbiased=False)
    return (x - m) / torch.sqrt(v + eps)
def _scatter_add(tgt, idx, src, axis=0):
    return tgt.clone().index_add_(axis, idx, src)
def _segment_sum(src, seg, n):
    out = torch.zeros((n,) + src.shape[1:], dtype=src.dtype)
    return out.index_add_(0, seg, src)
def _pad(x, pw):
    flat = tuple(v for pair in reversed(pw) for v in pair)
    return torch.nn.functional.pad(x, flat)

kernel_name = 'parallel_sum__spectral_gfnet__glu_gated_geglu__prompt'

def setup_inputs():

    _w = (lambda a: (lambda t: t.to(torch.bfloat16) if t.is_floating_point() else t)(torch.as_tensor(a)))
    def _A_setup():
        B, S, D = 1, 2048, 1024
        Df = D // 2 + 1
        return {
            "x": _w((lambda *s: torch.randn(*s, dtype=torch.bfloat16) * 0.05)(B, S, D)),
            "w_r": _w((lambda *s: torch.randn(*s, dtype=torch.bfloat16) * 0.8)(S, Df) * 0.02),
            "w_i": _w((lambda *s: torch.randn(*s, dtype=torch.bfloat16) * 0.8)(S, Df) * 0.02),
        }
    _A_in = _A_setup()

    def _B_setup():
        B, S, Dm, Df = 1, 2048, 1024, 3584
        return {
            "x": _w((lambda *s: torch.randn(*s, dtype=torch.bfloat16) * 0.05)(B, S, Dm)),
            "w_gate": _w((lambda *s: torch.randn(*s, dtype=torch.bfloat16) * 0.4)(Dm, Df) * (Dm ** -0.5)),
            "w_up": _w((lambda *s: torch.randn(*s, dtype=torch.bfloat16) * 0.4)(Dm, Df) * (Dm ** -0.5)),
            "w_down": _w((lambda *s: torch.randn(*s, dtype=torch.bfloat16) * 0.4)(Df, Dm) * (Df ** -0.5)),
        }
    _B_in = _B_setup()

    return {
        "A_x": _A_in["x"],
        "A_w_r": _A_in["w_r"],
        "A_w_i": _A_in["w_i"],
        "B_x": _B_in["x"],
        "B_w_gate": _B_in["w_gate"],
        "B_w_up": _B_in["w_up"],
        "B_w_down": _B_in["w_down"],
    }

def reference(A_x, A_w_r, A_w_i, B_x, B_w_gate, B_w_up, B_w_down):
    def _A_ref(x, w_r, w_i):
        B, S, D = x.shape
        X = (lambda x, axes=(-2,-1): torch.fft.rfft2(x.float(), dim=axes))(x, axes=(-2, -1))
        W = w_r + 1j * w_i
        X = X * W
        y = (lambda x, s, axes=(-2,-1): torch.fft.irfft2(x, s=s, dim=axes).to(torch.bfloat16))(X, (S, D), axes=(-2, -1))
        return y

    def _B_ref(x, w_gate, w_up, w_down):
        g = torch.einsum("bsd,df->bsf", x, w_gate)
        u = torch.einsum("bsd,df->bsf", x, w_up)
        h = _gelu(g) * u
        return torch.einsum("bsf,fd->bsd", h, w_down)

    x = A_x
    xn = _layernorm(x, axis=-1)
    return x + _A_ref(xn, A_w_r, A_w_i) + _B_ref(xn, B_w_gate, B_w_up, B_w_down)
```

```asm
; @launch grid=(256,1,1) block=(512,1,1) lds=163840
.amdgcn_target "amdgcn-amd-amdhsa--gfx950"
.text
.set CODE_BYTES, L_end - parallel_sum__spectral_gfnet__glu_gated_geglu__prompt_kernel
.globl parallel_sum__spectral_gfnet__glu_gated_geglu__prompt_kernel
.p2align 8
.type parallel_sum__spectral_gfnet__glu_gated_geglu__prompt_kernel,@function
parallel_sum__spectral_gfnet__glu_gated_geglu__prompt_kernel:
    s_cmp_ge_u32 s2, 256
    s_cbranch_scc1 L_end
    s_load_dwordx16 s[80:95], s[0:1], 0
    s_load_dwordx4 s[96:99], s[0:1], 64
    v_lshrrev_b32 v1, 6, v0
    v_and_b32 v2, 63, v0
    v_readfirstlane_b32 s20, v1
    v_lshlrev_b32 v3, 4, v2
    s_getpc_b64 s[4:5]
    s_and_b32 s4, s4, 0xffffff00
    s_mov_b32 s6, CODE_BYTES
    s_mov_b32 s7, 0x00020000
    s_cmp_ge_u32 s2, 8
    s_cbranch_scc1 L_nocw
    s_lshl_b32 s21, s20, 13
    v_lshlrev_b32 v12, 7, v2
    buffer_load_dword v13, v12, s[4:7], s21 offen
L_nocw:
    s_lshr_b32 s27, s20, 2
    s_lshl_b32 s27, s27, 3
    s_and_b32 s21, s20, 3
    s_add_u32 s27, s27, s21
    s_lshr_b32 s21, s2, 7
    s_lshl_b32 s21, s21, 4
    s_add_u32 s21, s21, s27
    s_bfe_u32 s22, s2, 0x10006
    s_lshl_b32 s22, s22, 2
    s_add_u32 s21, s21, s22
    s_lshl_b32 s21, s21, 6
    s_and_b32 s22, s2, 63
    s_add_u32 s21, s21, s22
    s_lshl_b32 s21, s21, 11
    s_waitcnt lgkmcnt(0)
    s_mov_b32 s8, s80
    s_mov_b32 s9, s81
    s_mov_b32 s10, 4194304
    s_mov_b32 s11, 0x00020000
    buffer_load_dwordx4 v[4:7], v3, s[8:11], s21 offen
    buffer_load_dwordx4 v[8:11], v3, s[8:11], s21 offen offset:1024
    s_add_u32 s48, s98, 41943040
    s_addc_u32 s49, s99, 0
    s_mov_b32 s50, 16384
    s_mov_b32 s51, 0x00020000
    s_mov_b32 s52, s96
    s_mov_b32 s53, s97
    s_mov_b32 s54, 256
    s_mov_b32 s55, 0x00020000
    s_cmp_ge_u32 s2, 32
    s_cbranch_scc1 L_nop0
    s_lshl_b32 s21, s2, 3
    s_add_u32 s21, s21, s20
    s_bitcmp1_b32 s21, 0
    s_cselect_b32 s12, s90, s88
    s_cselect_b32 s13, s91, s89
    s_mov_b32 s14, 7340032
    s_mov_b32 s15, 0x00020000
    s_lshr_b32 s21, s21, 1
    s_lshl_b32 s21, s21, 13
    v_lshlrev_b32 v12, 7, v2
    buffer_load_dword v150, v12, s[12:15], s21 offen
L_nop0:
    s_lshl_b32 s57, s2, 3
    s_add_u32 s57, s57, s20
    s_cmp_lg_u32 s57, 263
    s_cbranch_scc1 L_nozero
    v_lshlrev_b32 v12, 8, v2
    v_mov_b32 v13, 0
    buffer_store_dword v13, v12, s[48:51], 0 offen sc1
L_nozero:
    s_and_b32 s21, s2, 7
    s_lshr_b32 s22, s2, 3
    s_max_u32 s22, s22, 4
    s_sub_u32 s22, s22, 4
    s_and_b32 s23, s21, 1
    s_lshl_b32 s23, s23, 2
    s_and_b32 s24, s22, 3
    s_add_u32 s23, s23, s24
    s_lshr_b32 s24, s21, 1
    s_mul_i32 s24, s24, 7
    s_lshr_b32 s25, s22, 2
    s_add_u32 s24, s24, s25
    v_lshrrev_b32 v152, 4, v2
    s_lshl_b32 s26, s20, 2
    v_add_u32 v153, s26, v152
    v_bfe_u32 v154, v153, 3, 1
    v_lshlrev_b32 v154, 1, v154
    v_mul_u32_u24 v153, 7168, v153
    v_lshlrev_b32 v152, 2, v152
    v_and_b32 v155, 15, v2
    v_xor_b32 v152, v152, v155
    v_xor_b32 v152, v152, v154
    v_lshl_add_u32 v152, v152, 4, v153
    s_lshl_b32 s25, s24, 8
    s_add_u32 s36, s88, s25
    s_addc_u32 s37, s89, 0
    s_sub_u32 s36, s36, 2048
    s_subb_u32 s37, s37, 0
    s_sub_u32 s38, 7342080, s25
    s_mov_b32 s39, 0x00020000
    s_add_u32 s40, s90, s25
    s_addc_u32 s41, s91, 0
    s_sub_u32 s40, s40, 3072
    s_subb_u32 s41, s41, 0
    s_sub_u32 s42, 7343104, s25
    s_mov_b32 s43, 0x00020000
    s_lshl_b32 s28, s20, 12
    s_mov_b32 s30, 0
    s_and_b32 s44, s2, 15
    s_lshl_b32 s44, s44, 1
    s_lshr_b32 s45, s2, 7
    s_lshl_b32 s45, s45, 5
    s_add_u32 s44, s44, s45
    s_bfe_u32 s45, s2, 0x30004
    s_lshl_b32 s45, s45, 8
    s_add_u32 s44, s44, s45
    s_lshr_b32 s45, s20, 2
    s_add_u32 s44, s44, s45
    s_and_b32 s45, s20, 3
    s_lshl_b32 s45, s45, 6
    s_add_u32 s44, s44, s45
    s_mul_i32 s44, s44, 1026
    s_mov_b32 s16, s84
    s_mov_b32 s17, s85
    s_mov_b32 s18, 2101248
    s_mov_b32 s19, 0x00020000
    v_mov_b32 v62, 0
    v_lshrrev_b32 v40, 5, v2
    v_lshlrev_b32 v41, 2, v40
    v_add_u32 v42, s27, v41
    v_cvt_f32_u32 v42, v42
    v_add_f32 v43, 0x41800000, v42
    v_and_b32 v44, 31, v2
    v_cvt_f32_u32 v44, v44
    v_mul_f32 v45, 0x3d000000, v44
    v_and_b32 v46, 15, v2
    v_cvt_f32_u32 v46, v46
    v_mul_f32 v46, 0x3d000000, v46
    v_bfe_u32 v47, v2, 4, 1
    v_cvt_f32_u32 v47, v47
    v_mul_f32 v47, 0x3e800000, v47
    v_add_f32 v48, 0xbe800000, v47
    v_mov_b32 v49, 0x3e800000
    s_mov_b32 s35, 0x3fcfef9e
    s_lshl_b32 s21, s20, 1
    s_add_u32 s21, s21, 147712
    v_add_u32 v50, s21, v3
    v_mul_f32 v52, v45, v42
    v_mul_f32 v53, v45, v43
    v_fma_f32 v54, v45, v42, v49
    v_fma_f32 v55, v45, v43, v49
    v_fma_f32 v56, v46, v42, v47
    v_fma_f32 v57, v46, v43, v47
    v_fma_f32 v58, v46, v42, v48
    v_fma_f32 v59, v46, v43, v48
    v_cos_f32 v52, v52
    v_cos_f32 v53, v53
    v_cos_f32 v54, v54
    v_cos_f32 v55, v55
    v_cos_f32 v56, v56
    v_cos_f32 v57, v57
    v_cos_f32 v58, v58
    v_cos_f32 v59, v59
    v_mul_f32 v52, s35, v52
    v_mul_f32 v53, s35, v53
    v_mul_f32 v54, s35, v54
    v_mul_f32 v55, s35, v55
    v_mul_f32 v56, s35, v56
    v_mul_f32 v57, s35, v57
    v_mul_f32 v58, s35, v58
    v_mul_f32 v59, s35, v59
    v_cvt_pk_bf16_f32 v52, v52, v52
    v_cvt_pk_bf16_f32 v53, v53, v53
    v_cvt_pk_bf16_f32 v54, v54, v54
    v_cvt_pk_bf16_f32 v55, v55, v55
    v_cvt_pk_bf16_f32 v56, v56, v56
    v_cvt_pk_bf16_f32 v57, v57, v57
    v_cvt_pk_bf16_f32 v58, v58, v58
    v_cvt_pk_bf16_f32 v59, v59, v59
    ds_write_b16 v50, v52 offset:0
    ds_write_b16 v50, v53 offset:1024
    ds_write_b16 v50, v54 offset:2048
    ds_write_b16 v50, v55 offset:3072
    ds_write_b16 v50, v56 offset:4096
    ds_write_b16 v50, v57 offset:5120
    ds_write_b16 v50, v58 offset:6144
    ds_write_b16 v50, v59 offset:7168
    v_and_b32 v45, 31, v2
    v_cvt_f32_u32 v45, v45
    v_mul_f32 v45, 0x3a800000, v45
    v_lshrrev_b32 v46, 5, v2
    v_lshlrev_b32 v46, 2, v46
    v_cvt_f32_u32 v46, v46
    v_mul_f32 v46, v45, v46
    v_mov_b32 v47, 0x00000000
    v_fma_f32 v80, v45, v47, v46
    v_mov_b32 v47, 0x3f800000
    v_fma_f32 v81, v45, v47, v46
    v_mov_b32 v47, 0x40000000
    v_fma_f32 v82, v45, v47, v46
    v_mov_b32 v47, 0x40400000
    v_fma_f32 v83, v45, v47, v46
    v_mov_b32 v47, 0x41000000
    v_fma_f32 v84, v45, v47, v46
    v_mov_b32 v47, 0x41100000
    v_fma_f32 v85, v45, v47, v46
    v_mov_b32 v47, 0x41200000
    v_fma_f32 v86, v45, v47, v46
    v_mov_b32 v47, 0x41300000
    v_fma_f32 v87, v45, v47, v46
    v_mov_b32 v47, 0x41800000
    v_fma_f32 v88, v45, v47, v46
    v_mov_b32 v47, 0x41880000
    v_fma_f32 v89, v45, v47, v46
    v_mov_b32 v47, 0x41900000
    v_fma_f32 v90, v45, v47, v46
    v_mov_b32 v47, 0x41980000
    v_fma_f32 v91, v45, v47, v46
    v_mov_b32 v47, 0x41c00000
    v_fma_f32 v92, v45, v47, v46
    v_mov_b32 v47, 0x41c80000
    v_fma_f32 v93, v45, v47, v46
    v_mov_b32 v47, 0x41d00000
    v_fma_f32 v94, v45, v47, v46
    v_mov_b32 v47, 0x41d80000
    v_fma_f32 v95, v45, v47, v46
    v_cos_f32 v64, v80
    v_cos_f32 v65, v81
    v_cos_f32 v66, v82
    v_cos_f32 v67, v83
    v_cos_f32 v68, v84
    v_cos_f32 v69, v85
    v_cos_f32 v70, v86
    v_cos_f32 v71, v87
    v_cos_f32 v72, v88
    v_cos_f32 v73, v89
    v_cos_f32 v74, v90
    v_cos_f32 v75, v91
    v_cos_f32 v76, v92
    v_cos_f32 v77, v93
    v_cos_f32 v78, v94
    v_cos_f32 v79, v95
    v_sin_f32 v80, v80
    v_sin_f32 v81, v81
    v_sin_f32 v82, v82
    v_sin_f32 v83, v83
    v_sin_f32 v84, v84
    v_sin_f32 v85, v85
    v_sin_f32 v86, v86
    v_sin_f32 v87, v87
    v_sin_f32 v88, v88
    v_sin_f32 v89, v89
    v_sin_f32 v90, v90
    v_sin_f32 v91, v91
    v_sin_f32 v92, v92
    v_sin_f32 v93, v93
    v_sin_f32 v94, v94
    v_sin_f32 v95, v95
    s_mul_i32 s25, s20, 2080
    s_add_u32 s25, s25, 131072
    v_add_u32 v51, s25, v3
    v_lshlrev_b32 v60, 8, v40
    v_bfe_u32 v61, v2, 2, 2
    v_lshl_add_u32 v60, v61, 6, v60
    v_bfe_u32 v61, v2, 4, 1
    v_lshl_add_u32 v60, v61, 5, v60
    v_and_b32 v61, 3, v2
    v_lshl_add_u32 v60, v61, 3, v60
    v_add_u32 v60, s25, v60
    v_and_b32 v52, 7, v0
    v_mul_u32_u24 v53, 2080, v52
    v_lshrrev_b32 v54, 3, v0
    v_lshl_add_u32 v53, v54, 4, v53
    v_add_u32 v53, 131072, v53
    v_lshrrev_b32 v55, 2, v54
    v_lshlrev_b32 v55, 14, v55
    v_and_b32 v54, 3, v54
    v_lshl_add_u32 v55, v54, 8, v55
    v_lshl_add_u32 v55, v52, 4, v55
    s_and_b32 s31, s2, 1
    v_lshl_add_u32 v54, v54, 1, s31
    v_cmp_eq_u32 vcc, 3, v54
    v_add_u32 v54, 46137856, v55
    s_nop 0
    v_cndmask_b32 v55, v55, v54, vcc
    s_lshr_b32 s31, s2, 5
    s_lshl_b32 s31, s31, 19
    s_bfe_u32 s32, s2, 0x40001
    s_lshl_b32 s32, s32, 10
    s_add_u32 s31, s31, s32
    s_and_b32 s32, s2, 1
    s_lshl_b32 s32, s32, 7
    s_add_u32 s31, s31, s32
    s_add_u32 s32, s31, 0x40000
    s_mov_b32 s12, s98
    s_mov_b32 s13, s99
    s_mov_b32 s14, 50332160
    s_mov_b32 s15, 0x00020000
    s_cmp_lt_u32 s2, 32
    s_cbranch_scc1 L_rw0_a
    s_waitcnt vmcnt(0)
    s_branch L_rw0_b
L_rw0_a:
    s_waitcnt vmcnt(1)
L_rw0_b:
    s_cmp_lg_u32 s57, 263
    s_cbranch_scc1 L_noflagw
    v_mov_b32 v14, 1
    buffer_store_dword v14, v62, s[52:55], 0 offen sc1
L_noflagw:
    v_lshlrev_b32 v16, 16, v4
    v_and_b32 v17, 0xffff0000, v4
    v_lshlrev_b32 v18, 16, v5
    v_and_b32 v19, 0xffff0000, v5
    v_lshlrev_b32 v20, 16, v6
    v_and_b32 v21, 0xffff0000, v6
    v_lshlrev_b32 v22, 16, v7
    v_and_b32 v23, 0xffff0000, v7
    v_lshlrev_b32 v24, 16, v8
    v_and_b32 v25, 0xffff0000, v8
    v_lshlrev_b32 v26, 16, v9
    v_and_b32 v27, 0xffff0000, v9
    v_lshlrev_b32 v28, 16, v10
    v_and_b32 v29, 0xffff0000, v10
    v_lshlrev_b32 v30, 16, v11
    v_and_b32 v31, 0xffff0000, v11
    v_readfirstlane_b32 s33, v16
    s_nop 1
    v_subrev_f32 v96, s33, v16
    v_subrev_f32 v97, s33, v17
    v_subrev_f32 v98, s33, v18
    v_subrev_f32 v99, s33, v19
    v_subrev_f32 v100, s33, v20
    v_subrev_f32 v101, s33, v21
    v_subrev_f32 v102, s33, v22
    v_subrev_f32 v103, s33, v23
    v_subrev_f32 v104, s33, v24
    v_subrev_f32 v105, s33, v25
    v_subrev_f32 v106, s33, v26
    v_subrev_f32 v107, s33, v27
    v_subrev_f32 v108, s33, v28
    v_subrev_f32 v109, s33, v29
    v_subrev_f32 v110, s33, v30
    v_subrev_f32 v111, s33, v31
    v_add_f32 v32, v96, v97
    v_mul_f32 v35, v96, v96
    v_add_f32 v33, v98, v99
    v_mul_f32 v36, v97, v97
    v_fmac_f32 v35, v98, v98
    v_fmac_f32 v36, v99, v99
    v_add_f32 v32, v32, v100
    v_fmac_f32 v35, v100, v100
    v_add_f32 v33, v33, v101
    v_fmac_f32 v36, v101, v101
    v_add_f32 v32, v32, v102
    v_fmac_f32 v35, v102, v102
    v_add_f32 v33, v33, v103
    v_fmac_f32 v36, v103, v103
    v_add_f32 v32, v32, v104
    v_fmac_f32 v35, v104, v104
    v_add_f32 v33, v33, v105
    v_fmac_f32 v36, v105, v105
    v_add_f32 v32, v32, v106
    v_fmac_f32 v35, v106, v106
    v_add_f32 v33, v33, v107
    v_fmac_f32 v36, v107, v107
    v_add_f32 v32, v32, v108
    v_fmac_f32 v35, v108, v108
    v_add_f32 v33, v33, v109
    v_fmac_f32 v36, v109, v109
    v_add_f32 v32, v32, v110
    v_fmac_f32 v35, v110, v110
    v_add_f32 v33, v33, v111
    v_fmac_f32 v36, v111, v111
    v_add_f32 v32, v32, v33
    v_add_f32 v35, v35, v36
    s_nop 0
    s_nop 0
    v_add_f32_dpp v32, v32, v32 quad_perm:[1,0,3,2] row_mask:0xf bank_mask:0xf
    v_add_f32_dpp v35, v35, v35 quad_perm:[1,0,3,2] row_mask:0xf bank_mask:0xf
    s_nop 0
    v_add_f32_dpp v32, v32, v32 quad_perm:[2,3,0,1] row_mask:0xf bank_mask:0xf
    v_add_f32_dpp v35, v35, v35 quad_perm:[2,3,0,1] row_mask:0xf bank_mask:0xf
    s_nop 0
    v_add_f32_dpp v32, v32, v32 row_half_mirror row_mask:0xf bank_mask:0xf
    v_add_f32_dpp v35, v35, v35 row_half_mirror row_mask:0xf bank_mask:0xf
    s_nop 0
    v_add_f32_dpp v32, v32, v32 row_mirror row_mask:0xf bank_mask:0xf
    v_add_f32_dpp v35, v35, v35 row_mirror row_mask:0xf bank_mask:0xf
    s_nop 0
    v_readlane_b32 s4, v32, 0
    v_readlane_b32 s5, v32, 16
    v_readlane_b32 s6, v32, 32
    v_readlane_b32 s7, v32, 48
    v_readlane_b32 s8, v35, 0
    v_readlane_b32 s9, v35, 16
    v_readlane_b32 s10, v35, 32
    v_readlane_b32 s11, v35, 48
    v_mov_b32 v32, s4
    v_add_f32 v32, s5, v32
    v_add_f32 v32, s6, v32
    v_add_f32 v32, s7, v32
    v_mov_b32 v35, s8
    v_add_f32 v35, s9, v35
    v_add_f32 v35, s10, v35
    v_add_f32 v35, s11, v35
    v_mul_f32 v32, 0x3a800000, v32
    v_mul_f32 v35, 0x3a800000, v35
    v_fma_f32 v35, -v32, v32, v35
    v_max_f32 v35, 0, v35
    v_add_f32 v32, s33, v32
    v_cvt_pk_bf16_f32 v35, v35, v35
    v_and_b32 v35, 0xffff0000, v35
    v_add_f32 v35, 0x3727c5ac, v35
    v_cvt_pk_bf16_f32 v35, v35, v35
    v_and_b32 v35, 0xffff0000, v35
    v_sqrt_f32 v35, v35
    v_cvt_pk_bf16_f32 v32, v32, v32
    v_and_b32 v32, 0xffff0000, v32
    v_cvt_pk_bf16_f32 v35, v35, v35
    v_and_b32 v35, 0xffff0000, v35
    v_rcp_f32 v35, v35
    v_sub_f32 v16, v16, v32
    v_sub_f32 v17, v17, v32
    v_cvt_pk_bf16_f32 v34, v16, v17
    v_lshlrev_b32 v16, 16, v34
    v_and_b32 v17, 0xffff0000, v34
    v_mul_f32 v16, v16, v35
    v_mul_f32 v17, v17, v35
    v_cvt_pk_bf16_f32 v4, v16, v17
    v_sub_f32 v18, v18, v32
    v_sub_f32 v19, v19, v32
    v_cvt_pk_bf16_f32 v34, v18, v19
    v_lshlrev_b32 v18, 16, v34
    v_and_b32 v19, 0xffff0000, v34
    v_mul_f32 v18, v18, v35
    v_mul_f32 v19, v19, v35
    v_cvt_pk_bf16_f32 v5, v18, v19
    v_sub_f32 v20, v20, v32
    v_sub_f32 v21, v21, v32
    v_cvt_pk_bf16_f32 v34, v20, v21
    v_lshlrev_b32 v20, 16, v34
    v_and_b32 v21, 0xffff0000, v34
    v_mul_f32 v20, v20, v35
    v_mul_f32 v21, v21, v35
    v_cvt_pk_bf16_f32 v6, v20, v21
    v_sub_f32 v22, v22, v32
    v_sub_f32 v23, v23, v32
    v_cvt_pk_bf16_f32 v34, v22, v23
    v_lshlrev_b32 v22, 16, v34
    v_and_b32 v23, 0xffff0000, v34
    v_mul_f32 v22, v22, v35
    v_mul_f32 v23, v23, v35
    v_cvt_pk_bf16_f32 v7, v22, v23
    v_sub_f32 v24, v24, v32
    v_sub_f32 v25, v25, v32
    v_cvt_pk_bf16_f32 v34, v24, v25
    v_lshlrev_b32 v24, 16, v34
    v_and_b32 v25, 0xffff0000, v34
    v_mul_f32 v24, v24, v35
    v_mul_f32 v25, v25, v35
    v_cvt_pk_bf16_f32 v8, v24, v25
    v_sub_f32 v26, v26, v32
    v_sub_f32 v27, v27, v32
    v_cvt_pk_bf16_f32 v34, v26, v27
    v_lshlrev_b32 v26, 16, v34
    v_and_b32 v27, 0xffff0000, v34
    v_mul_f32 v26, v26, v35
    v_mul_f32 v27, v27, v35
    v_cvt_pk_bf16_f32 v9, v26, v27
    v_sub_f32 v28, v28, v32
    v_sub_f32 v29, v29, v32
    v_cvt_pk_bf16_f32 v34, v28, v29
    v_lshlrev_b32 v28, 16, v34
    v_and_b32 v29, 0xffff0000, v34
    v_mul_f32 v28, v28, v35
    v_mul_f32 v29, v29, v35
    v_cvt_pk_bf16_f32 v10, v28, v29
    v_sub_f32 v30, v30, v32
    v_sub_f32 v31, v31, v32
    v_cvt_pk_bf16_f32 v34, v30, v31
    v_lshlrev_b32 v30, 16, v34
    v_and_b32 v31, 0xffff0000, v34
    v_mul_f32 v30, v30, v35
    v_mul_f32 v31, v31, v35
    v_cvt_pk_bf16_f32 v11, v30, v31
    ds_write_b128 v51, v[4:7]
    ds_write_b128 v51, v[8:11] offset:1024
    s_waitcnt lgkmcnt(0)
    s_barrier
    ds_read_b128 v[12:15], v53
    ds_read_b128 v[56:59], v53 offset:1024
    ds_read_b64_tr_b16 v[4:5], v60 offset:0
    ds_read_b64_tr_b16 v[6:7], v60 offset:512
    ds_read_b64_tr_b16 v[8:9], v60 offset:1024
    ds_read_b64_tr_b16 v[10:11], v60 offset:1536
    v_add_u32 v61, 147712, v3
    ds_read_b128 v[96:99], v61 offset:0
    ds_read_b128 v[100:103], v61 offset:1024
    ds_read_b128 v[104:107], v61 offset:2048
    ds_read_b128 v[108:111], v61 offset:3072
    ds_read_b128 v[112:115], v61 offset:4096
    ds_read_b128 v[116:119], v61 offset:5120
    ds_read_b128 v[120:123], v61 offset:6144
    ds_read_b128 v[124:127], v61 offset:7168
    s_waitcnt lgkmcnt(12)
    buffer_store_dwordx4 v[12:15], v55, s[12:15], s31 offen sc1
    buffer_store_dwordx4 v[56:59], v55, s[12:15], s32 offen sc1
    s_cmp_lg_u32 s20, 0
    s_cbranch_scc1 L_noflag
    buffer_load_dword v63, v62, s[52:55], 0 offen sc1
L_noflag:
    s_mov_b32 s4, s82
    s_mov_b32 s5, s83
    s_mov_b32 s6, 2101248
    s_mov_b32 s7, 0x00020000
    buffer_load_dwordx4 v[132:135], v3, s[4:7], s44 offen
    buffer_load_dwordx4 v[136:139], v3, s[16:19], s44 offen
    buffer_load_ushort v148, v62, s[4:7], s44 offen offset:1024
    buffer_load_ushort v149, v62, s[16:19], s44 offen offset:1024
    s_cmp_lt_u32 s2, 32
    s_cbranch_scc1 L_w1a
    s_add_u32 m0, s28, 0
    s_nop 0
    buffer_load_dwordx4 v152, s[36:39], s30 offen offset:2048 lds
    buffer_load_dwordx4 v152, s[40:43], s30 offen offset:3072 lds
    s_add_u32 s30, s30, 229376
    s_add_u32 m0, s28, 32768
    s_nop 0
    buffer_load_dwordx4 v152, s[36:39], s30 offen offset:2048 lds
    buffer_load_dwordx4 v152, s[40:43], s30 offen offset:3072 lds
    s_add_u32 s30, s30, 229376
L_w1a:
    s_waitcnt lgkmcnt(4)
    v_mfma_f32_32x32x16_bf16 v[16:31], v[4:7], v[96:99], 0
    v_mfma_f32_32x32x16_bf16 v[32:47], v[4:7], v[104:107], 0
    v_mfma_f32_32x32x16_bf16 v[16:31], v[8:11], v[100:103], v[16:31]
    v_mfma_f32_32x32x16_bf16 v[32:47], v[8:11], v[108:111], v[32:47]
    s_nop 11
    v_cmp_eq_u32 vcc, 0, v2
    v_sub_f32 v50, v16, v17
    v_sub_f32 v51, v18, v19
    v_add_f32 v50, v50, v20
    v_sub_f32 v50, v50, v21
    v_add_f32 v51, v51, v22
    v_sub_f32 v51, v51, v23
    v_add_f32 v50, v50, v24
    v_sub_f32 v50, v50, v25
    v_add_f32 v51, v51, v26
    v_sub_f32 v51, v51, v27
    v_add_f32 v50, v50, v28
    v_sub_f32 v50, v50, v29
    v_add_f32 v51, v51, v30
    v_sub_f32 v51, v51, v31
    v_add_f32 v50, v50, v51
    v_mul_f32 v48, v16, v80
    v_mul_f32 v16, v16, v64
    v_fmac_f32 v16, v32, v80
    v_fma_f32 v32, v32, v64, -v48
    v_mul_f32 v48, v17, v81
    v_mul_f32 v17, v17, v65
    v_fmac_f32 v17, v33, v81
    v_fma_f32 v33, v33, v65, -v48
    v_mul_f32 v48, v18, v82
    v_mul_f32 v18, v18, v66
    v_fmac_f32 v18, v34, v82
    v_fma_f32 v34, v34, v66, -v48
    v_mul_f32 v48, v19, v83
    v_mul_f32 v19, v19, v67
    v_fmac_f32 v19, v35, v83
    v_fma_f32 v35, v35, v67, -v48
    v_mul_f32 v48, v20, v84
    v_mul_f32 v20, v20, v68
    v_fmac_f32 v20, v36, v84
    v_fma_f32 v36, v36, v68, -v48
    v_mul_f32 v48, v21, v85
    v_mul_f32 v21, v21, v69
    v_fmac_f32 v21, v37, v85
    v_fma_f32 v37, v37, v69, -v48
    v_mul_f32 v48, v22, v86
    v_mul_f32 v22, v22, v70
    v_fmac_f32 v22, v38, v86
    v_fma_f32 v38, v38, v70, -v48
    v_mul_f32 v48, v23, v87
    v_mul_f32 v23, v23, v71
    v_fmac_f32 v23, v39, v87
    v_fma_f32 v39, v39, v71, -v48
    v_mul_f32 v48, v24, v88
    v_mul_f32 v24, v24, v72
    v_fmac_f32 v24, v40, v88
    v_fma_f32 v40, v40, v72, -v48
    v_mul_f32 v48, v25, v89
    v_mul_f32 v25, v25, v73
    v_fmac_f32 v25, v41, v89
    v_fma_f32 v41, v41, v73, -v48
    v_mul_f32 v48, v26, v90
    v_mul_f32 v26, v26, v74
    v_fmac_f32 v26, v42, v90
    v_fma_f32 v42, v42, v74, -v48
    v_mul_f32 v48, v27, v91
    v_mul_f32 v27, v27, v75
    v_fmac_f32 v27, v43, v91
    v_fma_f32 v43, v43, v75, -v48
    v_mul_f32 v48, v28, v92
    v_mul_f32 v28, v28, v76
    v_fmac_f32 v28, v44, v92
    v_fma_f32 v44, v44, v76, -v48
    v_mul_f32 v48, v29, v93
    v_mul_f32 v29, v29, v77
    v_fmac_f32 v29, v45, v93
    v_fma_f32 v45, v45, v77, -v48
    v_mul_f32 v48, v30, v94
    v_mul_f32 v30, v30, v78
    v_fmac_f32 v30, v46, v94
    v_fma_f32 v46, v46, v78, -v48
    v_mul_f32 v48, v31, v95
    v_mul_f32 v31, v31, v79
    v_fmac_f32 v31, v47, v95
    v_fma_f32 v47, v47, v79, -v48
    v_readlane_b32 s33, v50, 0
    v_readlane_b32 s34, v50, 32
    v_cvt_pk_bf16_f32 v4, v16, v17
    v_cvt_pk_bf16_f32 v5, v18, v19
    v_cvt_pk_bf16_f32 v6, v20, v21
    v_cvt_pk_bf16_f32 v7, v22, v23
    v_cvt_pk_bf16_f32 v8, v24, v25
    v_cvt_pk_bf16_f32 v9, v26, v27
    v_cvt_pk_bf16_f32 v10, v28, v29
    v_cvt_pk_bf16_f32 v11, v30, v31
    v_cvt_pk_bf16_f32 v64, v32, v33
    v_cvt_pk_bf16_f32 v65, v34, v35
    v_cvt_pk_bf16_f32 v66, v36, v37
    v_cvt_pk_bf16_f32 v67, v38, v39
    v_cvt_pk_bf16_f32 v68, v40, v41
    v_cvt_pk_bf16_f32 v69, v42, v43
    v_cvt_pk_bf16_f32 v70, v44, v45
    v_cvt_pk_bf16_f32 v71, v46, v47
    v_mov_b32 v50, s33
    v_add_f32 v50, s34, v50
    s_waitcnt lgkmcnt(0)
    v_mfma_f32_32x32x16_bf16 v[16:31], v[112:115], v[4:7], 0
    v_mfma_f32_32x32x16_bf16 v[16:31], v[116:119], v[8:11], v[16:31]
    v_mfma_f32_32x32x16_bf16 v[16:31], v[120:123], v[64:67], v[16:31]
    v_mfma_f32_32x32x16_bf16 v[16:31], v[124:127], v[68:71], v[16:31]
    v_mul_f32 v50, s35, v50
    s_lshl_b32 s25, s20, 12
    v_add_u32 v51, s25, v3
    v_bfe_u32 v52, v0, 1, 5
    v_bfe_u32 v53, v0, 8, 1
    v_lshl_add_u32 v52, v53, 5, v52
    v_bfe_u32 v53, v0, 6, 2
    v_lshl_add_u32 v52, v52, 2, v53
    v_lshlrev_b32 v52, 2, v52
    v_add_u32 v72, 1024, v52
    v_lshrrev_b32 v53, 3, v0
    v_lshlrev_b32 v53, 15, v53
    v_and_b32 v54, 7, v0
    v_lshl_add_u32 v53, v54, 4, v53
    v_and_b32 v54, 1, v0
    v_mul_u32_u24 v54, 0x0202, v54
    v_lshl_or_b32 v54, v54, 16, v54
    v_add_u32 v54, 0x05040100, v54
    v_cndmask_b32 v24, v24, v50, vcc
    v_cvt_pk_bf16_f32 v32, v16, v24
    v_cvt_pk_bf16_f32 v33, v17, v25
    v_cvt_pk_bf16_f32 v34, v18, v26
    v_cvt_pk_bf16_f32 v35, v19, v27
    v_cvt_pk_bf16_f32 v36, v20, v28
    v_cvt_pk_bf16_f32 v37, v21, v29
    v_cvt_pk_bf16_f32 v38, v22, v30
    v_cvt_pk_bf16_f32 v39, v23, v31
    ds_write_b128 v51, v[32:35]
    ds_write_b128 v51, v[36:39] offset:1024
    s_cmp_lt_u32 s2, 32
    s_cbranch_scc1 L_rw2_a
    s_waitcnt vmcnt(8)
    s_branch L_rw2_b
L_rw2_a:
    s_waitcnt vmcnt(4)
L_rw2_b:
    s_waitcnt lgkmcnt(0)
    s_barrier
    s_cmp_lg_u32 s20, 0
    s_cbranch_scc1 L_p0_nosig
    v_readfirstlane_b32 s21, v63
    s_nop 3
    s_cmp_lg_u32 s21, 0
    s_cbranch_scc1 L_clr_done
    s_mov_b32 s58, 0
L_clr:
    buffer_load_dword v63, v62, s[52:55], 0 offen sc1
    s_waitcnt vmcnt(0)
    v_cmp_gt_u32 vcc, 1, v63
    s_nop 1
    s_cmp_eq_u64 vcc, 0
    s_cbranch_scc1 L_clr_done
    s_sleep 1
    s_add_u32 s58, s58, 1
    s_cmp_lt_u32 s58, 0x80000
    s_cbranch_scc1 L_clr
L_clr_done:
    s_lshr_b32 s21, s2, 5
    s_lshl_b32 s21, s21, 8
    v_mov_b32 v62, s21
    v_mov_b32 v63, 1
    s_mov_b64 s[78:79], exec
    s_mov_b64 exec, 1
    buffer_atomic_add v63, v62, s[48:51], 0 offen
    s_mov_b64 exec, s[78:79]
L_p0_nosig:
    ds_read2st64_b32 v[16:17], v52 offset0:0 offset1:16
    ds_read2st64_b32 v[18:19], v52 offset0:32 offset1:48
    ds_read2st64_b32 v[20:21], v52 offset0:64 offset1:80
    ds_read2st64_b32 v[22:23], v52 offset0:96 offset1:112
    ds_read2st64_b32 v[24:25], v72 offset0:0 offset1:16
    ds_read2st64_b32 v[26:27], v72 offset0:32 offset1:48
    ds_read2st64_b32 v[28:29], v72 offset0:64 offset1:80
    ds_read2st64_b32 v[30:31], v72 offset0:96 offset1:112
    s_add_u32 s12, s98, 20971520
    s_addc_u32 s13, s99, 0
    s_mov_b32 s14, 4194304
    s_mov_b32 s15, 0x00020000
    s_add_u32 s16, s98, 33554432
    s_addc_u32 s17, s99, 0
    s_mov_b32 s18, 4194304
    s_mov_b32 s19, 0x00020000
    s_add_u32 s4, s98, 39845888
    s_addc_u32 s5, s99, 0
    s_mov_b32 s6, 8192
    s_mov_b32 s7, 0x00020000
    s_bfe_u32 s21, s2, 0x10005
    s_lshl_b32 s21, s21, 14
    s_lshr_b32 s22, s2, 6
    s_lshl_b32 s22, s22, 12
    s_add_u32 s21, s21, s22
    s_and_b32 s22, s2, 31
    s_lshl_b32 s22, s22, 7
    s_add_u32 s21, s21, s22
    s_add_u32 s22, s21, 2097152
    s_lshl_b32 s25, s2, 7
    s_add_u32 s26, s25, 2097152
    s_lshl_b32 s31, s2, 5
    s_lshl_b32 s32, s20, 2
    s_add_u32 s31, s31, s32
    v_lshlrev_b32 v131, 20, v2
    s_waitcnt lgkmcnt(0)
    v_perm_b32 v32, v17, v16, v54
    v_perm_b32 v33, v19, v18, v54
    v_perm_b32 v34, v21, v20, v54
    v_perm_b32 v35, v23, v22, v54
    v_perm_b32 v36, v25, v24, v54
    v_perm_b32 v37, v27, v26, v54
    v_perm_b32 v38, v29, v28, v54
    v_perm_b32 v39, v31, v30, v54
    buffer_store_dwordx4 v[32:35], v53, s[12:15], s21 offen sc1
    buffer_store_dwordx4 v[36:39], v53, s[12:15], s22 offen sc1
    s_cmp_lt_u32 s2, 32
    s_cbranch_scc1 L_rw1_a
    s_waitcnt vmcnt(6)
    s_branch L_rw1_b
L_rw1_a:
    s_waitcnt vmcnt(2)
L_rw1_b:
    s_mov_b32 s33, 0x05040100
    s_mov_b32 s34, 0x07060302
    v_perm_b32 v140, v136, v132, s33
    v_perm_b32 v141, v136, v132, s34
    v_perm_b32 v142, v137, v133, s33
    v_perm_b32 v143, v137, v133, s34
    v_perm_b32 v144, v138, v134, s33
    v_perm_b32 v145, v138, v134, s34
    v_perm_b32 v146, v139, v135, s33
    v_perm_b32 v147, v139, v135, s34
    v_lshl_or_b32 v148, v149, 16, v148
    s_lshl_b32 s32, s20, 12
    s_add_u32 s32, s32, 32768
    v_lshl_add_u32 v128, v2, 5, s32
    ds_write_b128 v128, v[140:143]
    ds_write_b128 v128, v[144:147] offset:16
    s_waitcnt lgkmcnt(0)
    s_barrier
    v_and_b32 v128, 1, v0
    v_lshlrev_b32 v128, 14, v128
    v_lshrrev_b32 v129, 1, v0
    v_lshl_add_u32 v128, v129, 2, v128
    v_add_u32 v128, 32768, v128
    ds_read2st64_b32 v[132:133], v128 offset0:0 offset1:16
    ds_read2st64_b32 v[134:135], v128 offset0:32 offset1:48
    ds_read2st64_b32 v[136:137], v128 offset0:4 offset1:20
    ds_read2st64_b32 v[138:139], v128 offset0:36 offset1:52
    s_waitcnt lgkmcnt(0)
    buffer_store_dwordx4 v[132:135], v53, s[16:19], s25 offen sc1
    buffer_store_dwordx4 v[136:139], v53, s[16:19], s26 offen sc1
    buffer_store_dword v148, v131, s[4:7], s31 offen sc1
    s_cmp_lt_u32 s2, 32
    s_cbranch_scc1 L_aux
    v_mov_b32 v5, v152
    s_lshl_b32 s26, s20, 11
    v_add_u32 v4, s26, v3
    v_lshrrev_b32 v6, 3, v2
    v_cmp_eq_u32 vcc, 3, v6
    v_add_u32 v6, 46137856, v4
    s_nop 0
    v_cndmask_b32 v4, v4, v6, vcc
    s_lshl_b32 s25, s23, 19
    s_add_u32 s4, s98, s25
    s_addc_u32 s5, s99, 0
    s_mov_b32 s6, 46662144
    s_mov_b32 s7, 0x00020000
    s_add_u32 s16, s98, 4194304
    s_addc_u32 s17, s99, 0
    s_mov_b32 s18, 14680064
    s_mov_b32 s19, 0x00020000
    s_cmp_lg_u32 s20, 0
    s_cbranch_scc1 L_g1_nopoll
    s_lshl_b32 s21, s23, 8
    v_mov_b32 v62, s21
    s_mov_b32 s58, 0
L_px:
    buffer_load_dword v63, v62, s[48:51], 0 offen sc1
    s_waitcnt vmcnt(0)
    v_cmp_gt_u32 vcc, 32, v63
    s_nop 1
    s_cmp_eq_u64 vcc, 0
    s_cbranch_scc1 L_px_done
    s_sleep 1
    s_add_u32 s58, s58, 1
    s_cmp_lt_u32 s58, 0x80000
    s_cbranch_scc1 L_px
L_px_done:
L_g1_nopoll:
    s_waitcnt vmcnt(0)
    s_barrier
    s_cmp_lg_u32 s20, 1
    s_cbranch_scc1 L_g1_nosig
    s_lshr_b32 s21, s2, 5
    s_add_u32 s21, s21, 8
    s_lshl_b32 s21, s21, 8
    v_mov_b32 v12, s21
    v_mov_b32 v13, 1
    s_mov_b64 s[78:79], exec
    s_mov_b64 exec, 1
    buffer_atomic_add v13, v12, s[48:51], 0 offen
    s_mov_b64 exec, s[78:79]
L_g1_nosig:
    s_mov_b32 s29, 0
    s_add_u32 m0, s28, 0
    s_nop 0
    buffer_load_dwordx4 v4, s[4:7], s29 offen sc1 lds
    buffer_load_dwordx4 v4, s[4:7], s29 offen offset:1024 sc1 lds
    s_add_u32 s29, s29, 16384
    s_add_u32 m0, s28, 32768
    s_nop 0
    buffer_load_dwordx4 v4, s[4:7], s29 offen sc1 lds
    buffer_load_dwordx4 v4, s[4:7], s29 offen offset:1024 sc1 lds
    s_add_u32 s29, s29, 16384
    s_and_b32 s26, s20, 1
    s_lshl_b32 s26, s26, 14
    v_add_u32 v6, s26, v3
    s_lshr_b32 s25, s20, 1
    v_bfe_u32 v9, v2, 2, 2
    v_lshlrev_b32 v10, 8, v9
    v_and_b32 v8, 3, v2
    v_lshl_add_u32 v8, v8, 3, v10
    v_lshrrev_b32 v10, 4, v2
    v_lshl_add_u32 v8, v10, 13, v8
    v_and_b32 v11, 1, v10
    v_lshl_add_u32 v8, v11, 5, v8
    v_add_u32 v8, 2048, v8
    v_xor_b32 v10, s25, v9
    v_lshl_add_u32 v24, v10, 6, v8
    v_xor_b32 v25, 32, v24
    s_and_b32 s21, s2, 7
    s_lshr_b32 s22, s2, 3
    s_lshr_b32 s44, s21, 1
    s_lshl_b32 s44, s44, 2
    s_and_b32 s45, s22, 3
    s_add_u32 s44, s44, s45
    s_and_b32 s45, s21, 1
    s_lshl_b32 s45, s45, 3
    s_lshr_b32 s21, s22, 2
    s_add_u32 s45, s45, s21
    s_lshl_b32 s21, s45, 7
    s_add_u32 s8, s92, s21
    s_addc_u32 s9, s93, 0
    s_sub_u32 s10, 7340032, s21
    s_mov_b32 s11, 0x00020000
    v_lshrrev_b32 v14, 3, v2
    s_lshl_b32 s21, s20, 3
    v_add_u32 v14, s21, v14
    v_lshlrev_b32 v14, 11, v14
    v_bfe_u32 v15, v2, 4, 1
    v_lshlrev_b32 v15, 2, v15
    v_and_b32 v1, 7, v2
    v_xor_b32 v15, v15, v1
    v_lshl_add_u32 v14, v15, 4, v14
    s_lshl_b32 s46, s20, 10
    s_mov_b32 s47, 0
    s_sub_u32 s21, s2, 32
    s_lshr_b32 s22, s21, 3
    s_mul_i32 s25, s22, 26
    s_lshr_b32 s25, s25, 8
    s_mul_i32 s25, s25, 10
    s_sub_u32 s25, s22, s25
    s_add_u32 s25, s25, 2
    s_lshl_b32 s34, s25, 1
    s_mov_b32 s12, s92
    s_mov_b32 s13, s93
    s_mov_b32 s14, 7340032
    s_mov_b32 s15, 0x00020000
    v_lshlrev_b32 v20, 6, v2
    s_lshl_b32 s21, s21, 3
    s_add_u32 s21, s21, s20
    s_lshl_b32 s35, s21, 12
    v_mov_b32 v128, 0
    v_mov_b32 v129, 0
    v_mov_b32 v130, 0
    v_mov_b32 v131, 0
    v_mov_b32 v132, 0
    v_mov_b32 v133, 0
    v_mov_b32 v134, 0
    v_mov_b32 v135, 0
    v_mov_b32 v136, 0
    v_mov_b32 v137, 0
    v_mov_b32 v138, 0
    v_mov_b32 v139, 0
    v_mov_b32 v140, 0
    v_mov_b32 v141, 0
    v_mov_b32 v142, 0
    v_mov_b32 v143, 0
    v_mov_b32 v144, 0
    v_mov_b32 v145, 0
    v_mov_b32 v146, 0
    v_mov_b32 v147, 0
    v_mov_b32 v148, 0
    v_mov_b32 v149, 0
    v_mov_b32 v150, 0
    v_mov_b32 v151, 0
    v_mov_b32 v152, 0
    v_mov_b32 v153, 0
    v_mov_b32 v154, 0
    v_mov_b32 v155, 0
    v_mov_b32 v156, 0
    v_mov_b32 v157, 0
    v_mov_b32 v158, 0
    v_mov_b32 v159, 0
    v_mov_b32 v160, 0
    v_mov_b32 v161, 0
    v_mov_b32 v162, 0
    v_mov_b32 v163, 0
    v_mov_b32 v164, 0
    v_mov_b32 v165, 0
    v_mov_b32 v166, 0
    v_mov_b32 v167, 0
    v_mov_b32 v168, 0
    v_mov_b32 v169, 0
    v_mov_b32 v170, 0
    v_mov_b32 v171, 0
    v_mov_b32 v172, 0
    v_mov_b32 v173, 0
    v_mov_b32 v174, 0
    v_mov_b32 v175, 0
    v_mov_b32 v176, 0
    v_mov_b32 v177, 0
    v_mov_b32 v178, 0
    v_mov_b32 v179, 0
    v_mov_b32 v180, 0
    v_mov_b32 v181, 0
    v_mov_b32 v182, 0
    v_mov_b32 v183, 0
    v_mov_b32 v184, 0
    v_mov_b32 v185, 0
    v_mov_b32 v186, 0
    v_mov_b32 v187, 0
    v_mov_b32 v188, 0
    v_mov_b32 v189, 0
    v_mov_b32 v190, 0
    v_mov_b32 v191, 0
    v_mov_b32 v192, 0
    v_mov_b32 v193, 0
    v_mov_b32 v194, 0
    v_mov_b32 v195, 0
    v_mov_b32 v196, 0
    v_mov_b32 v197, 0
    v_mov_b32 v198, 0
    v_mov_b32 v199, 0
    v_mov_b32 v200, 0
    v_mov_b32 v201, 0
    v_mov_b32 v202, 0
    v_mov_b32 v203, 0
    v_mov_b32 v204, 0
    v_mov_b32 v205, 0
    v_mov_b32 v206, 0
    v_mov_b32 v207, 0
    v_mov_b32 v208, 0
    v_mov_b32 v209, 0
    v_mov_b32 v210, 0
    v_mov_b32 v211, 0
    v_mov_b32 v212, 0
    v_mov_b32 v213, 0
    v_mov_b32 v214, 0
    v_mov_b32 v215, 0
    v_mov_b32 v216, 0
    v_mov_b32 v217, 0
    v_mov_b32 v218, 0
    v_mov_b32 v219, 0
    v_mov_b32 v220, 0
    v_mov_b32 v221, 0
    v_mov_b32 v222, 0
    v_mov_b32 v223, 0
    v_mov_b32 v224, 0
    v_mov_b32 v225, 0
    v_mov_b32 v226, 0
    v_mov_b32 v227, 0
    v_mov_b32 v228, 0
    v_mov_b32 v229, 0
    v_mov_b32 v230, 0
    v_mov_b32 v231, 0
    v_mov_b32 v232, 0
    v_mov_b32 v233, 0
    v_mov_b32 v234, 0
    v_mov_b32 v235, 0
    v_mov_b32 v236, 0
    v_mov_b32 v237, 0
    v_mov_b32 v238, 0
    v_mov_b32 v239, 0
    v_mov_b32 v240, 0
    v_mov_b32 v241, 0
    v_mov_b32 v242, 0
    v_mov_b32 v243, 0
    v_mov_b32 v244, 0
    v_mov_b32 v245, 0
    v_mov_b32 v246, 0
    v_mov_b32 v247, 0
    v_mov_b32 v248, 0
    v_mov_b32 v249, 0
    v_mov_b32 v250, 0
    v_mov_b32 v251, 0
    v_mov_b32 v252, 0
    v_mov_b32 v253, 0
    v_mov_b32 v254, 0
    v_mov_b32 v255, 0
    s_waitcnt vmcnt(2)
    s_barrier
    v_add_u32 v16, 0, v6
    v_add_u32 v17, 0, v24
    v_add_u32 v18, 0, v25
    ds_read_b64_tr_b16 v[32:33], v17 offset:0
    ds_read_b64_tr_b16 v[34:35], v17 offset:4096
    ds_read_b128 v[48:51], v16 offset:0
    ds_read_b64_tr_b16 v[36:37], v17 offset:1024
    ds_read_b64_tr_b16 v[38:39], v17 offset:5120
    ds_read_b64_tr_b16 v[40:41], v18 offset:0
    ds_read_b64_tr_b16 v[42:43], v18 offset:4096
    ds_read_b64_tr_b16 v[44:45], v18 offset:1024
    ds_read_b64_tr_b16 v[46:47], v18 offset:5120
    ds_read_b128 v[52:55], v16 offset:1024
    ds_read_b128 v[56:59], v16 offset:4096
    ds_read_b128 v[60:63], v16 offset:5120
    ds_read_b128 v[64:67], v16 offset:8192
    ds_read_b128 v[68:71], v16 offset:9216
    ds_read_b128 v[72:75], v16 offset:12288
    ds_read_b128 v[76:79], v16 offset:13312
    s_add_u32 m0, s28, 65536
    s_nop 0
    buffer_load_dwordx4 v4, s[4:7], s29 offen sc1 lds
    buffer_load_dwordx4 v4, s[4:7], s29 offen offset:1024 sc1 lds
    s_add_u32 s29, s29, 16384
    buffer_load_dwordx4 v5, s[36:39], s30 offen offset:2048 lds
    buffer_load_dwordx4 v5, s[40:43], s30 offen offset:3072 lds
    s_add_u32 s30, s30, 229376
    s_add_u32 m0, s28, 98304
    s_nop 0
    buffer_load_dwordx4 v4, s[4:7], s29 offen sc1 lds
    buffer_load_dwordx4 v4, s[4:7], s29 offen offset:1024 sc1 lds
    s_add_u32 s29, s29, 16384
    buffer_load_dwordx4 v5, s[36:39], s30 offen offset:2048 lds
    buffer_load_dwordx4 v5, s[40:43], s30 offen offset:3072 lds
    s_add_u32 s30, s30, 229376
    s_mov_b32 s32, 0
    s_add_u32 s31, s28, s32
    s_add_u32 s32, s32, 32768
    s_cmp_ge_u32 s32, 131072
    s_cselect_b32 s32, 0, s32
    v_add_u32 v16, s32, v6
    v_add_u32 v17, s32, v24
    v_add_u32 v18, s32, v25
    s_mov_b32 s33, 0
L_g1_loop:
    s_waitcnt vmcnt(8) lgkmcnt(0)
    s_barrier
    v_mfma_f32_16x16x32_bf16 v[128:131], v[32:35], v[48:51], v[128:131]
    s_mov_b32 m0, s31
    v_mfma_f32_16x16x32_bf16 v[132:135], v[36:39], v[48:51], v[132:135]
    ds_read_b64_tr_b16 v[80:81], v17 offset:0
    v_mfma_f32_16x16x32_bf16 v[136:139], v[40:43], v[48:51], v[136:139]
    ds_read_b64_tr_b16 v[82:83], v17 offset:4096
    v_mfma_f32_16x16x32_bf16 v[140:143], v[44:47], v[48:51], v[140:143]
    buffer_load_dwordx4 v4, s[4:7], s29 offen sc1 lds
    v_mfma_f32_16x16x32_bf16 v[144:147], v[32:35], v[52:55], v[144:147]
    ds_read_b128 v[96:99], v16 offset:0
    v_mfma_f32_16x16x32_bf16 v[148:151], v[36:39], v[52:55], v[148:151]
    ds_read_b64_tr_b16 v[84:85], v17 offset:1024
    v_mfma_f32_16x16x32_bf16 v[152:155], v[40:43], v[52:55], v[152:155]
    buffer_load_dwordx4 v4, s[4:7], s29 offen offset:1024 sc1 lds
    v_mfma_f32_16x16x32_bf16 v[156:159], v[44:47], v[52:55], v[156:159]
    ds_read_b64_tr_b16 v[86:87], v17 offset:5120
    v_mfma_f32_16x16x32_bf16 v[160:163], v[32:35], v[56:59], v[160:163]
    ds_read_b64_tr_b16 v[88:89], v18 offset:0
    v_mfma_f32_16x16x32_bf16 v[164:167], v[36:39], v[56:59], v[164:167]
    buffer_load_dwordx4 v5, s[36:39], s30 offen offset:2048 lds
    v_mfma_f32_16x16x32_bf16 v[168:171], v[40:43], v[56:59], v[168:171]
    ds_read_b64_tr_b16 v[90:91], v18 offset:4096
    v_mfma_f32_16x16x32_bf16 v[172:175], v[44:47], v[56:59], v[172:175]
    ds_read_b64_tr_b16 v[92:93], v18 offset:1024
    v_mfma_f32_16x16x32_bf16 v[176:179], v[32:35], v[60:63], v[176:179]
    buffer_load_dwordx4 v5, s[40:43], s30 offen offset:3072 lds
    v_mfma_f32_16x16x32_bf16 v[180:183], v[36:39], v[60:63], v[180:183]
    ds_read_b64_tr_b16 v[94:95], v18 offset:5120
    v_mfma_f32_16x16x32_bf16 v[184:187], v[40:43], v[60:63], v[184:187]
    ds_read_b128 v[100:103], v16 offset:1024
    v_mfma_f32_16x16x32_bf16 v[188:191], v[44:47], v[60:63], v[188:191]
    s_add_u32 s29, s29, 16384
    v_mfma_f32_16x16x32_bf16 v[192:195], v[32:35], v[64:67], v[192:195]
    ds_read_b128 v[104:107], v16 offset:4096
    v_mfma_f32_16x16x32_bf16 v[196:199], v[36:39], v[64:67], v[196:199]
    ds_read_b128 v[108:111], v16 offset:5120
    v_mfma_f32_16x16x32_bf16 v[200:203], v[40:43], v[64:67], v[200:203]
    s_add_u32 s30, s30, 229376
    v_mfma_f32_16x16x32_bf16 v[204:207], v[44:47], v[64:67], v[204:207]
    ds_read_b128 v[112:115], v16 offset:8192
    v_mfma_f32_16x16x32_bf16 v[208:211], v[32:35], v[68:71], v[208:211]
    ds_read_b128 v[116:119], v16 offset:9216
    v_mfma_f32_16x16x32_bf16 v[212:215], v[36:39], v[68:71], v[212:215]
    ds_read_b128 v[120:123], v16 offset:12288
    v_mfma_f32_16x16x32_bf16 v[216:219], v[40:43], v[68:71], v[216:219]
    ds_read_b128 v[124:127], v16 offset:13312
    v_mfma_f32_16x16x32_bf16 v[220:223], v[44:47], v[68:71], v[220:223]
    v_mfma_f32_16x16x32_bf16 v[224:227], v[32:35], v[72:75], v[224:227]
    s_add_u32 s31, s28, s32
    v_mfma_f32_16x16x32_bf16 v[228:231], v[36:39], v[72:75], v[228:231]
    s_add_u32 s32, s32, 32768
    v_mfma_f32_16x16x32_bf16 v[232:235], v[40:43], v[72:75], v[232:235]
    s_cmp_ge_u32 s32, 131072
    v_mfma_f32_16x16x32_bf16 v[236:239], v[44:47], v[72:75], v[236:239]
    s_cselect_b32 s32, 0, s32
    v_mfma_f32_16x16x32_bf16 v[240:243], v[32:35], v[76:79], v[240:243]
    v_add_u32 v16, s32, v6
    v_mfma_f32_16x16x32_bf16 v[244:247], v[36:39], v[76:79], v[244:247]
    v_add_u32 v17, s32, v24
    v_mfma_f32_16x16x32_bf16 v[248:251], v[40:43], v[76:79], v[248:251]
    v_add_u32 v18, s32, v25
    v_mfma_f32_16x16x32_bf16 v[252:255], v[44:47], v[76:79], v[252:255]
    s_cmp_lg_u32 s33, s34
    s_cbranch_scc1 L_g1_nopf
    buffer_load_dword v19, v20, s[12:15], s35 offen
L_g1_nopf:
    s_waitcnt vmcnt(8) lgkmcnt(0)
    s_barrier
    v_mfma_f32_16x16x32_bf16 v[128:131], v[80:83], v[96:99], v[128:131]
    s_mov_b32 m0, s31
    v_mfma_f32_16x16x32_bf16 v[132:135], v[84:87], v[96:99], v[132:135]
    ds_read_b64_tr_b16 v[32:33], v17 offset:0
    v_mfma_f32_16x16x32_bf16 v[136:139], v[88:91], v[96:99], v[136:139]
    ds_read_b64_tr_b16 v[34:35], v17 offset:4096
    v_mfma_f32_16x16x32_bf16 v[140:143], v[92:95], v[96:99], v[140:143]
    buffer_load_dwordx4 v4, s[4:7], s29 offen sc1 lds
    v_mfma_f32_16x16x32_bf16 v[144:147], v[80:83], v[100:103], v[144:147]
    ds_read_b128 v[48:51], v16 offset:0
    v_mfma_f32_16x16x32_bf16 v[148:151], v[84:87], v[100:103], v[148:151]
    ds_read_b64_tr_b16 v[36:37], v17 offset:1024
    v_mfma_f32_16x16x32_bf16 v[152:155], v[88:91], v[100:103], v[152:155]
    buffer_load_dwordx4 v4, s[4:7], s29 offen offset:1024 sc1 lds
    v_mfma_f32_16x16x32_bf16 v[156:159], v[92:95], v[100:103], v[156:159]
    ds_read_b64_tr_b16 v[38:39], v17 offset:5120
    v_mfma_f32_16x16x32_bf16 v[160:163], v[80:83], v[104:107], v[160:163]
    ds_read_b64_tr_b16 v[40:41], v18 offset:0
    v_mfma_f32_16x16x32_bf16 v[164:167], v[84:87], v[104:107], v[164:167]
    buffer_load_dwordx4 v5, s[36:39], s30 offen offset:2048 lds
    v_mfma_f32_16x16x32_bf16 v[168:171], v[88:91], v[104:107], v[168:171]
    ds_read_b64_tr_b16 v[42:43], v18 offset:4096
    v_mfma_f32_16x16x32_bf16 v[172:175], v[92:95], v[104:107], v[172:175]
    ds_read_b64_tr_b16 v[44:45], v18 offset:1024
    v_mfma_f32_16x16x32_bf16 v[176:179], v[80:83], v[108:111], v[176:179]
    buffer_load_dwordx4 v5, s[40:43], s30 offen offset:3072 lds
    v_mfma_f32_16x16x32_bf16 v[180:183], v[84:87], v[108:111], v[180:183]
    ds_read_b64_tr_b16 v[46:47], v18 offset:5120
    v_mfma_f32_16x16x32_bf16 v[184:187], v[88:91], v[108:111], v[184:187]
    ds_read_b128 v[52:55], v16 offset:1024
    v_mfma_f32_16x16x32_bf16 v[188:191], v[92:95], v[108:111], v[188:191]
    s_add_u32 s29, s29, 16384
    v_mfma_f32_16x16x32_bf16 v[192:195], v[80:83], v[112:115], v[192:195]
    ds_read_b128 v[56:59], v16 offset:4096
    v_mfma_f32_16x16x32_bf16 v[196:199], v[84:87], v[112:115], v[196:199]
    ds_read_b128 v[60:63], v16 offset:5120
    v_mfma_f32_16x16x32_bf16 v[200:203], v[88:91], v[112:115], v[200:203]
    s_add_u32 s30, s30, 229376
    v_mfma_f32_16x16x32_bf16 v[204:207], v[92:95], v[112:115], v[204:207]
    ds_read_b128 v[64:67], v16 offset:8192
    v_mfma_f32_16x16x32_bf16 v[208:211], v[80:83], v[116:119], v[208:211]
    ds_read_b128 v[68:71], v16 offset:9216
    v_mfma_f32_16x16x32_bf16 v[212:215], v[84:87], v[116:119], v[212:215]
    ds_read_b128 v[72:75], v16 offset:12288
    v_mfma_f32_16x16x32_bf16 v[216:219], v[88:91], v[116:119], v[216:219]
    ds_read_b128 v[76:79], v16 offset:13312
    v_mfma_f32_16x16x32_bf16 v[220:223], v[92:95], v[116:119], v[220:223]
    v_mfma_f32_16x16x32_bf16 v[224:227], v[80:83], v[120:123], v[224:227]
    s_add_u32 s31, s28, s32
    s_add_u32 s32, s32, 32768
    v_mfma_f32_16x16x32_bf16 v[228:231], v[84:87], v[120:123], v[228:231]
    s_cmp_ge_u32 s32, 131072
    v_mfma_f32_16x16x32_bf16 v[232:235], v[88:91], v[120:123], v[232:235]
    s_cselect_b32 s32, 0, s32
    v_mfma_f32_16x16x32_bf16 v[236:239], v[92:95], v[120:123], v[236:239]
    v_add_u32 v16, s32, v6
    v_add_u32 v17, s32, v24
    v_mfma_f32_16x16x32_bf16 v[240:243], v[80:83], v[124:127], v[240:243]
    v_add_u32 v18, s32, v25
    v_mfma_f32_16x16x32_bf16 v[244:247], v[84:87], v[124:127], v[244:247]
    s_add_u32 s33, s33, 2
    v_mfma_f32_16x16x32_bf16 v[248:251], v[88:91], v[124:127], v[248:251]
    s_cmp_lt_u32 s33, 28
    v_mfma_f32_16x16x32_bf16 v[252:255], v[92:95], v[124:127], v[252:255]
    s_cbranch_scc1 L_g1_loop
    s_waitcnt vmcnt(8) lgkmcnt(0)
    s_barrier
    v_mfma_f32_16x16x32_bf16 v[128:131], v[32:35], v[48:51], v[128:131]
    s_add_u32 m0, s46, 0
    v_mfma_f32_16x16x32_bf16 v[132:135], v[36:39], v[48:51], v[132:135]
    ds_read_b64_tr_b16 v[80:81], v17 offset:0
    v_mfma_f32_16x16x32_bf16 v[136:139], v[40:43], v[48:51], v[136:139]
    ds_read_b64_tr_b16 v[82:83], v17 offset:4096
    v_mfma_f32_16x16x32_bf16 v[140:143], v[44:47], v[48:51], v[140:143]
    buffer_load_dwordx4 v14, s[8:11], s47 offen lds
    s_add_u32 s47, s47, 131072
    v_mfma_f32_16x16x32_bf16 v[144:147], v[32:35], v[52:55], v[144:147]
    ds_read_b128 v[96:99], v16 offset:0
    v_mfma_f32_16x16x32_bf16 v[148:151], v[36:39], v[52:55], v[148:151]
    ds_read_b64_tr_b16 v[84:85], v17 offset:1024
    v_mfma_f32_16x16x32_bf16 v[152:155], v[40:43], v[52:55], v[152:155]
    s_add_u32 m0, s46, 8192
    v_mfma_f32_16x16x32_bf16 v[156:159], v[44:47], v[52:55], v[156:159]
    ds_read_b64_tr_b16 v[86:87], v17 offset:5120
    v_mfma_f32_16x16x32_bf16 v[160:163], v[32:35], v[56:59], v[160:163]
    ds_read_b64_tr_b16 v[88:89], v18 offset:0
    v_mfma_f32_16x16x32_bf16 v[164:167], v[36:39], v[56:59], v[164:167]
    buffer_load_dwordx4 v14, s[8:11], s47 offen lds
    s_add_u32 s47, s47, 131072
    v_mfma_f32_16x16x32_bf16 v[168:171], v[40:43], v[56:59], v[168:171]
    ds_read_b64_tr_b16 v[90:91], v18 offset:4096
    v_mfma_f32_16x16x32_bf16 v[172:175], v[44:47], v[56:59], v[172:175]
    ds_read_b64_tr_b16 v[92:93], v18 offset:1024
    v_mfma_f32_16x16x32_bf16 v[176:179], v[32:35], v[60:63], v[176:179]
    s_add_u32 m0, s46, 16384
    v_mfma_f32_16x16x32_bf16 v[180:183], v[36:39], v[60:63], v[180:183]
    ds_read_b64_tr_b16 v[94:95], v18 offset:5120
    v_mfma_f32_16x16x32_bf16 v[184:187], v[40:43], v[60:63], v[184:187]
    ds_read_b128 v[100:103], v16 offset:1024
    v_mfma_f32_16x16x32_bf16 v[188:191], v[44:47], v[60:63], v[188:191]
    buffer_load_dwordx4 v14, s[8:11], s47 offen lds
    s_add_u32 s47, s47, 131072
    v_mfma_f32_16x16x32_bf16 v[192:195], v[32:35], v[64:67], v[192:195]
    ds_read_b128 v[104:107], v16 offset:4096
    v_mfma_f32_16x16x32_bf16 v[196:199], v[36:39], v[64:67], v[196:199]
    ds_read_b128 v[108:111], v16 offset:5120
    v_mfma_f32_16x16x32_bf16 v[200:203], v[40:43], v[64:67], v[200:203]
    s_add_u32 m0, s46, 24576
    v_mfma_f32_16x16x32_bf16 v[204:207], v[44:47], v[64:67], v[204:207]
    ds_read_b128 v[112:115], v16 offset:8192
    v_mfma_f32_16x16x32_bf16 v[208:211], v[32:35], v[68:71], v[208:211]
    ds_read_b128 v[116:119], v16 offset:9216
    v_mfma_f32_16x16x32_bf16 v[212:215], v[36:39], v[68:71], v[212:215]
    buffer_load_dwordx4 v14, s[8:11], s47 offen lds
    s_add_u32 s47, s47, 131072
    v_mfma_f32_16x16x32_bf16 v[216:219], v[40:43], v[68:71], v[216:219]
    ds_read_b128 v[120:123], v16 offset:12288
    v_mfma_f32_16x16x32_bf16 v[220:223], v[44:47], v[68:71], v[220:223]
    ds_read_b128 v[124:127], v16 offset:13312
    v_mfma_f32_16x16x32_bf16 v[224:227], v[32:35], v[72:75], v[224:227]
    s_add_u32 s31, s28, s32
    v_mfma_f32_16x16x32_bf16 v[228:231], v[36:39], v[72:75], v[228:231]
    s_add_u32 s32, s32, 32768
    v_mfma_f32_16x16x32_bf16 v[232:235], v[40:43], v[72:75], v[232:235]
    s_cmp_ge_u32 s32, 131072
    v_mfma_f32_16x16x32_bf16 v[236:239], v[44:47], v[72:75], v[236:239]
    s_cselect_b32 s32, 0, s32
    v_mfma_f32_16x16x32_bf16 v[240:243], v[32:35], v[76:79], v[240:243]
    v_add_u32 v16, s32, v6
    v_mfma_f32_16x16x32_bf16 v[244:247], v[36:39], v[76:79], v[244:247]
    v_add_u32 v17, s32, v24
    v_mfma_f32_16x16x32_bf16 v[248:251], v[40:43], v[76:79], v[248:251]
    v_add_u32 v18, s32, v25
    v_mfma_f32_16x16x32_bf16 v[252:255], v[44:47], v[76:79], v[252:255]
    s_waitcnt vmcnt(8) lgkmcnt(0)
    s_barrier
    v_mfma_f32_16x16x32_bf16 v[128:131], v[80:83], v[96:99], v[128:131]
    s_add_u32 m0, s46, 32768
    v_mfma_f32_16x16x32_bf16 v[132:135], v[84:87], v[96:99], v[132:135]
    ds_read_b64_tr_b16 v[32:33], v17 offset:0
    v_mfma_f32_16x16x32_bf16 v[136:139], v[88:91], v[96:99], v[136:139]
    ds_read_b64_tr_b16 v[34:35], v17 offset:4096
    v_mfma_f32_16x16x32_bf16 v[140:143], v[92:95], v[96:99], v[140:143]
    buffer_load_dwordx4 v14, s[8:11], s47 offen lds
    s_add_u32 s47, s47, 131072
    v_mfma_f32_16x16x32_bf16 v[144:147], v[80:83], v[100:103], v[144:147]
    ds_read_b128 v[48:51], v16 offset:0
    v_mfma_f32_16x16x32_bf16 v[148:151], v[84:87], v[100:103], v[148:151]
    ds_read_b64_tr_b16 v[36:37], v17 offset:1024
    v_mfma_f32_16x16x32_bf16 v[152:155], v[88:91], v[100:103], v[152:155]
    s_add_u32 m0, s46, 40960
    v_mfma_f32_16x16x32_bf16 v[156:159], v[92:95], v[100:103], v[156:159]
    ds_read_b64_tr_b16 v[38:39], v17 offset:5120
    v_mfma_f32_16x16x32_bf16 v[160:163], v[80:83], v[104:107], v[160:163]
    ds_read_b64_tr_b16 v[40:41], v18 offset:0
    v_mfma_f32_16x16x32_bf16 v[164:167], v[84:87], v[104:107], v[164:167]
    buffer_load_dwordx4 v14, s[8:11], s47 offen lds
    s_add_u32 s47, s47, 131072
    v_mfma_f32_16x16x32_bf16 v[168:171], v[88:91], v[104:107], v[168:171]
    ds_read_b64_tr_b16 v[42:43], v18 offset:4096
    v_mfma_f32_16x16x32_bf16 v[172:175], v[92:95], v[104:107], v[172:175]
    ds_read_b64_tr_b16 v[44:45], v18 offset:1024
    v_mfma_f32_16x16x32_bf16 v[176:179], v[80:83], v[108:111], v[176:179]
    s_add_u32 m0, s46, 49152
    v_mfma_f32_16x16x32_bf16 v[180:183], v[84:87], v[108:111], v[180:183]
    ds_read_b64_tr_b16 v[46:47], v18 offset:5120
    v_mfma_f32_16x16x32_bf16 v[184:187], v[88:91], v[108:111], v[184:187]
    ds_read_b128 v[52:55], v16 offset:1024
    v_mfma_f32_16x16x32_bf16 v[188:191], v[92:95], v[108:111], v[188:191]
    buffer_load_dwordx4 v14, s[8:11], s47 offen lds
    s_add_u32 s47, s47, 131072
    v_mfma_f32_16x16x32_bf16 v[192:195], v[80:83], v[112:115], v[192:195]
    ds_read_b128 v[56:59], v16 offset:4096
    v_mfma_f32_16x16x32_bf16 v[196:199], v[84:87], v[112:115], v[196:199]
    ds_read_b128 v[60:63], v16 offset:5120
    v_mfma_f32_16x16x32_bf16 v[200:203], v[88:91], v[112:115], v[200:203]
    s_add_u32 m0, s46, 57344
    v_mfma_f32_16x16x32_bf16 v[204:207], v[92:95], v[112:115], v[204:207]
    ds_read_b128 v[64:67], v16 offset:8192
    v_mfma_f32_16x16x32_bf16 v[208:211], v[80:83], v[116:119], v[208:211]
    ds_read_b128 v[68:71], v16 offset:9216
    v_mfma_f32_16x16x32_bf16 v[212:215], v[84:87], v[116:119], v[212:215]
    buffer_load_dwordx4 v14, s[8:11], s47 offen lds
    s_add_u32 s47, s47, 131072
    v_mfma_f32_16x16x32_bf16 v[216:219], v[88:91], v[116:119], v[216:219]
    ds_read_b128 v[72:75], v16 offset:12288
    v_mfma_f32_16x16x32_bf16 v[220:223], v[92:95], v[116:119], v[220:223]
    ds_read_b128 v[76:79], v16 offset:13312
    v_mfma_f32_16x16x32_bf16 v[224:227], v[80:83], v[120:123], v[224:227]
    s_add_u32 s31, s28, s32
    v_mfma_f32_16x16x32_bf16 v[228:231], v[84:87], v[120:123], v[228:231]
    s_add_u32 s32, s32, 32768
    v_mfma_f32_16x16x32_bf16 v[232:235], v[88:91], v[120:123], v[232:235]
    s_cmp_ge_u32 s32, 131072
    v_mfma_f32_16x16x32_bf16 v[236:239], v[92:95], v[120:123], v[236:239]
    s_cselect_b32 s32, 0, s32
    v_mfma_f32_16x16x32_bf16 v[240:243], v[80:83], v[124:127], v[240:243]
    v_add_u32 v16, s32, v6
    v_mfma_f32_16x16x32_bf16 v[244:247], v[84:87], v[124:127], v[244:247]
    v_add_u32 v17, s32, v24
    v_mfma_f32_16x16x32_bf16 v[248:251], v[88:91], v[124:127], v[248:251]
    v_add_u32 v18, s32, v25
    v_mfma_f32_16x16x32_bf16 v[252:255], v[92:95], v[124:127], v[252:255]
    s_waitcnt vmcnt(8) lgkmcnt(0)
    s_barrier
    v_mfma_f32_16x16x32_bf16 v[128:131], v[32:35], v[48:51], v[128:131]
    s_add_u32 m0, s46, 65536
    ds_read_b64_tr_b16 v[80:81], v17 offset:0
    v_mfma_f32_16x16x32_bf16 v[132:135], v[36:39], v[48:51], v[132:135]
    ds_read_b64_tr_b16 v[82:83], v17 offset:4096
    v_mfma_f32_16x16x32_bf16 v[136:139], v[40:43], v[48:51], v[136:139]
    buffer_load_dwordx4 v14, s[8:11], s47 offen lds
    s_add_u32 s47, s47, 131072
    v_mfma_f32_16x16x32_bf16 v[140:143], v[44:47], v[48:51], v[140:143]
    ds_read_b128 v[96:99], v16 offset:0
    v_mfma_f32_16x16x32_bf16 v[144:147], v[32:35], v[52:55], v[144:147]
    ds_read_b64_tr_b16 v[84:85], v17 offset:1024
    v_mfma_f32_16x16x32_bf16 v[148:151], v[36:39], v[52:55], v[148:151]
    s_add_u32 m0, s46, 73728
    v_mfma_f32_16x16x32_bf16 v[152:155], v[40:43], v[52:55], v[152:155]
    ds_read_b64_tr_b16 v[86:87], v17 offset:5120
    v_mfma_f32_16x16x32_bf16 v[156:159], v[44:47], v[52:55], v[156:159]
    ds_read_b64_tr_b16 v[88:89], v18 offset:0
    v_mfma_f32_16x16x32_bf16 v[160:163], v[32:35], v[56:59], v[160:163]
    buffer_load_dwordx4 v14, s[8:11], s47 offen lds
    s_add_u32 s47, s47, 131072
    v_mfma_f32_16x16x32_bf16 v[164:167], v[36:39], v[56:59], v[164:167]
    ds_read_b64_tr_b16 v[90:91], v18 offset:4096
    v_mfma_f32_16x16x32_bf16 v[168:171], v[40:43], v[56:59], v[168:171]
    ds_read_b64_tr_b16 v[92:93], v18 offset:1024
    v_mfma_f32_16x16x32_bf16 v[172:175], v[44:47], v[56:59], v[172:175]
    s_add_u32 m0, s46, 81920
    v_mfma_f32_16x16x32_bf16 v[176:179], v[32:35], v[60:63], v[176:179]
    ds_read_b64_tr_b16 v[94:95], v18 offset:5120
    ds_read_b128 v[100:103], v16 offset:1024
    v_mfma_f32_16x16x32_bf16 v[180:183], v[36:39], v[60:63], v[180:183]
    buffer_load_dwordx4 v14, s[8:11], s47 offen lds
    s_add_u32 s47, s47, 131072
    v_mfma_f32_16x16x32_bf16 v[184:187], v[40:43], v[60:63], v[184:187]
    ds_read_b128 v[104:107], v16 offset:4096
    v_mfma_f32_16x16x32_bf16 v[188:191], v[44:47], v[60:63], v[188:191]
    ds_read_b128 v[108:111], v16 offset:5120
    v_mfma_f32_16x16x32_bf16 v[192:195], v[32:35], v[64:67], v[192:195]
    s_add_u32 m0, s46, 90112
    v_mfma_f32_16x16x32_bf16 v[196:199], v[36:39], v[64:67], v[196:199]
    ds_read_b128 v[112:115], v16 offset:8192
    v_mfma_f32_16x16x32_bf16 v[200:203], v[40:43], v[64:67], v[200:203]
    ds_read_b128 v[116:119], v16 offset:9216
    v_mfma_f32_16x16x32_bf16 v[204:207], v[44:47], v[64:67], v[204:207]
    buffer_load_dwordx4 v14, s[8:11], s47 offen lds
    s_add_u32 s47, s47, 131072
    v_mfma_f32_16x16x32_bf16 v[208:211], v[32:35], v[68:71], v[208:211]
    ds_read_b128 v[120:123], v16 offset:12288
    v_mfma_f32_16x16x32_bf16 v[212:215], v[36:39], v[68:71], v[212:215]
    ds_read_b128 v[124:127], v16 offset:13312
    v_mfma_f32_16x16x32_bf16 v[216:219], v[40:43], v[68:71], v[216:219]
    v_mov_b32 v12, 6144
    v_mfma_f32_16x16x32_bf16 v[220:223], v[44:47], v[68:71], v[220:223]
    buffer_load_dword v13, v12, s[48:51], 0 offen sc1
    v_mfma_f32_16x16x32_bf16 v[224:227], v[32:35], v[72:75], v[224:227]
    s_add_u32 s31, s28, s32
    v_mfma_f32_16x16x32_bf16 v[228:231], v[36:39], v[72:75], v[228:231]
    s_add_u32 s32, s32, 32768
    v_mfma_f32_16x16x32_bf16 v[232:235], v[40:43], v[72:75], v[232:235]
    s_cmp_ge_u32 s32, 131072
    v_mfma_f32_16x16x32_bf16 v[236:239], v[44:47], v[72:75], v[236:239]
    s_cselect_b32 s32, 0, s32
    v_mfma_f32_16x16x32_bf16 v[240:243], v[32:35], v[76:79], v[240:243]
    v_add_u32 v16, s32, v6
    v_mfma_f32_16x16x32_bf16 v[244:247], v[36:39], v[76:79], v[244:247]
    v_add_u32 v17, s32, v24
    v_mfma_f32_16x16x32_bf16 v[248:251], v[40:43], v[76:79], v[248:251]
    v_add_u32 v18, s32, v25
    v_mfma_f32_16x16x32_bf16 v[252:255], v[44:47], v[76:79], v[252:255]
    s_waitcnt lgkmcnt(0)
    s_barrier
    v_mfma_f32_16x16x32_bf16 v[128:131], v[80:83], v[96:99], v[128:131]
    s_add_u32 m0, s46, 98304
    v_mfma_f32_16x16x32_bf16 v[132:135], v[84:87], v[96:99], v[132:135]
    v_mfma_f32_16x16x32_bf16 v[136:139], v[88:91], v[96:99], v[136:139]
    buffer_load_dwordx4 v14, s[8:11], s47 offen lds
    s_add_u32 s47, s47, 131072
    v_mfma_f32_16x16x32_bf16 v[140:143], v[92:95], v[96:99], v[140:143]
    v_mfma_f32_16x16x32_bf16 v[144:147], v[80:83], v[100:103], v[144:147]
    s_add_u32 m0, s46, 106496
    v_mfma_f32_16x16x32_bf16 v[148:151], v[84:87], v[100:103], v[148:151]
    v_mfma_f32_16x16x32_bf16 v[152:155], v[88:91], v[100:103], v[152:155]
    buffer_load_dwordx4 v14, s[8:11], s47 offen lds
    s_add_u32 s47, s47, 131072
    v_mfma_f32_16x16x32_bf16 v[156:159], v[92:95], v[100:103], v[156:159]
    v_mfma_f32_16x16x32_bf16 v[160:163], v[80:83], v[104:107], v[160:163]
    s_add_u32 m0, s46, 114688
    v_mfma_f32_16x16x32_bf16 v[164:167], v[84:87], v[104:107], v[164:167]
    v_mfma_f32_16x16x32_bf16 v[168:171], v[88:91], v[104:107], v[168:171]
    buffer_load_dwordx4 v14, s[8:11], s47 offen lds
    s_add_u32 s47, s47, 131072
    v_mfma_f32_16x16x32_bf16 v[172:175], v[92:95], v[104:107], v[172:175]
    v_mfma_f32_16x16x32_bf16 v[176:179], v[80:83], v[108:111], v[176:179]
    s_add_u32 m0, s46, 122880
    v_mfma_f32_16x16x32_bf16 v[180:183], v[84:87], v[108:111], v[180:183]
    v_mfma_f32_16x16x32_bf16 v[184:187], v[88:91], v[108:111], v[184:187]
    buffer_load_dwordx4 v14, s[8:11], s47 offen lds
    s_add_u32 s47, s47, 131072
    v_mfma_f32_16x16x32_bf16 v[188:191], v[92:95], v[108:111], v[188:191]
    v_mfma_f32_16x16x32_bf16 v[192:195], v[80:83], v[112:115], v[192:195]
    v_mfma_f32_16x16x32_bf16 v[196:199], v[84:87], v[112:115], v[196:199]
    v_mfma_f32_16x16x32_bf16 v[200:203], v[88:91], v[112:115], v[200:203]
    v_mfma_f32_16x16x32_bf16 v[204:207], v[92:95], v[112:115], v[204:207]
    v_mfma_f32_16x16x32_bf16 v[208:211], v[80:83], v[116:119], v[208:211]
    v_mfma_f32_16x16x32_bf16 v[212:215], v[84:87], v[116:119], v[212:215]
    v_mfma_f32_16x16x32_bf16 v[216:219], v[88:91], v[116:119], v[216:219]
    v_mfma_f32_16x16x32_bf16 v[220:223], v[92:95], v[116:119], v[220:223]
    v_mfma_f32_16x16x32_bf16 v[224:227], v[80:83], v[120:123], v[224:227]
    v_mfma_f32_16x16x32_bf16 v[228:231], v[84:87], v[120:123], v[228:231]
    v_mfma_f32_16x16x32_bf16 v[232:235], v[88:91], v[120:123], v[232:235]
    v_mfma_f32_16x16x32_bf16 v[236:239], v[92:95], v[120:123], v[236:239]
    v_mfma_f32_16x16x32_bf16 v[240:243], v[80:83], v[124:127], v[240:243]
    v_mfma_f32_16x16x32_bf16 v[244:247], v[84:87], v[124:127], v[244:247]
    v_mfma_f32_16x16x32_bf16 v[248:251], v[88:91], v[124:127], v[248:251]
    v_mfma_f32_16x16x32_bf16 v[252:255], v[92:95], v[124:127], v[252:255]
    v_mov_b32 v26, 0xc0135761
    v_mov_b32 v28, 0xbdd2d3e8
    v_mov_b32 v30, 1.0
    v_mov_b32 v27, 0xc0135761
    v_mov_b32 v29, 0xbdd2d3e8
    v_mov_b32 v31, 1.0
    s_lshl_b32 s26, s23, 1
    s_and_b32 s25, s20, 1
    s_add_u32 s26, s26, s25
    s_mul_i32 s26, s26, 224
    s_lshl_b32 s25, s24, 3
    s_add_u32 s26, s26, s25
    s_and_b32 s25, s20, 6
    s_add_u32 s26, s26, s25
    s_lshl_b32 s26, s26, 12
    v_and_b32 v11, 15, v2
    v_bfe_u32 v9, v2, 4, 1
    v_lshl_add_u32 v11, v9, 5, v11
    v_lshlrev_b32 v11, 4, v11
    v_lshrrev_b32 v9, 5, v2
    v_lshl_add_u32 v11, v9, 12, v11
    v_and_b32 v9, 24, v2
    v_cmp_eq_u32 vcc, 8, v9
    v_add_u32 v9, 0, v11
    s_nop 0
    v_cndmask_b32 v10, v11, v9, vcc
    v_pk_mul_f32 v[32:33], v[128:129], v[128:129]
    v_pk_mul_f32 v[34:35], v[130:131], v[130:131]
    v_pk_mul_f32 v[36:37], v[136:137], v[136:137]
    v_pk_mul_f32 v[38:39], v[138:139], v[138:139]
    v_pk_fma_f32 v[32:33], v[32:33], v[28:29], v[26:27]
    v_pk_fma_f32 v[34:35], v[34:35], v[28:29], v[26:27]
    v_pk_fma_f32 v[36:37], v[36:37], v[28:29], v[26:27]
    v_pk_fma_f32 v[38:39], v[38:39], v[28:29], v[26:27]
    v_pk_mul_f32 v[32:33], v[32:33], v[128:129]
    v_pk_mul_f32 v[34:35], v[34:35], v[130:131]
    v_pk_mul_f32 v[36:37], v[36:37], v[136:137]
    v_pk_mul_f32 v[38:39], v[38:39], v[138:139]
    v_exp_f32 v32, v32
    v_exp_f32 v33, v33
    v_exp_f32 v34, v34
    v_exp_f32 v35, v35
    v_exp_f32 v36, v36
    v_exp_f32 v37, v37
    v_exp_f32 v38, v38
    v_exp_f32 v39, v39
    v_pk_mul_f32 v[132:133], v[132:133], v[128:129]
    v_pk_mul_f32 v[134:135], v[134:135], v[130:131]
    v_pk_mul_f32 v[140:141], v[140:141], v[136:137]
    v_pk_mul_f32 v[142:143], v[142:143], v[138:139]
    v_pk_add_f32 v[32:33], v[32:33], v[30:31]
    v_pk_add_f32 v[34:35], v[34:35], v[30:31]
    v_pk_add_f32 v[36:37], v[36:37], v[30:31]
    v_pk_add_f32 v[38:39], v[38:39], v[30:31]
    v_rcp_f32 v32, v32
    v_rcp_f32 v33, v33
    v_rcp_f32 v34, v34
    v_rcp_f32 v35, v35
    v_rcp_f32 v36, v36
    v_rcp_f32 v37, v37
    v_rcp_f32 v38, v38
    v_rcp_f32 v39, v39
    s_nop 0
    v_pk_mul_f32 v[32:33], v[32:33], v[132:133]
    v_pk_mul_f32 v[34:35], v[34:35], v[134:135]
    v_pk_mul_f32 v[36:37], v[36:37], v[140:141]
    v_pk_mul_f32 v[38:39], v[38:39], v[142:143]
    v_cvt_pk_bf16_f32 v40, v32, v33
    v_cvt_pk_bf16_f32 v41, v34, v35
    v_cvt_pk_bf16_f32 v42, v36, v37
    v_cvt_pk_bf16_f32 v43, v38, v39
    buffer_store_dwordx4 v[40:43], v11, s[16:19], s26 offen offset:0 sc1
    v_pk_mul_f32 v[44:45], v[144:145], v[144:145]
    v_pk_mul_f32 v[46:47], v[146:147], v[146:147]
    v_pk_mul_f32 v[48:49], v[152:153], v[152:153]
    v_pk_mul_f32 v[50:51], v[154:155], v[154:155]
    v_pk_fma_f32 v[44:45], v[44:45], v[28:29], v[26:27]
    v_pk_fma_f32 v[46:47], v[46:47], v[28:29], v[26:27]
    v_pk_fma_f32 v[48:49], v[48:49], v[28:29], v[26:27]
    v_pk_fma_f32 v[50:51], v[50:51], v[28:29], v[26:27]
    v_pk_mul_f32 v[44:45], v[44:45], v[144:145]
    v_pk_mul_f32 v[46:47], v[46:47], v[146:147]
    v_pk_mul_f32 v[48:49], v[48:49], v[152:153]
    v_pk_mul_f32 v[50:51], v[50:51], v[154:155]
    v_exp_f32 v44, v44
    v_exp_f32 v45, v45
    v_exp_f32 v46, v46
    v_exp_f32 v47, v47
    v_exp_f32 v48, v48
    v_exp_f32 v49, v49
    v_exp_f32 v50, v50
    v_exp_f32 v51, v51
    v_pk_mul_f32 v[148:149], v[148:149], v[144:145]
    v_pk_mul_f32 v[150:151], v[150:151], v[146:147]
    v_pk_mul_f32 v[156:157], v[156:157], v[152:153]
    v_pk_mul_f32 v[158:159], v[158:159], v[154:155]
    v_pk_add_f32 v[44:45], v[44:45], v[30:31]
    v_pk_add_f32 v[46:47], v[46:47], v[30:31]
    v_pk_add_f32 v[48:49], v[48:49], v[30:31]
    v_pk_add_f32 v[50:51], v[50:51], v[30:31]
    v_rcp_f32 v44, v44
    v_rcp_f32 v45, v45
    v_rcp_f32 v46, v46
    v_rcp_f32 v47, v47
    v_rcp_f32 v48, v48
    v_rcp_f32 v49, v49
    v_rcp_f32 v50, v50
    v_rcp_f32 v51, v51
    s_nop 0
    v_pk_mul_f32 v[44:45], v[44:45], v[148:149]
    v_pk_mul_f32 v[46:47], v[46:47], v[150:151]
    v_pk_mul_f32 v[48:49], v[48:49], v[156:157]
    v_pk_mul_f32 v[50:51], v[50:51], v[158:159]
    v_cvt_pk_bf16_f32 v52, v44, v45
    v_cvt_pk_bf16_f32 v53, v46, v47
    v_cvt_pk_bf16_f32 v54, v48, v49
    v_cvt_pk_bf16_f32 v55, v50, v51
    buffer_store_dwordx4 v[52:55], v10, s[16:19], s26 offen offset:256 sc1
    v_pk_mul_f32 v[56:57], v[160:161], v[160:161]
    v_pk_mul_f32 v[58:59], v[162:163], v[162:163]
    v_pk_mul_f32 v[60:61], v[168:169], v[168:169]
    v_pk_mul_f32 v[62:63], v[170:171], v[170:171]
    v_pk_fma_f32 v[56:57], v[56:57], v[28:29], v[26:27]
    v_pk_fma_f32 v[58:59], v[58:59], v[28:29], v[26:27]
    v_pk_fma_f32 v[60:61], v[60:61], v[28:29], v[26:27]
    v_pk_fma_f32 v[62:63], v[62:63], v[28:29], v[26:27]
    v_pk_mul_f32 v[56:57], v[56:57], v[160:161]
    v_pk_mul_f32 v[58:59], v[58:59], v[162:163]
    v_pk_mul_f32 v[60:61], v[60:61], v[168:169]
    v_pk_mul_f32 v[62:63], v[62:63], v[170:171]
    v_exp_f32 v56, v56
    v_exp_f32 v57, v57
    v_exp_f32 v58, v58
    v_exp_f32 v59, v59
    v_exp_f32 v60, v60
    v_exp_f32 v61, v61
    v_exp_f32 v62, v62
    v_exp_f32 v63, v63
    v_pk_mul_f32 v[164:165], v[164:165], v[160:161]
    v_pk_mul_f32 v[166:167], v[166:167], v[162:163]
    v_pk_mul_f32 v[172:173], v[172:173], v[168:169]
    v_pk_mul_f32 v[174:175], v[174:175], v[170:171]
    v_pk_add_f32 v[56:57], v[56:57], v[30:31]
    v_pk_add_f32 v[58:59], v[58:59], v[30:31]
    v_pk_add_f32 v[60:61], v[60:61], v[30:31]
    v_pk_add_f32 v[62:63], v[62:63], v[30:31]
    v_rcp_f32 v56, v56
    v_rcp_f32 v57, v57
    v_rcp_f32 v58, v58
    v_rcp_f32 v59, v59
    v_rcp_f32 v60, v60
    v_rcp_f32 v61, v61
    v_rcp_f32 v62, v62
    v_rcp_f32 v63, v63
    s_nop 0
    v_pk_mul_f32 v[56:57], v[56:57], v[164:165]
    v_pk_mul_f32 v[58:59], v[58:59], v[166:167]
    v_pk_mul_f32 v[60:61], v[60:61], v[172:173]
    v_pk_mul_f32 v[62:63], v[62:63], v[174:175]
    v_cvt_pk_bf16_f32 v64, v56, v57
    v_cvt_pk_bf16_f32 v65, v58, v59
    v_cvt_pk_bf16_f32 v66, v60, v61
    v_cvt_pk_bf16_f32 v67, v62, v63
    buffer_store_dwordx4 v[64:67], v11, s[16:19], s26 offen offset:1024 sc1
    v_pk_mul_f32 v[32:33], v[176:177], v[176:177]
    v_pk_mul_f32 v[34:35], v[178:179], v[178:179]
    v_pk_mul_f32 v[36:37], v[184:185], v[184:185]
    v_pk_mul_f32 v[38:39], v[186:187], v[186:187]
    v_pk_fma_f32 v[32:33], v[32:33], v[28:29], v[26:27]
    v_pk_fma_f32 v[34:35], v[34:35], v[28:29], v[26:27]
    v_pk_fma_f32 v[36:37], v[36:37], v[28:29], v[26:27]
    v_pk_fma_f32 v[38:39], v[38:39], v[28:29], v[26:27]
    v_pk_mul_f32 v[32:33], v[32:33], v[176:177]
    v_pk_mul_f32 v[34:35], v[34:35], v[178:179]
    v_pk_mul_f32 v[36:37], v[36:37], v[184:185]
    v_pk_mul_f32 v[38:39], v[38:39], v[186:187]
    v_exp_f32 v32, v32
    v_exp_f32 v33, v33
    v_exp_f32 v34, v34
    v_exp_f32 v35, v35
    v_exp_f32 v36, v36
    v_exp_f32 v37, v37
    v_exp_f32 v38, v38
    v_exp_f32 v39, v39
    v_pk_mul_f32 v[180:181], v[180:181], v[176:177]
    v_pk_mul_f32 v[182:183], v[182:183], v[178:179]
    v_pk_mul_f32 v[188:189], v[188:189], v[184:185]
    v_pk_mul_f32 v[190:191], v[190:191], v[186:187]
    v_pk_add_f32 v[32:33], v[32:33], v[30:31]
    v_pk_add_f32 v[34:35], v[34:35], v[30:31]
    v_pk_add_f32 v[36:37], v[36:37], v[30:31]
    v_pk_add_f32 v[38:39], v[38:39], v[30:31]
    v_rcp_f32 v32, v32
    v_rcp_f32 v33, v33
    v_rcp_f32 v34, v34
    v_rcp_f32 v35, v35
    v_rcp_f32 v36, v36
    v_rcp_f32 v37, v37
    v_rcp_f32 v38, v38
    v_rcp_f32 v39, v39
    s_nop 0
    v_pk_mul_f32 v[32:33], v[32:33], v[180:181]
    v_pk_mul_f32 v[34:35], v[34:35], v[182:183]
    v_pk_mul_f32 v[36:37], v[36:37], v[188:189]
    v_pk_mul_f32 v[38:39], v[38:39], v[190:191]
    v_cvt_pk_bf16_f32 v40, v32, v33
    v_cvt_pk_bf16_f32 v41, v34, v35
    v_cvt_pk_bf16_f32 v42, v36, v37
    v_cvt_pk_bf16_f32 v43, v38, v39
    buffer_store_dwordx4 v[40:43], v10, s[16:19], s26 offen offset:1280 sc1
    v_pk_mul_f32 v[44:45], v[192:193], v[192:193]
    v_pk_mul_f32 v[46:47], v[194:195], v[194:195]
    v_pk_mul_f32 v[48:49], v[200:201], v[200:201]
    v_pk_mul_f32 v[50:51], v[202:203], v[202:203]
    v_pk_fma_f32 v[44:45], v[44:45], v[28:29], v[26:27]
    v_pk_fma_f32 v[46:47], v[46:47], v[28:29], v[26:27]
    v_pk_fma_f32 v[48:49], v[48:49], v[28:29], v[26:27]
    v_pk_fma_f32 v[50:51], v[50:51], v[28:29], v[26:27]
    v_pk_mul_f32 v[44:45], v[44:45], v[192:193]
    v_pk_mul_f32 v[46:47], v[46:47], v[194:195]
    v_pk_mul_f32 v[48:49], v[48:49], v[200:201]
    v_pk_mul_f32 v[50:51], v[50:51], v[202:203]
    v_exp_f32 v44, v44
    v_exp_f32 v45, v45
    v_exp_f32 v46, v46
    v_exp_f32 v47, v47
    v_exp_f32 v48, v48
    v_exp_f32 v49, v49
    v_exp_f32 v50, v50
    v_exp_f32 v51, v51
    v_pk_mul_f32 v[196:197], v[196:197], v[192:193]
    v_pk_mul_f32 v[198:199], v[198:199], v[194:195]
    v_pk_mul_f32 v[204:205], v[204:205], v[200:201]
    v_pk_mul_f32 v[206:207], v[206:207], v[202:203]
    v_pk_add_f32 v[44:45], v[44:45], v[30:31]
    v_pk_add_f32 v[46:47], v[46:47], v[30:31]
    v_pk_add_f32 v[48:49], v[48:49], v[30:31]
    v_pk_add_f32 v[50:51], v[50:51], v[30:31]
    v_rcp_f32 v44, v44
    v_rcp_f32 v45, v45
    v_rcp_f32 v46, v46
    v_rcp_f32 v47, v47
    v_rcp_f32 v48, v48
    v_rcp_f32 v49, v49
    v_rcp_f32 v50, v50
    v_rcp_f32 v51, v51
    s_nop 0
    v_pk_mul_f32 v[44:45], v[44:45], v[196:197]
    v_pk_mul_f32 v[46:47], v[46:47], v[198:199]
    v_pk_mul_f32 v[48:49], v[48:49], v[204:205]
    v_pk_mul_f32 v[50:51], v[50:51], v[206:207]
    v_cvt_pk_bf16_f32 v52, v44, v45
    v_cvt_pk_bf16_f32 v53, v46, v47
    v_cvt_pk_bf16_f32 v54, v48, v49
    v_cvt_pk_bf16_f32 v55, v50, v51
    buffer_store_dwordx4 v[52:55], v11, s[16:19], s26 offen offset:2048 sc1
    v_pk_mul_f32 v[56:57], v[208:209], v[208:209]
    v_pk_mul_f32 v[58:59], v[210:211], v[210:211]
    v_pk_mul_f32 v[60:61], v[216:217], v[216:217]
    v_pk_mul_f32 v[62:63], v[218:219], v[218:219]
    v_pk_fma_f32 v[56:57], v[56:57], v[28:29], v[26:27]
    v_pk_fma_f32 v[58:59], v[58:59], v[28:29], v[26:27]
    v_pk_fma_f32 v[60:61], v[60:61], v[28:29], v[26:27]
    v_pk_fma_f32 v[62:63], v[62:63], v[28:29], v[26:27]
    v_pk_mul_f32 v[56:57], v[56:57], v[208:209]
    v_pk_mul_f32 v[58:59], v[58:59], v[210:211]
    v_pk_mul_f32 v[60:61], v[60:61], v[216:217]
    v_pk_mul_f32 v[62:63], v[62:63], v[218:219]
    v_exp_f32 v56, v56
    v_exp_f32 v57, v57
    v_exp_f32 v58, v58
    v_exp_f32 v59, v59
    v_exp_f32 v60, v60
    v_exp_f32 v61, v61
    v_exp_f32 v62, v62
    v_exp_f32 v63, v63
    v_pk_mul_f32 v[212:213], v[212:213], v[208:209]
    v_pk_mul_f32 v[214:215], v[214:215], v[210:211]
    v_pk_mul_f32 v[220:221], v[220:221], v[216:217]
    v_pk_mul_f32 v[222:223], v[222:223], v[218:219]
    v_pk_add_f32 v[56:57], v[56:57], v[30:31]
    v_pk_add_f32 v[58:59], v[58:59], v[30:31]
    v_pk_add_f32 v[60:61], v[60:61], v[30:31]
    v_pk_add_f32 v[62:63], v[62:63], v[30:31]
    v_rcp_f32 v56, v56
    v_rcp_f32 v57, v57
    v_rcp_f32 v58, v58
    v_rcp_f32 v59, v59
    v_rcp_f32 v60, v60
    v_rcp_f32 v61, v61
    v_rcp_f32 v62, v62
    v_rcp_f32 v63, v63
    s_nop 0
    v_pk_mul_f32 v[56:57], v[56:57], v[212:213]
    v_pk_mul_f32 v[58:59], v[58:59], v[214:215]
    v_pk_mul_f32 v[60:61], v[60:61], v[220:221]
    v_pk_mul_f32 v[62:63], v[62:63], v[222:223]
    v_cvt_pk_bf16_f32 v64, v56, v57
    v_cvt_pk_bf16_f32 v65, v58, v59
    v_cvt_pk_bf16_f32 v66, v60, v61
    v_cvt_pk_bf16_f32 v67, v62, v63
    buffer_store_dwordx4 v[64:67], v10, s[16:19], s26 offen offset:2304 sc1
    v_pk_mul_f32 v[32:33], v[224:225], v[224:225]
    v_pk_mul_f32 v[34:35], v[226:227], v[226:227]
    v_pk_mul_f32 v[36:37], v[232:233], v[232:233]
    v_pk_mul_f32 v[38:39], v[234:235], v[234:235]
    v_pk_fma_f32 v[32:33], v[32:33], v[28:29], v[26:27]
    v_pk_fma_f32 v[34:35], v[34:35], v[28:29], v[26:27]
    v_pk_fma_f32 v[36:37], v[36:37], v[28:29], v[26:27]
    v_pk_fma_f32 v[38:39], v[38:39], v[28:29], v[26:27]
    v_pk_mul_f32 v[32:33], v[32:33], v[224:225]
    v_pk_mul_f32 v[34:35], v[34:35], v[226:227]
    v_pk_mul_f32 v[36:37], v[36:37], v[232:233]
    v_pk_mul_f32 v[38:39], v[38:39], v[234:235]
    v_exp_f32 v32, v32
    v_exp_f32 v33, v33
    v_exp_f32 v34, v34
    v_exp_f32 v35, v35
    v_exp_f32 v36, v36
    v_exp_f32 v37, v37
    v_exp_f32 v38, v38
    v_exp_f32 v39, v39
    v_pk_mul_f32 v[228:229], v[228:229], v[224:225]
    v_pk_mul_f32 v[230:231], v[230:231], v[226:227]
    v_pk_mul_f32 v[236:237], v[236:237], v[232:233]
    v_pk_mul_f32 v[238:239], v[238:239], v[234:235]
    v_pk_add_f32 v[32:33], v[32:33], v[30:31]
    v_pk_add_f32 v[34:35], v[34:35], v[30:31]
    v_pk_add_f32 v[36:37], v[36:37], v[30:31]
    v_pk_add_f32 v[38:39], v[38:39], v[30:31]
    v_rcp_f32 v32, v32
    v_rcp_f32 v33, v33
    v_rcp_f32 v34, v34
    v_rcp_f32 v35, v35
    v_rcp_f32 v36, v36
    v_rcp_f32 v37, v37
    v_rcp_f32 v38, v38
    v_rcp_f32 v39, v39
    s_nop 0
    v_pk_mul_f32 v[32:33], v[32:33], v[228:229]
    v_pk_mul_f32 v[34:35], v[34:35], v[230:231]
    v_pk_mul_f32 v[36:37], v[36:37], v[236:237]
    v_pk_mul_f32 v[38:39], v[38:39], v[238:239]
    v_cvt_pk_bf16_f32 v40, v32, v33
    v_cvt_pk_bf16_f32 v41, v34, v35
    v_cvt_pk_bf16_f32 v42, v36, v37
    v_cvt_pk_bf16_f32 v43, v38, v39
    buffer_store_dwordx4 v[40:43], v11, s[16:19], s26 offen offset:3072 sc1
    v_pk_mul_f32 v[44:45], v[240:241], v[240:241]
    v_pk_mul_f32 v[46:47], v[242:243], v[242:243]
    v_pk_mul_f32 v[48:49], v[248:249], v[248:249]
    v_pk_mul_f32 v[50:51], v[250:251], v[250:251]
    v_pk_fma_f32 v[44:45], v[44:45], v[28:29], v[26:27]
    v_pk_fma_f32 v[46:47], v[46:47], v[28:29], v[26:27]
    v_pk_fma_f32 v[48:49], v[48:49], v[28:29], v[26:27]
    v_pk_fma_f32 v[50:51], v[50:51], v[28:29], v[26:27]
    v_pk_mul_f32 v[44:45], v[44:45], v[240:241]
    v_pk_mul_f32 v[46:47], v[46:47], v[242:243]
    v_pk_mul_f32 v[48:49], v[48:49], v[248:249]
    v_pk_mul_f32 v[50:51], v[50:51], v[250:251]
    v_exp_f32 v44, v44
    v_exp_f32 v45, v45
    v_exp_f32 v46, v46
    v_exp_f32 v47, v47
    v_exp_f32 v48, v48
    v_exp_f32 v49, v49
    v_exp_f32 v50, v50
    v_exp_f32 v51, v51
    v_pk_mul_f32 v[244:245], v[244:245], v[240:241]
    v_pk_mul_f32 v[246:247], v[246:247], v[242:243]
    v_pk_mul_f32 v[252:253], v[252:253], v[248:249]
    v_pk_mul_f32 v[254:255], v[254:255], v[250:251]
    v_pk_add_f32 v[44:45], v[44:45], v[30:31]
    v_pk_add_f32 v[46:47], v[46:47], v[30:31]
    v_pk_add_f32 v[48:49], v[48:49], v[30:31]
    v_pk_add_f32 v[50:51], v[50:51], v[30:31]
    v_rcp_f32 v44, v44
    v_rcp_f32 v45, v45
    v_rcp_f32 v46, v46
    v_rcp_f32 v47, v47
    v_rcp_f32 v48, v48
    v_rcp_f32 v49, v49
    v_rcp_f32 v50, v50
    v_rcp_f32 v51, v51
    s_nop 0
    v_pk_mul_f32 v[44:45], v[44:45], v[244:245]
    v_pk_mul_f32 v[46:47], v[46:47], v[246:247]
    v_pk_mul_f32 v[48:49], v[48:49], v[252:253]
    v_pk_mul_f32 v[50:51], v[50:51], v[254:255]
    v_cvt_pk_bf16_f32 v52, v44, v45
    v_cvt_pk_bf16_f32 v53, v46, v47
    v_cvt_pk_bf16_f32 v54, v48, v49
    v_cvt_pk_bf16_f32 v55, v50, v51
    buffer_store_dwordx4 v[52:55], v10, s[16:19], s26 offen offset:3328 sc1
    s_add_u32 s59, s23, 16
    s_lshl_b32 s59, s59, 8
    s_waitcnt vmcnt(12)
    v_cmp_gt_u32 vcc, 32, v13
    s_nop 1
    s_cmp_eq_u64 vcc, 0
    s_cselect_b32 s56, 1, 0
    s_branch L_phase2
L_aux:
    s_lshl_b32 s22, s20, 14
    s_lshl_b32 s21, s2, 17
    s_add_u32 s21, s21, s22
    s_or_b32 s28, s2, s20
    s_add_u32 s4, s98, 20971520
    s_addc_u32 s5, s99, 0
    s_mov_b32 s6, 4194304
    s_mov_b32 s7, 0x00020000
    s_add_u32 s8, s98, 33554432
    s_addc_u32 s9, s99, 0
    s_mov_b32 s10, 4194304
    s_mov_b32 s11, 0x00020000
    s_add_u32 s12, s98, 39845888
    s_addc_u32 s13, s99, 0
    s_mov_b32 s14, 8192
    s_mov_b32 s15, 0x00020000
    s_waitcnt vmcnt(0)
    s_barrier
    s_cmp_lg_u32 s20, 0
    s_cbranch_scc1 L_aux_nosig
    v_mov_b32 v4, 2048
    v_mov_b32 v5, 1
    s_mov_b64 s[78:79], exec
    s_mov_b64 exec, 1
    buffer_atomic_add v5, v4, s[48:51], 0 offen
    s_mov_b64 exec, s[78:79]
L_aux_nosig:
    s_lshl_b32 s29, s2, 3
    s_add_u32 s29, s29, s20
    s_lshl_b32 s29, s29, 13
    v_lshlrev_b32 v7, 7, v2
    s_mov_b32 s16, s88
    s_mov_b32 s17, s89
    s_mov_b32 s18, 7340032
    s_mov_b32 s19, 0x00020000
    s_mov_b32 s36, s90
    s_mov_b32 s37, s91
    s_mov_b32 s38, 7340032
    s_mov_b32 s39, 0x00020000
    s_mov_b32 s40, s92
    s_mov_b32 s41, s93
    s_mov_b32 s42, 7340032
    s_mov_b32 s43, 0x00020000
    s_bfe_u32 s24, s2, 0x20001
    s_lshl_b32 s25, s24, 3
    s_add_u32 s25, s25, 1
    s_min_u32 s25, s25, 21
    s_bfe_u32 s24, s2, 0x10003
    s_lshl_b32 s24, s24, 2
    s_add_u32 s25, s25, s24
    s_lshl_b32 s25, s25, 8
    s_add_u32 s25, s25, 128
    s_mul_i32 s24, s20, 458752
    s_add_u32 s30, s25, s24
    s_bitcmp1_b32 s2, 4
    s_cselect_b32 s44, s90, s88
    s_cselect_b32 s45, s91, s89
    s_mov_b32 s46, 7340032
    s_mov_b32 s47, 0x00020000
    s_mov_b32 m0, 157696
    v_lshlrev_b32 v7, 3, v3
    s_add_u32 s24, s29, 1046528
    buffer_load_dword v7, s[16:19], s24 offen lds
    s_add_u32 s24, s29, 1046528
    buffer_load_dword v7, s[36:39], s24 offen lds
    v_lshrrev_b32 v104, 5, v2
    v_lshlrev_b32 v104, 2, v104
    v_add_u32 v105, s27, v104
    v_cvt_f32_u32 v105, v105
    v_add_f32 v106, 0x41800000, v105
    v_fma_f32 v107, v105, 2.0, 1.0
    v_fma_f32 v108, v106, 2.0, 1.0
    v_and_b32 v109, 31, v2
    v_cvt_f32_u32 v109, v109
    v_mul_f32 v110, 0x3d000000, v109
    v_add_f32 v111, 0x3c800000, v110
    v_mul_f32 v112, 0x3c800000, v109
    v_mov_b32 v117, 0
    v_mov_b32 v118, 0xbe800000
    v_mov_b32 v119, 0x3e800000
    s_mov_b32 s26, 0x3fcfef9e
    s_lshl_b32 s24, s20, 1
    s_add_u32 s24, s24, 131072
    v_add_u32 v6, s24, v3
    v_fma_f32 v168, v110, v105, v117
    v_fma_f32 v169, v110, v106, v117
    v_fma_f32 v170, v110, v105, v118
    v_fma_f32 v171, v110, v106, v118
    v_fma_f32 v172, v110, v105, v119
    v_fma_f32 v173, v110, v106, v119
    v_fma_f32 v174, v111, v105, v117
    v_fma_f32 v175, v111, v106, v117
    v_fma_f32 v176, v111, v105, v118
    v_fma_f32 v177, v111, v106, v118
    v_fma_f32 v178, v111, v105, v119
    v_fma_f32 v179, v111, v106, v119
    v_fma_f32 v180, v112, v107, v117
    v_fma_f32 v181, v112, v108, v117
    v_fma_f32 v182, v112, v107, v118
    v_fma_f32 v183, v112, v108, v118
    v_fma_f32 v184, v112, v107, v119
    v_fma_f32 v185, v112, v108, v119
    v_cos_f32 v168, v168
    v_cos_f32 v169, v169
    v_cos_f32 v170, v170
    v_cos_f32 v171, v171
    v_cos_f32 v172, v172
    v_cos_f32 v173, v173
    v_cos_f32 v174, v174
    v_cos_f32 v175, v175
    v_cos_f32 v176, v176
    v_cos_f32 v177, v177
    v_cos_f32 v178, v178
    v_cos_f32 v179, v179
    v_cos_f32 v180, v180
    v_cos_f32 v181, v181
    v_cos_f32 v182, v182
    v_cos_f32 v183, v183
    v_cos_f32 v184, v184
    v_cos_f32 v185, v185
    v_mul_f32 v168, s26, v168
    v_mul_f32 v169, s26, v169
    v_mul_f32 v170, s26, v170
    v_mul_f32 v171, s26, v171
    v_mul_f32 v172, s26, v172
    v_mul_f32 v173, s26, v173
    v_mul_f32 v174, s26, v174
    v_mul_f32 v175, s26, v175
    v_mul_f32 v176, s26, v176
    v_mul_f32 v177, s26, v177
    v_mul_f32 v178, s26, v178
    v_mul_f32 v179, s26, v179
    v_mul_f32 v180, s26, v180
    v_mul_f32 v181, s26, v181
    v_mul_f32 v182, s26, v182
    v_mul_f32 v183, s26, v183
    v_mul_f32 v184, s26, v184
    v_mul_f32 v185, s26, v185
    v_cvt_pk_bf16_f32 v168, v168, v168
    v_cvt_pk_bf16_f32 v169, v169, v169
    v_cvt_pk_bf16_f32 v170, v170, v170
    v_cvt_pk_bf16_f32 v171, v171, v171
    v_cvt_pk_bf16_f32 v172, v172, v172
    v_cvt_pk_bf16_f32 v173, v173, v173
    v_cvt_pk_bf16_f32 v174, v174, v174
    v_cvt_pk_bf16_f32 v175, v175, v175
    v_cvt_pk_bf16_f32 v176, v176, v176
    v_cvt_pk_bf16_f32 v177, v177, v177
    v_cvt_pk_bf16_f32 v178, v178, v178
    v_cvt_pk_bf16_f32 v179, v179, v179
    v_cvt_pk_bf16_f32 v180, v180, v180
    v_cvt_pk_bf16_f32 v181, v181, v181
    v_cvt_pk_bf16_f32 v182, v182, v182
    v_cvt_pk_bf16_f32 v183, v183, v183
    v_cvt_pk_bf16_f32 v184, v184, v184
    v_cvt_pk_bf16_f32 v185, v185, v185
    ds_write_b16 v6, v168 offset:0
    ds_write_b16 v6, v169 offset:1024
    ds_write_b16 v6, v170 offset:2048
    ds_write_b16 v6, v171 offset:3072
    ds_write_b16 v6, v172 offset:4096
    ds_write_b16 v6, v173 offset:5120
    ds_write_b16 v6, v174 offset:6144
    ds_write_b16 v6, v175 offset:7168
    ds_write_b16 v6, v176 offset:8192
    ds_write_b16 v6, v177 offset:9216
    ds_write_b16 v6, v178 offset:10240
    ds_write_b16 v6, v179 offset:11264
    ds_write_b16 v6, v180 offset:12288
    ds_write_b16 v6, v181 offset:13312
    ds_write_b16 v6, v182 offset:14336
    ds_write_b16 v6, v183 offset:15360
    ds_write_b16 v6, v184 offset:16384
    ds_write_b16 v6, v185 offset:17408
    v_and_b32 v6, 31, v2
    v_cvt_f32_u32 v6, v6
    v_mul_f32 v6, 0x3a000000, v6
    v_lshrrev_b32 v7, 5, v2
    v_lshlrev_b32 v7, 2, v7
    v_cvt_f32_u32 v7, v7
    v_mul_f32 v7, v6, v7
    v_mov_b32 v1, 0x00000000
    v_fma_f32 v24, v6, v1, v7
    v_mov_b32 v1, 0x3f800000
    v_fma_f32 v25, v6, v1, v7
    v_mov_b32 v1, 0x40000000
    v_fma_f32 v26, v6, v1, v7
    v_mov_b32 v1, 0x40400000
    v_fma_f32 v27, v6, v1, v7
    v_mov_b32 v1, 0x41000000
    v_fma_f32 v28, v6, v1, v7
    v_mov_b32 v1, 0x41100000
    v_fma_f32 v29, v6, v1, v7
    v_mov_b32 v1, 0x41200000
    v_fma_f32 v30, v6, v1, v7
    v_mov_b32 v1, 0x41300000
    v_fma_f32 v31, v6, v1, v7
    v_mov_b32 v1, 0x41800000
    v_fma_f32 v32, v6, v1, v7
    v_mov_b32 v1, 0x41880000
    v_fma_f32 v33, v6, v1, v7
    v_mov_b32 v1, 0x41900000
    v_fma_f32 v34, v6, v1, v7
    v_mov_b32 v1, 0x41980000
    v_fma_f32 v35, v6, v1, v7
    v_mov_b32 v1, 0x41c00000
    v_fma_f32 v36, v6, v1, v7
    v_mov_b32 v1, 0x41c80000
    v_fma_f32 v37, v6, v1, v7
    v_mov_b32 v1, 0x41d00000
    v_fma_f32 v38, v6, v1, v7
    v_mov_b32 v1, 0x41d80000
    v_fma_f32 v39, v6, v1, v7
    v_cos_f32 v8, v24
    v_cos_f32 v9, v25
    v_cos_f32 v10, v26
    v_cos_f32 v11, v27
    v_cos_f32 v12, v28
    v_cos_f32 v13, v29
    v_cos_f32 v14, v30
    v_cos_f32 v15, v31
    v_cos_f32 v16, v32
    v_cos_f32 v17, v33
    v_cos_f32 v18, v34
    v_cos_f32 v19, v35
    v_cos_f32 v20, v36
    v_cos_f32 v21, v37
    v_cos_f32 v22, v38
    v_cos_f32 v23, v39
    v_sin_f32 v24, v24
    v_sin_f32 v25, v25
    v_sin_f32 v26, v26
    v_sin_f32 v27, v27
    v_sin_f32 v28, v28
    v_sin_f32 v29, v29
    v_sin_f32 v30, v30
    v_sin_f32 v31, v31
    v_sin_f32 v32, v32
    v_sin_f32 v33, v33
    v_sin_f32 v34, v34
    v_sin_f32 v35, v35
    v_sin_f32 v36, v36
    v_sin_f32 v37, v37
    v_sin_f32 v38, v38
    v_sin_f32 v39, v39
    v_lshrrev_b32 v1, 4, v2
    v_and_b32 v4, 7, v2
    v_xor_b32 v1, v1, v4
    v_lshrrev_b32 v4, 3, v2
    v_lshlrev_b32 v4, 7, v4
    v_lshl_add_u32 v104, v1, 4, v4
    v_xor_b32 v105, 64, v104
    s_lshr_b32 s24, s20, 1
    s_lshl_b32 s24, s24, 15
    s_and_b32 s25, s20, 1
    s_lshl_b32 s25, s25, 2
    v_bfe_u32 v1, v2, 1, 3
    v_xor_b32 v1, s25, v1
    v_lshlrev_b32 v4, 7, v2
    v_lshl_add_u32 v4, v1, 4, v4
    v_add_u32 v106, s24, v4
    v_xor_b32 v107, 16, v106
    v_xor_b32 v108, 32, v106
    v_xor_b32 v109, 48, v106
    v_bfe_u32 v1, v2, 2, 3
    v_xor_b32 v1, s25, v1
    v_and_b32 v4, 1, v2
    v_xor_b32 v1, v1, v4
    v_lshrrev_b32 v4, 1, v2
    v_lshlrev_b32 v4, 7, v4
    v_lshl_add_u32 v4, v1, 4, v4
    v_add_u32 v6, s24, v4
    v_xor_b32 v0, 32, v6
    v_add_u32 v5, 131072, v3
    s_cmp_lg_u32 s20, 0
    s_cbranch_scc1 L_aux_nopoll
    v_and_b32 v1, 7, v2
    v_add_u32 v1, 8, v1
    v_lshlrev_b32 v1, 8, v1
    s_mov_b32 s58, 0
L_pf:
    buffer_load_dword v4, v1, s[48:51], 0 offen sc1
    s_waitcnt vmcnt(0)
    v_cmp_gt_u32 vcc, 32, v4
    s_nop 1
    s_cmp_eq_u64 vcc, 0
    s_cbranch_scc1 L_pf_done
    s_sleep 1
    s_add_u32 s58, s58, 1
    s_cmp_lt_u32 s58, 0x80000
    s_cbranch_scc1 L_pf
L_pf_done:
L_aux_nopoll:
    s_waitcnt lgkmcnt(0)
    s_barrier
    s_add_u32 m0, s22, 0
    s_add_u32 s24, s21, 0
    buffer_load_dwordx4 v104, s[4:7], s24 offen offset:0 sc1 lds
    buffer_load_dwordx4 v105, s[4:7], s24 offen offset:1024 sc1 lds
    buffer_load_dwordx4 v104, s[4:7], s24 offen offset:2048 sc1 lds
    buffer_load_dwordx4 v105, s[4:7], s24 offen offset:3072 sc1 lds
    s_add_u32 m0, s22, 4096
    s_add_u32 s24, s21, 4096
    buffer_load_dwordx4 v104, s[4:7], s24 offen offset:0 sc1 lds
    buffer_load_dwordx4 v105, s[4:7], s24 offen offset:1024 sc1 lds
    buffer_load_dwordx4 v104, s[4:7], s24 offen offset:2048 sc1 lds
    buffer_load_dwordx4 v105, s[4:7], s24 offen offset:3072 sc1 lds
    s_add_u32 m0, s22, 8192
    s_add_u32 s24, s21, 8192
    buffer_load_dwordx4 v104, s[4:7], s24 offen offset:0 sc1 lds
    buffer_load_dwordx4 v105, s[4:7], s24 offen offset:1024 sc1 lds
    buffer_load_dwordx4 v104, s[4:7], s24 offen offset:2048 sc1 lds
    buffer_load_dwordx4 v105, s[4:7], s24 offen offset:3072 sc1 lds
    s_add_u32 m0, s22, 12288
    s_add_u32 s24, s21, 12288
    buffer_load_dwordx4 v104, s[4:7], s24 offen offset:0 sc1 lds
    buffer_load_dwordx4 v105, s[4:7], s24 offen offset:1024 sc1 lds
    buffer_load_dwordx4 v104, s[4:7], s24 offen offset:2048 sc1 lds
    buffer_load_dwordx4 v105, s[4:7], s24 offen offset:3072 sc1 lds
    s_waitcnt vmcnt(0)
    s_barrier
    ds_read_b128 v[40:43], v106 offset:0
    ds_read_b128 v[44:47], v107 offset:0
    ds_read_b128 v[48:51], v106 offset:8192
    ds_read_b128 v[52:55], v107 offset:8192
    ds_read_b128 v[56:59], v106 offset:16384
    ds_read_b128 v[60:63], v107 offset:16384
    ds_read_b128 v[64:67], v106 offset:24576
    ds_read_b128 v[68:71], v107 offset:24576
    ds_read_b128 v[72:75], v108 offset:0
    ds_read_b128 v[76:79], v109 offset:0
    ds_read_b128 v[80:83], v108 offset:8192
    ds_read_b128 v[84:87], v109 offset:8192
    ds_read_b128 v[88:91], v108 offset:16384
    ds_read_b128 v[92:95], v109 offset:16384
    ds_read_b128 v[96:99], v108 offset:24576
    ds_read_b128 v[100:103], v109 offset:24576
    s_waitcnt lgkmcnt(0)
    s_barrier
    s_add_u32 m0, s22, 0
    s_add_u32 s24, s21, 0
    buffer_load_dwordx4 v104, s[8:11], s24 offen offset:0 sc1 lds
    buffer_load_dwordx4 v105, s[8:11], s24 offen offset:1024 sc1 lds
    buffer_load_dwordx4 v104, s[8:11], s24 offen offset:2048 sc1 lds
    buffer_load_dwordx4 v105, s[8:11], s24 offen offset:3072 sc1 lds
    s_add_u32 m0, s22, 4096
    s_add_u32 s24, s21, 4096
    buffer_load_dwordx4 v104, s[8:11], s24 offen offset:0 sc1 lds
    buffer_load_dwordx4 v105, s[8:11], s24 offen offset:1024 sc1 lds
    buffer_load_dwordx4 v104, s[8:11], s24 offen offset:2048 sc1 lds
    buffer_load_dwordx4 v105, s[8:11], s24 offen offset:3072 sc1 lds
    s_add_u32 m0, s22, 8192
    s_add_u32 s24, s21, 8192
    buffer_load_dwordx4 v104, s[8:11], s24 offen offset:0 sc1 lds
    buffer_load_dwordx4 v105, s[8:11], s24 offen offset:1024 sc1 lds
    buffer_load_dwordx4 v104, s[8:11], s24 offen offset:2048 sc1 lds
    buffer_load_dwordx4 v105, s[8:11], s24 offen offset:3072 sc1 lds
    s_add_u32 m0, s22, 12288
    s_add_u32 s24, s21, 12288
    buffer_load_dwordx4 v104, s[8:11], s24 offen offset:0 sc1 lds
    buffer_load_dwordx4 v105, s[8:11], s24 offen offset:1024 sc1 lds
    buffer_load_dwordx4 v104, s[8:11], s24 offen offset:2048 sc1 lds
    buffer_load_dwordx4 v105, s[8:11], s24 offen offset:3072 sc1 lds
    s_cmp_lg_u32 s2, 0
    s_cbranch_scc1 L_aux_no512
    s_lshl_b32 s24, s20, 10
    s_add_u32 m0, s24, 149504
    s_nop 0
    buffer_load_dwordx4 v3, s[12:15], s24 offen sc1 lds
L_aux_no512:
    ds_read_b128 v[232:235], v5 offset:0
    ds_read_b128 v[236:239], v5 offset:2048
    ds_read_b128 v[240:243], v5 offset:4096
    s_cmp_lg_u32 s28, 0
    s_cbranch_scc1 L_aux_nsp1
    v_mov_b32 v44, 0
    v_mov_b32 v45, 0
    v_mov_b32 v46, 0
    v_mov_b32 v47, 0
    v_mov_b32 v52, 0
    v_mov_b32 v53, 0
    v_mov_b32 v54, 0
    v_mov_b32 v55, 0
    v_mov_b32 v60, 0
    v_mov_b32 v61, 0
    v_mov_b32 v62, 0
    v_mov_b32 v63, 0
    v_mov_b32 v68, 0
    v_mov_b32 v69, 0
    v_mov_b32 v70, 0
    v_mov_b32 v71, 0
L_aux_nsp1:
    s_waitcnt lgkmcnt(0)
    ds_read_b128 v[244:247], v5 offset:1024
    ds_read_b128 v[248:251], v5 offset:3072
    ds_read_b128 v[252:255], v5 offset:5120
    v_mfma_f32_32x32x16_bf16 v[104:119], v[40:43], v[232:235], 0
    v_mfma_f32_32x32x16_bf16 v[120:135], v[44:47], v[232:235], 0
    v_mfma_f32_32x32x16_bf16 v[104:119], v[44:47], v[236:239], v[104:119]
    v_mfma_f32_32x32x16_bf16 v[120:135], v[40:43], v[240:243], v[120:135]
    s_waitcnt lgkmcnt(0)
    ds_read_b128 v[232:235], v5 offset:12288
    ds_read_b128 v[236:239], v5 offset:14336
    ds_read_b128 v[240:243], v5 offset:16384
    v_mfma_f32_32x32x16_bf16 v[104:119], v[48:51], v[244:247], v[104:119]
    v_mfma_f32_32x32x16_bf16 v[120:135], v[52:55], v[244:247], v[120:135]
    v_mfma_f32_32x32x16_bf16 v[104:119], v[52:55], v[248:251], v[104:119]
    v_mfma_f32_32x32x16_bf16 v[120:135], v[48:51], v[252:255], v[120:135]
    s_waitcnt lgkmcnt(0)
    ds_read_b128 v[244:247], v5 offset:13312
    ds_read_b128 v[248:251], v5 offset:15360
    ds_read_b128 v[252:255], v5 offset:17408
    v_mfma_f32_32x32x16_bf16 v[136:151], v[56:59], v[232:235], 0
    v_mfma_f32_32x32x16_bf16 v[152:167], v[60:63], v[232:235], 0
    v_mfma_f32_32x32x16_bf16 v[136:151], v[60:63], v[236:239], v[136:151]
    v_mfma_f32_32x32x16_bf16 v[152:167], v[56:59], v[240:243], v[152:167]
    s_waitcnt lgkmcnt(0)
    ds_read_b128 v[232:235], v5 offset:0
    ds_read_b128 v[236:239], v5 offset:2048
    ds_read_b128 v[240:243], v5 offset:4096
    v_mfma_f32_32x32x16_bf16 v[136:151], v[64:67], v[244:247], v[136:151]
    v_mfma_f32_32x32x16_bf16 v[152:167], v[68:71], v[244:247], v[152:167]
    v_mfma_f32_32x32x16_bf16 v[136:151], v[68:71], v[248:251], v[136:151]
    v_mfma_f32_32x32x16_bf16 v[152:167], v[64:67], v[252:255], v[152:167]
    s_waitcnt lgkmcnt(0)
    ds_read_b128 v[244:247], v5 offset:1024
    ds_read_b128 v[248:251], v5 offset:3072
    ds_read_b128 v[252:255], v5 offset:5120
    v_mfma_f32_32x32x16_bf16 v[168:183], v[72:75], v[232:235], 0
    s_nop 11
    v_add_f32 v1, v104, v136
    v_add_f32 v4, v120, v152
    v_sub_f32 v7, v104, v136
    v_sub_f32 v152, v120, v152
    v_mul_f32 v104, v1, v8
    v_mul_f32 v120, v4, v8
    v_mul_f32 v136, v7, v8
    v_fma_f32 v104, v4, v24, v104
    v_fma_f32 v120, -v1, v24, v120
    v_fma_f32 v136, v152, v24, v136
    v_mul_f32 v152, v152, v8
    v_mfma_f32_32x32x16_bf16 v[184:199], v[76:79], v[232:235], 0
    v_fma_f32 v152, -v7, v24, v152
    v_add_f32 v1, v105, v137
    v_add_f32 v4, v121, v153
    v_sub_f32 v7, v105, v137
    v_sub_f32 v153, v121, v153
    v_mul_f32 v105, v1, v9
    v_mul_f32 v121, v4, v9
    v_mul_f32 v137, v7, v9
    v_fma_f32 v105, v4, v25, v105
    v_fma_f32 v121, -v1, v25, v121
    v_fma_f32 v137, v153, v25, v137
    v_mul_f32 v153, v153, v9
    v_mfma_f32_32x32x16_bf16 v[168:183], v[76:79], v[236:239], v[168:183]
    v_fma_f32 v153, -v7, v25, v153
    v_add_f32 v1, v106, v138
    v_add_f32 v4, v122, v154
    v_sub_f32 v7, v106, v138
    v_sub_f32 v154, v122, v154
    v_mul_f32 v106, v1, v10
    v_mul_f32 v122, v4, v10
    v_mul_f32 v138, v7, v10
    v_fma_f32 v106, v4, v26, v106
    v_fma_f32 v122, -v1, v26, v122
    v_fma_f32 v138, v154, v26, v138
    v_mul_f32 v154, v154, v10
    v_mfma_f32_32x32x16_bf16 v[184:199], v[72:75], v[240:243], v[184:199]
    v_fma_f32 v154, -v7, v26, v154
    v_add_f32 v1, v107, v139
    v_add_f32 v4, v123, v155
    v_sub_f32 v7, v107, v139
    v_sub_f32 v155, v123, v155
    v_mul_f32 v107, v1, v11
    v_mul_f32 v123, v4, v11
    v_mul_f32 v139, v7, v11
    v_fma_f32 v107, v4, v27, v107
    v_fma_f32 v123, -v1, v27, v123
    v_fma_f32 v139, v155, v27, v139
    v_mul_f32 v155, v155, v11
    s_waitcnt lgkmcnt(0)
    ds_read_b128 v[232:235], v5 offset:12288
    ds_read_b128 v[236:239], v5 offset:14336
    ds_read_b128 v[240:243], v5 offset:16384
    v_mfma_f32_32x32x16_bf16 v[168:183], v[80:83], v[244:247], v[168:183]
    v_fma_f32 v155, -v7, v27, v155
    v_add_f32 v1, v108, v140
    v_add_f32 v4, v124, v156
    v_sub_f32 v7, v108, v140
    v_sub_f32 v156, v124, v156
    v_mul_f32 v108, v1, v12
    v_mul_f32 v124, v4, v12
    v_mul_f32 v140, v7, v12
    v_fma_f32 v108, v4, v28, v108
    v_fma_f32 v124, -v1, v28, v124
    v_fma_f32 v140, v156, v28, v140
    v_mul_f32 v156, v156, v12
    v_mfma_f32_32x32x16_bf16 v[184:199], v[84:87], v[244:247], v[184:199]
    v_fma_f32 v156, -v7, v28, v156
    v_add_f32 v1, v109, v141
    v_add_f32 v4, v125, v157
    v_sub_f32 v7, v109, v141
    v_sub_f32 v157, v125, v157
    v_mul_f32 v109, v1, v13
    v_mul_f32 v125, v4, v13
    v_mul_f32 v141, v7, v13
    v_fma_f32 v109, v4, v29, v109
    v_fma_f32 v125, -v1, v29, v125
    v_fma_f32 v141, v157, v29, v141
    v_mul_f32 v157, v157, v13
    v_mfma_f32_32x32x16_bf16 v[168:183], v[84:87], v[248:251], v[168:183]
    v_fma_f32 v157, -v7, v29, v157
    v_add_f32 v1, v110, v142
    v_add_f32 v4, v126, v158
    v_sub_f32 v7, v110, v142
    v_sub_f32 v158, v126, v158
    v_mul_f32 v110, v1, v14
    v_mul_f32 v126, v4, v14
    v_mul_f32 v142, v7, v14
    v_fma_f32 v110, v4, v30, v110
    v_fma_f32 v126, -v1, v30, v126
    v_fma_f32 v142, v158, v30, v142
    v_mul_f32 v158, v158, v14
    v_mfma_f32_32x32x16_bf16 v[184:199], v[80:83], v[252:255], v[184:199]
    v_fma_f32 v158, -v7, v30, v158
    v_add_f32 v1, v111, v143
    v_add_f32 v4, v127, v159
    v_sub_f32 v7, v111, v143
    v_sub_f32 v159, v127, v159
    v_mul_f32 v111, v1, v15
    v_mul_f32 v127, v4, v15
    v_mul_f32 v143, v7, v15
    v_fma_f32 v111, v4, v31, v111
    v_fma_f32 v127, -v1, v31, v127
    v_fma_f32 v143, v159, v31, v143
    v_mul_f32 v159, v159, v15
    s_waitcnt lgkmcnt(0)
    ds_read_b128 v[244:247], v5 offset:13312
    ds_read_b128 v[248:251], v5 offset:15360
    ds_read_b128 v[252:255], v5 offset:17408
    v_mfma_f32_32x32x16_bf16 v[200:215], v[88:91], v[232:235], 0
    v_fma_f32 v159, -v7, v31, v159
    v_add_f32 v1, v112, v144
    v_add_f32 v4, v128, v160
    v_sub_f32 v7, v112, v144
    v_sub_f32 v160, v128, v160
    v_mul_f32 v112, v1, v16
    v_mul_f32 v128, v4, v16
    v_mul_f32 v144, v7, v16
    v_fma_f32 v112, v4, v32, v112
    v_fma_f32 v128, -v1, v32, v128
    v_fma_f32 v144, v160, v32, v144
    v_mul_f32 v160, v160, v16
    v_mfma_f32_32x32x16_bf16 v[216:231], v[92:95], v[232:235], 0
    v_fma_f32 v160, -v7, v32, v160
    v_add_f32 v1, v113, v145
    v_add_f32 v4, v129, v161
    v_sub_f32 v7, v113, v145
    v_sub_f32 v161, v129, v161
    v_mul_f32 v113, v1, v17
    v_mul_f32 v129, v4, v17
    v_mul_f32 v145, v7, v17
    v_fma_f32 v113, v4, v33, v113
    v_fma_f32 v129, -v1, v33, v129
    v_fma_f32 v145, v161, v33, v145
    v_mul_f32 v161, v161, v17
    v_mfma_f32_32x32x16_bf16 v[200:215], v[92:95], v[236:239], v[200:215]
    v_fma_f32 v161, -v7, v33, v161
    v_add_f32 v1, v114, v146
    v_add_f32 v4, v130, v162
    v_sub_f32 v7, v114, v146
    v_sub_f32 v162, v130, v162
    v_mul_f32 v114, v1, v18
    v_mul_f32 v130, v4, v18
    v_mul_f32 v146, v7, v18
    v_fma_f32 v114, v4, v34, v114
    v_fma_f32 v130, -v1, v34, v130
    v_fma_f32 v146, v162, v34, v146
    v_mul_f32 v162, v162, v18
    v_mfma_f32_32x32x16_bf16 v[216:231], v[88:91], v[240:243], v[216:231]
    v_fma_f32 v162, -v7, v34, v162
    v_add_f32 v1, v115, v147
    v_add_f32 v4, v131, v163
    v_sub_f32 v7, v115, v147
    v_sub_f32 v163, v131, v163
    v_mul_f32 v115, v1, v19
    v_mul_f32 v131, v4, v19
    v_mul_f32 v147, v7, v19
    v_fma_f32 v115, v4, v35, v115
    v_fma_f32 v131, -v1, v35, v131
    v_fma_f32 v147, v163, v35, v147
    v_mul_f32 v163, v163, v19
    s_waitcnt lgkmcnt(0)
    ds_read_b128 v[232:235], v5 offset:0
    ds_read_b128 v[236:239], v5 offset:2048
    ds_read_b128 v[240:243], v5 offset:4096
    v_mfma_f32_32x32x16_bf16 v[200:215], v[96:99], v[244:247], v[200:215]
    v_fma_f32 v163, -v7, v35, v163
    v_add_f32 v1, v116, v148
    v_add_f32 v4, v132, v164
    v_sub_f32 v7, v116, v148
    v_sub_f32 v164, v132, v164
    v_mul_f32 v116, v1, v20
    v_mul_f32 v132, v4, v20
    v_mul_f32 v148, v7, v20
    v_fma_f32 v116, v4, v36, v116
    v_fma_f32 v132, -v1, v36, v132
    v_fma_f32 v148, v164, v36, v148
    v_mul_f32 v164, v164, v20
    v_mfma_f32_32x32x16_bf16 v[216:231], v[100:103], v[244:247], v[216:231]
    v_fma_f32 v164, -v7, v36, v164
    v_add_f32 v1, v117, v149
    v_add_f32 v4, v133, v165
    v_sub_f32 v7, v117, v149
    v_sub_f32 v165, v133, v165
    v_mul_f32 v117, v1, v21
    v_mul_f32 v133, v4, v21
    v_mul_f32 v149, v7, v21
    v_fma_f32 v117, v4, v37, v117
    v_fma_f32 v133, -v1, v37, v133
    v_fma_f32 v149, v165, v37, v149
    v_mul_f32 v165, v165, v21
    v_mfma_f32_32x32x16_bf16 v[200:215], v[100:103], v[248:251], v[200:215]
    v_fma_f32 v165, -v7, v37, v165
    v_add_f32 v1, v118, v150
    v_add_f32 v4, v134, v166
    v_sub_f32 v7, v118, v150
    v_sub_f32 v166, v134, v166
    v_mul_f32 v118, v1, v22
    v_mul_f32 v134, v4, v22
    v_mul_f32 v150, v7, v22
    v_fma_f32 v118, v4, v38, v118
    v_fma_f32 v134, -v1, v38, v134
    v_fma_f32 v150, v166, v38, v150
    v_mul_f32 v166, v166, v22
    v_mfma_f32_32x32x16_bf16 v[216:231], v[96:99], v[252:255], v[216:231]
    v_fma_f32 v166, -v7, v38, v166
    v_add_f32 v1, v119, v151
    v_add_f32 v4, v135, v167
    v_sub_f32 v7, v119, v151
    v_sub_f32 v167, v135, v167
    v_mul_f32 v119, v1, v23
    v_mul_f32 v135, v4, v23
    v_mul_f32 v151, v7, v23
    v_fma_f32 v119, v4, v39, v119
    v_fma_f32 v135, -v1, v39, v135
    v_fma_f32 v151, v167, v39, v151
    v_mul_f32 v167, v167, v23
    v_fma_f32 v167, -v7, v39, v167
    v_cvt_pk_bf16_f32 v40, v104, v105
    v_cvt_pk_bf16_f32 v41, v106, v107
    v_cvt_pk_bf16_f32 v42, v108, v109
    v_cvt_pk_bf16_f32 v43, v110, v111
    v_cvt_pk_bf16_f32 v48, v112, v113
    v_cvt_pk_bf16_f32 v49, v114, v115
    v_cvt_pk_bf16_f32 v50, v116, v117
    v_cvt_pk_bf16_f32 v51, v118, v119
    v_cvt_pk_bf16_f32 v44, v120, v121
    v_cvt_pk_bf16_f32 v45, v122, v123
    v_cvt_pk_bf16_f32 v46, v124, v125
    v_cvt_pk_bf16_f32 v47, v126, v127
    v_cvt_pk_bf16_f32 v52, v128, v129
    v_cvt_pk_bf16_f32 v53, v130, v131
    v_cvt_pk_bf16_f32 v54, v132, v133
    v_cvt_pk_bf16_f32 v55, v134, v135
    v_cvt_pk_bf16_f32 v56, v136, v137
    v_cvt_pk_bf16_f32 v57, v138, v139
    v_cvt_pk_bf16_f32 v58, v140, v141
    v_cvt_pk_bf16_f32 v59, v142, v143
    v_cvt_pk_bf16_f32 v64, v144, v145
    v_cvt_pk_bf16_f32 v65, v146, v147
    v_cvt_pk_bf16_f32 v66, v148, v149
    v_cvt_pk_bf16_f32 v67, v150, v151
    v_cvt_pk_bf16_f32 v60, v152, v153
    v_cvt_pk_bf16_f32 v61, v154, v155
    v_cvt_pk_bf16_f32 v62, v156, v157
    v_cvt_pk_bf16_f32 v63, v158, v159
    v_cvt_pk_bf16_f32 v68, v160, v161
    v_cvt_pk_bf16_f32 v69, v162, v163
    v_cvt_pk_bf16_f32 v70, v164, v165
    v_cvt_pk_bf16_f32 v71, v166, v167
    s_waitcnt lgkmcnt(0)
    ds_read_b128 v[244:247], v5 offset:1024
    ds_read_b128 v[248:251], v5 offset:3072
    ds_read_b128 v[252:255], v5 offset:5120
    v_mfma_f32_32x32x16_bf16 v[104:119], v[232:235], v[40:43], 0
    v_add_f32 v1, v168, v200
    v_add_f32 v4, v184, v216
    v_sub_f32 v7, v168, v200
    v_sub_f32 v216, v184, v216
    v_mul_f32 v168, v1, v8
    v_mul_f32 v184, v4, v8
    v_mul_f32 v200, v7, v8
    v_fma_f32 v168, v4, v24, v168
    v_fma_f32 v184, -v1, v24, v184
    v_fma_f32 v200, v216, v24, v200
    v_mul_f32 v216, v216, v8
    v_fma_f32 v216, -v7, v24, v216
    v_mfma_f32_32x32x16_bf16 v[120:135], v[232:235], v[44:47], 0
    v_add_f32 v1, v169, v201
    v_add_f32 v4, v185, v217
    v_sub_f32 v7, v169, v201
    v_sub_f32 v217, v185, v217
    v_mul_f32 v169, v1, v9
    v_mul_f32 v185, v4, v9
    v_mul_f32 v201, v7, v9
    v_fma_f32 v169, v4, v25, v169
    v_fma_f32 v185, -v1, v25, v185
    v_fma_f32 v201, v217, v25, v201
    v_mul_f32 v217, v217, v9
    v_fma_f32 v217, -v7, v25, v217
    v_mfma_f32_32x32x16_bf16 v[104:119], v[236:239], v[44:47], v[104:119]
    v_add_f32 v1, v170, v202
    v_add_f32 v4, v186, v218
    v_sub_f32 v7, v170, v202
    v_sub_f32 v218, v186, v218
    v_mul_f32 v170, v1, v10
    v_mul_f32 v186, v4, v10
    v_mul_f32 v202, v7, v10
    v_fma_f32 v170, v4, v26, v170
    v_fma_f32 v186, -v1, v26, v186
    v_fma_f32 v202, v218, v26, v202
    v_mul_f32 v218, v218, v10
    v_fma_f32 v218, -v7, v26, v218
    v_mfma_f32_32x32x16_bf16 v[120:135], v[240:243], v[40:43], v[120:135]
    v_add_f32 v1, v171, v203
    v_add_f32 v4, v187, v219
    v_sub_f32 v7, v171, v203
    v_sub_f32 v219, v187, v219
    v_mul_f32 v171, v1, v11
    v_mul_f32 v187, v4, v11
    v_mul_f32 v203, v7, v11
    v_fma_f32 v171, v4, v27, v171
    v_fma_f32 v187, -v1, v27, v187
    v_fma_f32 v203, v219, v27, v203
    v_mul_f32 v219, v219, v11
    v_fma_f32 v219, -v7, v27, v219
    s_waitcnt lgkmcnt(0)
    ds_read_b128 v[232:235], v5 offset:6144
    ds_read_b128 v[236:239], v5 offset:8192
    ds_read_b128 v[240:243], v5 offset:10240
    v_mfma_f32_32x32x16_bf16 v[104:119], v[244:247], v[48:51], v[104:119]
    v_add_f32 v1, v172, v204
    v_add_f32 v4, v188, v220
    v_sub_f32 v7, v172, v204
    v_sub_f32 v220, v188, v220
    v_mul_f32 v172, v1, v12
    v_mul_f32 v188, v4, v12
    v_mul_f32 v204, v7, v12
    v_fma_f32 v172, v4, v28, v172
    v_fma_f32 v188, -v1, v28, v188
    v_fma_f32 v204, v220, v28, v204
    v_mul_f32 v220, v220, v12
    v_fma_f32 v220, -v7, v28, v220
    v_mfma_f32_32x32x16_bf16 v[120:135], v[244:247], v[52:55], v[120:135]
    v_add_f32 v1, v173, v205
    v_add_f32 v4, v189, v221
    v_sub_f32 v7, v173, v205
    v_sub_f32 v221, v189, v221
    v_mul_f32 v173, v1, v13
    v_mul_f32 v189, v4, v13
    v_mul_f32 v205, v7, v13
    v_fma_f32 v173, v4, v29, v173
    v_fma_f32 v189, -v1, v29, v189
    v_fma_f32 v205, v221, v29, v205
    v_mul_f32 v221, v221, v13
    v_fma_f32 v221, -v7, v29, v221
    v_mfma_f32_32x32x16_bf16 v[104:119], v[248:251], v[52:55], v[104:119]
    v_add_f32 v1, v174, v206
    v_add_f32 v4, v190, v222
    v_sub_f32 v7, v174, v206
    v_sub_f32 v222, v190, v222
    v_mul_f32 v174, v1, v14
    v_mul_f32 v190, v4, v14
    v_mul_f32 v206, v7, v14
    v_fma_f32 v174, v4, v30, v174
    v_fma_f32 v190, -v1, v30, v190
    v_fma_f32 v206, v222, v30, v206
    v_mul_f32 v222, v222, v14
    v_fma_f32 v222, -v7, v30, v222
    v_mfma_f32_32x32x16_bf16 v[120:135], v[252:255], v[48:51], v[120:135]
    v_add_f32 v1, v175, v207
    v_add_f32 v4, v191, v223
    v_sub_f32 v7, v175, v207
    v_sub_f32 v223, v191, v223
    v_mul_f32 v175, v1, v15
    v_mul_f32 v191, v4, v15
    v_mul_f32 v207, v7, v15
    v_fma_f32 v175, v4, v31, v175
    v_fma_f32 v191, -v1, v31, v191
    v_fma_f32 v207, v223, v31, v207
    v_mul_f32 v223, v223, v15
    s_waitcnt lgkmcnt(0)
    ds_read_b128 v[244:247], v5 offset:7168
    ds_read_b128 v[248:251], v5 offset:9216
    ds_read_b128 v[252:255], v5 offset:11264
    v_mfma_f32_32x32x16_bf16 v[136:151], v[232:235], v[56:59], 0
    v_fma_f32 v223, -v7, v31, v223
    v_add_f32 v1, v176, v208
    v_add_f32 v4, v192, v224
    v_sub_f32 v7, v176, v208
    v_sub_f32 v224, v192, v224
    v_mul_f32 v176, v1, v16
    v_mul_f32 v192, v4, v16
    v_mul_f32 v208, v7, v16
    v_fma_f32 v176, v4, v32, v176
    v_fma_f32 v192, -v1, v32, v192
    v_fma_f32 v208, v224, v32, v208
    v_mul_f32 v224, v224, v16
    v_mfma_f32_32x32x16_bf16 v[152:167], v[232:235], v[60:63], 0
    v_fma_f32 v224, -v7, v32, v224
    v_add_f32 v1, v177, v209
    v_add_f32 v4, v193, v225
    v_sub_f32 v7, v177, v209
    v_sub_f32 v225, v193, v225
    v_mul_f32 v177, v1, v17
    v_mul_f32 v193, v4, v17
    v_mul_f32 v209, v7, v17
    v_fma_f32 v177, v4, v33, v177
    v_fma_f32 v193, -v1, v33, v193
    v_fma_f32 v209, v225, v33, v209
    v_mul_f32 v225, v225, v17
    v_mfma_f32_32x32x16_bf16 v[136:151], v[236:239], v[60:63], v[136:151]
    v_fma_f32 v225, -v7, v33, v225
    v_add_f32 v1, v178, v210
    v_add_f32 v4, v194, v226
    v_sub_f32 v7, v178, v210
    v_sub_f32 v226, v194, v226
    v_mul_f32 v178, v1, v18
    v_mul_f32 v194, v4, v18
    v_mul_f32 v210, v7, v18
    v_fma_f32 v178, v4, v34, v178
    v_fma_f32 v194, -v1, v34, v194
    v_fma_f32 v210, v226, v34, v210
    v_mul_f32 v226, v226, v18
    v_mfma_f32_32x32x16_bf16 v[152:167], v[240:243], v[56:59], v[152:167]
    v_fma_f32 v226, -v7, v34, v226
    v_add_f32 v1, v179, v211
    v_add_f32 v4, v195, v227
    v_sub_f32 v7, v179, v211
    v_sub_f32 v227, v195, v227
    v_mul_f32 v179, v1, v19
    v_mul_f32 v195, v4, v19
    v_mul_f32 v211, v7, v19
    v_fma_f32 v179, v4, v35, v179
    v_fma_f32 v195, -v1, v35, v195
    v_fma_f32 v211, v227, v35, v211
    v_mul_f32 v227, v227, v19
    s_waitcnt lgkmcnt(0)
    ds_read_b128 v[232:235], v5 offset:0
    ds_read_b128 v[236:239], v5 offset:2048
    ds_read_b128 v[240:243], v5 offset:4096
    v_mfma_f32_32x32x16_bf16 v[136:151], v[244:247], v[64:67], v[136:151]
    v_fma_f32 v227, -v7, v35, v227
    v_add_f32 v1, v180, v212
    v_add_f32 v4, v196, v228
    v_sub_f32 v7, v180, v212
    v_sub_f32 v228, v196, v228
    v_mul_f32 v180, v1, v20
    v_mul_f32 v196, v4, v20
    v_mul_f32 v212, v7, v20
    v_fma_f32 v180, v4, v36, v180
    v_fma_f32 v196, -v1, v36, v196
    v_fma_f32 v212, v228, v36, v212
    v_mul_f32 v228, v228, v20
    v_mfma_f32_32x32x16_bf16 v[152:167], v[244:247], v[68:71], v[152:167]
    v_fma_f32 v228, -v7, v36, v228
    v_add_f32 v1, v181, v213
    v_add_f32 v4, v197, v229
    v_sub_f32 v7, v181, v213
    v_sub_f32 v229, v197, v229
    v_mul_f32 v181, v1, v21
    v_mul_f32 v197, v4, v21
    v_mul_f32 v213, v7, v21
    v_fma_f32 v181, v4, v37, v181
    v_fma_f32 v197, -v1, v37, v197
    v_fma_f32 v213, v229, v37, v213
    v_mul_f32 v229, v229, v21
    v_mfma_f32_32x32x16_bf16 v[136:151], v[248:251], v[68:71], v[136:151]
    v_fma_f32 v229, -v7, v37, v229
    v_add_f32 v1, v182, v214
    v_add_f32 v4, v198, v230
    v_sub_f32 v7, v182, v214
    v_sub_f32 v230, v198, v230
    v_mul_f32 v182, v1, v22
    v_mul_f32 v198, v4, v22
    v_mul_f32 v214, v7, v22
    v_fma_f32 v182, v4, v38, v182
    v_fma_f32 v198, -v1, v38, v198
    v_fma_f32 v214, v230, v38, v214
    v_mul_f32 v230, v230, v22
    v_mfma_f32_32x32x16_bf16 v[152:167], v[252:255], v[64:67], v[152:167]
    v_fma_f32 v230, -v7, v38, v230
    v_add_f32 v1, v183, v215
    v_add_f32 v4, v199, v231
    v_sub_f32 v7, v183, v215
    v_sub_f32 v231, v199, v231
    v_mul_f32 v183, v1, v23
    v_mul_f32 v199, v4, v23
    v_mul_f32 v215, v7, v23
    v_fma_f32 v183, v4, v39, v183
    v_fma_f32 v199, -v1, v39, v199
    v_fma_f32 v215, v231, v39, v215
    v_mul_f32 v231, v231, v23
    v_fma_f32 v231, -v7, v39, v231
    v_cvt_pk_bf16_f32 v72, v168, v169
    v_cvt_pk_bf16_f32 v73, v170, v171
    v_cvt_pk_bf16_f32 v74, v172, v173
    v_cvt_pk_bf16_f32 v75, v174, v175
    v_cvt_pk_bf16_f32 v80, v176, v177
    v_cvt_pk_bf16_f32 v81, v178, v179
    v_cvt_pk_bf16_f32 v82, v180, v181
    v_cvt_pk_bf16_f32 v83, v182, v183
    v_cvt_pk_bf16_f32 v76, v184, v185
    v_cvt_pk_bf16_f32 v77, v186, v187
    v_cvt_pk_bf16_f32 v78, v188, v189
    v_cvt_pk_bf16_f32 v79, v190, v191
    v_cvt_pk_bf16_f32 v84, v192, v193
    v_cvt_pk_bf16_f32 v85, v194, v195
    v_cvt_pk_bf16_f32 v86, v196, v197
    v_cvt_pk_bf16_f32 v87, v198, v199
    v_cvt_pk_bf16_f32 v88, v200, v201
    v_cvt_pk_bf16_f32 v89, v202, v203
    v_cvt_pk_bf16_f32 v90, v204, v205
    v_cvt_pk_bf16_f32 v91, v206, v207
    v_cvt_pk_bf16_f32 v96, v208, v209
    v_cvt_pk_bf16_f32 v97, v210, v211
    v_cvt_pk_bf16_f32 v98, v212, v213
    v_cvt_pk_bf16_f32 v99, v214, v215
    v_cvt_pk_bf16_f32 v92, v216, v217
    v_cvt_pk_bf16_f32 v93, v218, v219
    v_cvt_pk_bf16_f32 v94, v220, v221
    v_cvt_pk_bf16_f32 v95, v222, v223
    v_cvt_pk_bf16_f32 v100, v224, v225
    v_cvt_pk_bf16_f32 v101, v226, v227
    v_cvt_pk_bf16_f32 v102, v228, v229
    v_cvt_pk_bf16_f32 v103, v230, v231
    s_waitcnt vmcnt(0)
    s_barrier
    s_mov_b32 m0, 157696
    v_lshlrev_b32 v7, 3, v3
    s_add_u32 s24, s29, 3143680
    buffer_load_dword v7, s[16:19], s24 offen lds
    s_add_u32 s24, s29, 3143680
    buffer_load_dword v7, s[36:39], s24 offen lds
    s_add_u32 s24, s29, 5240832
    buffer_load_dword v7, s[16:19], s24 offen lds
    s_add_u32 s24, s29, 5240832
    buffer_load_dword v7, s[36:39], s24 offen lds
    ds_read_b128 v[40:43], v6 offset:0
    ds_read_b128 v[44:47], v6 offset:4096
    ds_read_b128 v[48:51], v6 offset:8192
    ds_read_b128 v[52:55], v6 offset:12288
    ds_read_b128 v[56:59], v6 offset:16384
    ds_read_b128 v[60:63], v6 offset:20480
    ds_read_b128 v[64:67], v6 offset:24576
    ds_read_b128 v[68:71], v6 offset:28672
    s_waitcnt lgkmcnt(0)
    ds_read_b128 v[244:247], v5 offset:1024
    ds_read_b128 v[248:251], v5 offset:3072
    ds_read_b128 v[252:255], v5 offset:5120
    v_mfma_f32_32x32x16_bf16 v[168:183], v[232:235], v[72:75], 0
    s_waitcnt lgkmcnt(0)
    v_lshlrev_b32 v1, 16, v40
    v_and_b32 v4, 0xffff0000, v40
    v_mul_f32 v7, v104, v4
    v_mul_f32 v104, v104, v1
    v_fma_f32 v104, -v120, v4, v104
    v_fma_f32 v120, v120, v1, v7
    v_lshlrev_b32 v1, 16, v41
    v_and_b32 v4, 0xffff0000, v41
    v_mul_f32 v7, v105, v4
    v_mul_f32 v105, v105, v1
    v_fma_f32 v105, -v121, v4, v105
    v_mfma_f32_32x32x16_bf16 v[184:199], v[232:235], v[76:79], 0
    v_fma_f32 v121, v121, v1, v7
    v_lshlrev_b32 v1, 16, v42
    v_and_b32 v4, 0xffff0000, v42
    v_mul_f32 v7, v106, v4
    v_mul_f32 v106, v106, v1
    v_fma_f32 v106, -v122, v4, v106
    v_fma_f32 v122, v122, v1, v7
    v_lshlrev_b32 v1, 16, v43
    v_and_b32 v4, 0xffff0000, v43
    v_mul_f32 v7, v107, v4
    v_mul_f32 v107, v107, v1
    v_fma_f32 v107, -v123, v4, v107
    v_mfma_f32_32x32x16_bf16 v[168:183], v[236:239], v[76:79], v[168:183]
    v_fma_f32 v123, v123, v1, v7
    v_lshlrev_b32 v1, 16, v44
    v_and_b32 v4, 0xffff0000, v44
    v_mul_f32 v7, v108, v4
    v_mul_f32 v108, v108, v1
    v_fma_f32 v108, -v124, v4, v108
    v_fma_f32 v124, v124, v1, v7
    v_lshlrev_b32 v1, 16, v45
    v_and_b32 v4, 0xffff0000, v45
    v_mul_f32 v7, v109, v4
    v_mul_f32 v109, v109, v1
    v_fma_f32 v109, -v125, v4, v109
    v_mfma_f32_32x32x16_bf16 v[184:199], v[240:243], v[72:75], v[184:199]
    v_fma_f32 v125, v125, v1, v7
    v_lshlrev_b32 v1, 16, v46
    v_and_b32 v4, 0xffff0000, v46
    v_mul_f32 v7, v110, v4
    v_mul_f32 v110, v110, v1
    v_fma_f32 v110, -v126, v4, v110
    v_fma_f32 v126, v126, v1, v7
    v_lshlrev_b32 v1, 16, v47
    v_and_b32 v4, 0xffff0000, v47
    v_mul_f32 v7, v111, v4
    v_mul_f32 v111, v111, v1
    v_fma_f32 v111, -v127, v4, v111
    s_waitcnt lgkmcnt(0)
    ds_read_b128 v[232:235], v5 offset:6144
    ds_read_b128 v[236:239], v5 offset:8192
    ds_read_b128 v[240:243], v5 offset:10240
    v_mfma_f32_32x32x16_bf16 v[168:183], v[244:247], v[80:83], v[168:183]
    v_fma_f32 v127, v127, v1, v7
    v_lshlrev_b32 v1, 16, v48
    v_and_b32 v4, 0xffff0000, v48
    v_mul_f32 v7, v112, v4
    v_mul_f32 v112, v112, v1
    v_fma_f32 v112, -v128, v4, v112
    v_fma_f32 v128, v128, v1, v7
    v_lshlrev_b32 v1, 16, v49
    v_and_b32 v4, 0xffff0000, v49
    v_mul_f32 v7, v113, v4
    v_mul_f32 v113, v113, v1
    v_fma_f32 v113, -v129, v4, v113
    v_mfma_f32_32x32x16_bf16 v[184:199], v[244:247], v[84:87], v[184:199]
    v_fma_f32 v129, v129, v1, v7
    v_lshlrev_b32 v1, 16, v50
    v_and_b32 v4, 0xffff0000, v50
    v_mul_f32 v7, v114, v4
    v_mul_f32 v114, v114, v1
    v_fma_f32 v114, -v130, v4, v114
    v_fma_f32 v130, v130, v1, v7
    v_lshlrev_b32 v1, 16, v51
    v_and_b32 v4, 0xffff0000, v51
    v_mul_f32 v7, v115, v4
    v_mul_f32 v115, v115, v1
    v_fma_f32 v115, -v131, v4, v115
    v_mfma_f32_32x32x16_bf16 v[168:183], v[248:251], v[84:87], v[168:183]
    v_fma_f32 v131, v131, v1, v7
    v_lshlrev_b32 v1, 16, v52
    v_and_b32 v4, 0xffff0000, v52
    v_mul_f32 v7, v116, v4
    v_mul_f32 v116, v116, v1
    v_fma_f32 v116, -v132, v4, v116
    v_fma_f32 v132, v132, v1, v7
    v_lshlrev_b32 v1, 16, v53
    v_and_b32 v4, 0xffff0000, v53
    v_mul_f32 v7, v117, v4
    v_mul_f32 v117, v117, v1
    v_fma_f32 v117, -v133, v4, v117
    v_mfma_f32_32x32x16_bf16 v[184:199], v[252:255], v[80:83], v[184:199]
    v_fma_f32 v133, v133, v1, v7
    v_lshlrev_b32 v1, 16, v54
    v_and_b32 v4, 0xffff0000, v54
    v_mul_f32 v7, v118, v4
    v_mul_f32 v118, v118, v1
    v_fma_f32 v118, -v134, v4, v118
    v_fma_f32 v134, v134, v1, v7
    v_lshlrev_b32 v1, 16, v55
    v_and_b32 v4, 0xffff0000, v55
    v_mul_f32 v7, v119, v4
    v_mul_f32 v119, v119, v1
    v_fma_f32 v119, -v135, v4, v119
    s_waitcnt lgkmcnt(0)
    ds_read_b128 v[244:247], v5 offset:7168
    ds_read_b128 v[248:251], v5 offset:9216
    ds_read_b128 v[252:255], v5 offset:11264
    v_mfma_f32_32x32x16_bf16 v[200:215], v[232:235], v[88:91], 0
    v_fma_f32 v135, v135, v1, v7
    v_lshlrev_b32 v1, 16, v56
    v_and_b32 v4, 0xffff0000, v56
    v_mul_f32 v7, v136, v4
    v_mul_f32 v136, v136, v1
    v_fma_f32 v136, -v152, v4, v136
    v_fma_f32 v152, v152, v1, v7
    v_lshlrev_b32 v1, 16, v57
    v_and_b32 v4, 0xffff0000, v57
    v_mul_f32 v7, v137, v4
    v_mul_f32 v137, v137, v1
    v_fma_f32 v137, -v153, v4, v137
    v_mfma_f32_32x32x16_bf16 v[216:231], v[232:235], v[92:95], 0
    v_fma_f32 v153, v153, v1, v7
    v_lshlrev_b32 v1, 16, v58
    v_and_b32 v4, 0xffff0000, v58
    v_mul_f32 v7, v138, v4
    v_mul_f32 v138, v138, v1
    v_fma_f32 v138, -v154, v4, v138
    v_fma_f32 v154, v154, v1, v7
    v_lshlrev_b32 v1, 16, v59
    v_and_b32 v4, 0xffff0000, v59
    v_mul_f32 v7, v139, v4
    v_mul_f32 v139, v139, v1
    v_fma_f32 v139, -v155, v4, v139
    v_mfma_f32_32x32x16_bf16 v[200:215], v[236:239], v[92:95], v[200:215]
    v_fma_f32 v155, v155, v1, v7
    v_lshlrev_b32 v1, 16, v60
    v_and_b32 v4, 0xffff0000, v60
    v_mul_f32 v7, v140, v4
    v_mul_f32 v140, v140, v1
    v_fma_f32 v140, -v156, v4, v140
    v_fma_f32 v156, v156, v1, v7
    v_lshlrev_b32 v1, 16, v61
    v_and_b32 v4, 0xffff0000, v61
    v_mul_f32 v7, v141, v4
    v_mul_f32 v141, v141, v1
    v_fma_f32 v141, -v157, v4, v141
    v_mfma_f32_32x32x16_bf16 v[216:231], v[240:243], v[88:91], v[216:231]
    v_fma_f32 v157, v157, v1, v7
    v_lshlrev_b32 v1, 16, v62
    v_and_b32 v4, 0xffff0000, v62
    v_mul_f32 v7, v142, v4
    v_mul_f32 v142, v142, v1
    v_fma_f32 v142, -v158, v4, v142
    v_fma_f32 v158, v158, v1, v7
    v_lshlrev_b32 v1, 16, v63
    v_and_b32 v4, 0xffff0000, v63
    v_mul_f32 v7, v143, v4
    v_mul_f32 v143, v143, v1
    v_fma_f32 v143, -v159, v4, v143
    s_waitcnt lgkmcnt(0)
    ds_read_b128 v[232:235], v5 offset:0
    ds_read_b128 v[236:239], v5 offset:2048
    ds_read_b128 v[240:243], v5 offset:4096
    v_mfma_f32_32x32x16_bf16 v[200:215], v[244:247], v[96:99], v[200:215]
    v_fma_f32 v159, v159, v1, v7
    v_lshlrev_b32 v1, 16, v64
    v_and_b32 v4, 0xffff0000, v64
    v_mul_f32 v7, v144, v4
    v_mul_f32 v144, v144, v1
    v_fma_f32 v144, -v160, v4, v144
    v_fma_f32 v160, v160, v1, v7
    v_lshlrev_b32 v1, 16, v65
    v_and_b32 v4, 0xffff0000, v65
    v_mul_f32 v7, v145, v4
    v_mul_f32 v145, v145, v1
    v_fma_f32 v145, -v161, v4, v145
    v_mfma_f32_32x32x16_bf16 v[216:231], v[244:247], v[100:103], v[216:231]
    v_fma_f32 v161, v161, v1, v7
    v_lshlrev_b32 v1, 16, v66
    v_and_b32 v4, 0xffff0000, v66
    v_mul_f32 v7, v146, v4
    v_mul_f32 v146, v146, v1
    v_fma_f32 v146, -v162, v4, v146
    v_fma_f32 v162, v162, v1, v7
    v_lshlrev_b32 v1, 16, v67
    v_and_b32 v4, 0xffff0000, v67
    v_mul_f32 v7, v147, v4
    v_mul_f32 v147, v147, v1
    v_fma_f32 v147, -v163, v4, v147
    v_mfma_f32_32x32x16_bf16 v[200:215], v[248:251], v[100:103], v[200:215]
    v_fma_f32 v163, v163, v1, v7
    v_lshlrev_b32 v1, 16, v68
    v_and_b32 v4, 0xffff0000, v68
    v_mul_f32 v7, v148, v4
    v_mul_f32 v148, v148, v1
    v_fma_f32 v148, -v164, v4, v148
    v_fma_f32 v164, v164, v1, v7
    v_lshlrev_b32 v1, 16, v69
    v_and_b32 v4, 0xffff0000, v69
    v_mul_f32 v7, v149, v4
    v_mul_f32 v149, v149, v1
    v_fma_f32 v149, -v165, v4, v149
    v_mfma_f32_32x32x16_bf16 v[216:231], v[252:255], v[96:99], v[216:231]
    v_fma_f32 v165, v165, v1, v7
    v_lshlrev_b32 v1, 16, v70
    v_and_b32 v4, 0xffff0000, v70
    v_mul_f32 v7, v150, v4
    v_mul_f32 v150, v150, v1
    v_fma_f32 v150, -v166, v4, v150
    v_fma_f32 v166, v166, v1, v7
    v_lshlrev_b32 v1, 16, v71
    v_and_b32 v4, 0xffff0000, v71
    v_mul_f32 v7, v151, v4
    v_mul_f32 v151, v151, v1
    v_fma_f32 v151, -v167, v4, v151
    v_fma_f32 v167, v167, v1, v7
    v_cvt_pk_bf16_f32 v40, v104, v105
    v_cvt_pk_bf16_f32 v41, v106, v107
    v_cvt_pk_bf16_f32 v42, v108, v109
    v_cvt_pk_bf16_f32 v43, v110, v111
    v_cvt_pk_bf16_f32 v48, v112, v113
    v_cvt_pk_bf16_f32 v49, v114, v115
    v_cvt_pk_bf16_f32 v50, v116, v117
    v_cvt_pk_bf16_f32 v51, v118, v119
    v_cvt_pk_bf16_f32 v44, v120, v121
    v_cvt_pk_bf16_f32 v45, v122, v123
    v_cvt_pk_bf16_f32 v46, v124, v125
    v_cvt_pk_bf16_f32 v47, v126, v127
    v_cvt_pk_bf16_f32 v52, v128, v129
    v_cvt_pk_bf16_f32 v53, v130, v131
    v_cvt_pk_bf16_f32 v54, v132, v133
    v_cvt_pk_bf16_f32 v55, v134, v135
    v_cvt_pk_bf16_f32 v56, v136, v137
    v_cvt_pk_bf16_f32 v57, v138, v139
    v_cvt_pk_bf16_f32 v58, v140, v141
    v_cvt_pk_bf16_f32 v59, v142, v143
    v_cvt_pk_bf16_f32 v64, v144, v145
    v_cvt_pk_bf16_f32 v65, v146, v147
    v_cvt_pk_bf16_f32 v66, v148, v149
    v_cvt_pk_bf16_f32 v67, v150, v151
    v_cvt_pk_bf16_f32 v60, v152, v153
    v_cvt_pk_bf16_f32 v61, v154, v155
    v_cvt_pk_bf16_f32 v62, v156, v157
    v_cvt_pk_bf16_f32 v63, v158, v159
    v_cvt_pk_bf16_f32 v68, v160, v161
    v_cvt_pk_bf16_f32 v69, v162, v163
    v_cvt_pk_bf16_f32 v70, v164, v165
    v_cvt_pk_bf16_f32 v71, v166, v167
    ds_read_b128 v[72:75], v0 offset:0
    ds_read_b128 v[76:79], v0 offset:4096
    ds_read_b128 v[80:83], v0 offset:8192
    ds_read_b128 v[84:87], v0 offset:12288
    ds_read_b128 v[88:91], v0 offset:16384
    ds_read_b128 v[92:95], v0 offset:20480
    ds_read_b128 v[96:99], v0 offset:24576
    ds_read_b128 v[100:103], v0 offset:28672
    s_waitcnt lgkmcnt(0)
    ds_read_b128 v[244:247], v5 offset:1024
    ds_read_b128 v[248:251], v5 offset:3072
    ds_read_b128 v[252:255], v5 offset:5120
    v_mfma_f32_32x32x16_bf16 v[104:119], v[40:43], v[232:235], 0
    s_waitcnt lgkmcnt(0)
    v_lshlrev_b32 v1, 16, v72
    v_and_b32 v4, 0xffff0000, v72
    v_mul_f32 v7, v168, v4
    v_mul_f32 v168, v168, v1
    v_fma_f32 v168, -v184, v4, v168
    v_fma_f32 v184, v184, v1, v7
    v_lshlrev_b32 v1, 16, v73
    v_and_b32 v4, 0xffff0000, v73
    v_mul_f32 v7, v169, v4
    v_mul_f32 v169, v169, v1
    v_fma_f32 v169, -v185, v4, v169
    v_mfma_f32_32x32x16_bf16 v[120:135], v[44:47], v[232:235], 0
    v_fma_f32 v185, v185, v1, v7
    v_lshlrev_b32 v1, 16, v74
    v_and_b32 v4, 0xffff0000, v74
    v_mul_f32 v7, v170, v4
    v_mul_f32 v170, v170, v1
    v_fma_f32 v170, -v186, v4, v170
    v_fma_f32 v186, v186, v1, v7
    v_lshlrev_b32 v1, 16, v75
    v_and_b32 v4, 0xffff0000, v75
    v_mul_f32 v7, v171, v4
    v_mul_f32 v171, v171, v1
    v_fma_f32 v171, -v187, v4, v171
    v_mfma_f32_32x32x16_bf16 v[104:119], v[44:47], v[240:243], v[104:119]
    v_fma_f32 v187, v187, v1, v7
    v_lshlrev_b32 v1, 16, v76
    v_and_b32 v4, 0xffff0000, v76
    v_mul_f32 v7, v172, v4
    v_mul_f32 v172, v172, v1
    v_fma_f32 v172, -v188, v4, v172
    v_fma_f32 v188, v188, v1, v7
    v_lshlrev_b32 v1, 16, v77
    v_and_b32 v4, 0xffff0000, v77
    v_mul_f32 v7, v173, v4
    v_mul_f32 v173, v173, v1
    v_fma_f32 v173, -v189, v4, v173
    v_mfma_f32_32x32x16_bf16 v[120:135], v[40:43], v[236:239], v[120:135]
    v_fma_f32 v189, v189, v1, v7
    v_lshlrev_b32 v1, 16, v78
    v_and_b32 v4, 0xffff0000, v78
    v_mul_f32 v7, v174, v4
    v_mul_f32 v174, v174, v1
    v_fma_f32 v174, -v190, v4, v174
    v_fma_f32 v190, v190, v1, v7
    v_lshlrev_b32 v1, 16, v79
    v_and_b32 v4, 0xffff0000, v79
    v_mul_f32 v7, v175, v4
    v_mul_f32 v175, v175, v1
    v_fma_f32 v175, -v191, v4, v175
    s_waitcnt lgkmcnt(0)
    ds_read_b128 v[232:235], v5 offset:12288
    ds_read_b128 v[236:239], v5 offset:14336
    ds_read_b128 v[240:243], v5 offset:16384
    v_mfma_f32_32x32x16_bf16 v[104:119], v[48:51], v[244:247], v[104:119]
    v_fma_f32 v191, v191, v1, v7
    v_lshlrev_b32 v1, 16, v80
    v_and_b32 v4, 0xffff0000, v80
    v_mul_f32 v7, v176, v4
    v_mul_f32 v176, v176, v1
    v_fma_f32 v176, -v192, v4, v176
    v_fma_f32 v192, v192, v1, v7
    v_lshlrev_b32 v1, 16, v81
    v_and_b32 v4, 0xffff0000, v81
    v_mul_f32 v7, v177, v4
    v_mul_f32 v177, v177, v1
    v_fma_f32 v177, -v193, v4, v177
    v_mfma_f32_32x32x16_bf16 v[120:135], v[52:55], v[244:247], v[120:135]
    v_fma_f32 v193, v193, v1, v7
    v_lshlrev_b32 v1, 16, v82
    v_and_b32 v4, 0xffff0000, v82
    v_mul_f32 v7, v178, v4
    v_mul_f32 v178, v178, v1
    v_fma_f32 v178, -v194, v4, v178
    v_fma_f32 v194, v194, v1, v7
    v_lshlrev_b32 v1, 16, v83
    v_and_b32 v4, 0xffff0000, v83
    v_mul_f32 v7, v179, v4
    v_mul_f32 v179, v179, v1
    v_fma_f32 v179, -v195, v4, v179
    v_mfma_f32_32x32x16_bf16 v[104:119], v[52:55], v[252:255], v[104:119]
    v_fma_f32 v195, v195, v1, v7
    v_lshlrev_b32 v1, 16, v84
    v_and_b32 v4, 0xffff0000, v84
    v_mul_f32 v7, v180, v4
    v_mul_f32 v180, v180, v1
    v_fma_f32 v180, -v196, v4, v180
    v_fma_f32 v196, v196, v1, v7
    v_lshlrev_b32 v1, 16, v85
    v_and_b32 v4, 0xffff0000, v85
    v_mul_f32 v7, v181, v4
    v_mul_f32 v181, v181, v1
    v_fma_f32 v181, -v197, v4, v181
    v_mfma_f32_32x32x16_bf16 v[120:135], v[48:51], v[248:251], v[120:135]
    v_fma_f32 v197, v197, v1, v7
    v_lshlrev_b32 v1, 16, v86
    v_and_b32 v4, 0xffff0000, v86
    v_mul_f32 v7, v182, v4
    v_mul_f32 v182, v182, v1
    v_fma_f32 v182, -v198, v4, v182
    v_fma_f32 v198, v198, v1, v7
    v_lshlrev_b32 v1, 16, v87
    v_and_b32 v4, 0xffff0000, v87
    v_mul_f32 v7, v183, v4
    v_mul_f32 v183, v183, v1
    v_fma_f32 v183, -v199, v4, v183
    s_waitcnt lgkmcnt(0)
    ds_read_b128 v[244:247], v5 offset:13312
    ds_read_b128 v[248:251], v5 offset:15360
    ds_read_b128 v[252:255], v5 offset:17408
    v_mfma_f32_32x32x16_bf16 v[136:151], v[56:59], v[232:235], 0
    v_fma_f32 v199, v199, v1, v7
    v_lshlrev_b32 v1, 16, v88
    v_and_b32 v4, 0xffff0000, v88
    v_mul_f32 v7, v200, v4
    v_mul_f32 v200, v200, v1
    v_fma_f32 v200, -v216, v4, v200
    v_fma_f32 v216, v216, v1, v7
    v_lshlrev_b32 v1, 16, v89
    v_and_b32 v4, 0xffff0000, v89
    v_mul_f32 v7, v201, v4
    v_mul_f32 v201, v201, v1
    v_fma_f32 v201, -v217, v4, v201
    v_mfma_f32_32x32x16_bf16 v[152:167], v[60:63], v[232:235], 0
    v_fma_f32 v217, v217, v1, v7
    v_lshlrev_b32 v1, 16, v90
    v_and_b32 v4, 0xffff0000, v90
    v_mul_f32 v7, v202, v4
    v_mul_f32 v202, v202, v1
    v_fma_f32 v202, -v218, v4, v202
    v_fma_f32 v218, v218, v1, v7
    v_lshlrev_b32 v1, 16, v91
    v_and_b32 v4, 0xffff0000, v91
    v_mul_f32 v7, v203, v4
    v_mul_f32 v203, v203, v1
    v_fma_f32 v203, -v219, v4, v203
    v_mfma_f32_32x32x16_bf16 v[136:151], v[60:63], v[240:243], v[136:151]
    v_fma_f32 v219, v219, v1, v7
    v_lshlrev_b32 v1, 16, v92
    v_and_b32 v4, 0xffff0000, v92
    v_mul_f32 v7, v204, v4
    v_mul_f32 v204, v204, v1
    v_fma_f32 v204, -v220, v4, v204
    v_fma_f32 v220, v220, v1, v7
    v_lshlrev_b32 v1, 16, v93
    v_and_b32 v4, 0xffff0000, v93
    v_mul_f32 v7, v205, v4
    v_mul_f32 v205, v205, v1
    v_fma_f32 v205, -v221, v4, v205
    v_mfma_f32_32x32x16_bf16 v[152:167], v[56:59], v[236:239], v[152:167]
    v_fma_f32 v221, v221, v1, v7
    v_lshlrev_b32 v1, 16, v94
    v_and_b32 v4, 0xffff0000, v94
    v_mul_f32 v7, v206, v4
    v_mul_f32 v206, v206, v1
    v_fma_f32 v206, -v222, v4, v206
    v_fma_f32 v222, v222, v1, v7
    v_lshlrev_b32 v1, 16, v95
    v_and_b32 v4, 0xffff0000, v95
    v_mul_f32 v7, v207, v4
    v_mul_f32 v207, v207, v1
    v_fma_f32 v207, -v223, v4, v207
    s_waitcnt lgkmcnt(0)
    ds_read_b128 v[232:235], v5 offset:0
    ds_read_b128 v[236:239], v5 offset:2048
    ds_read_b128 v[240:243], v5 offset:4096
    v_mfma_f32_32x32x16_bf16 v[136:151], v[64:67], v[244:247], v[136:151]
    v_fma_f32 v223, v223, v1, v7
    v_lshlrev_b32 v1, 16, v96
    v_and_b32 v4, 0xffff0000, v96
    v_mul_f32 v7, v208, v4
    v_mul_f32 v208, v208, v1
    v_fma_f32 v208, -v224, v4, v208
    v_fma_f32 v224, v224, v1, v7
    v_lshlrev_b32 v1, 16, v97
    v_and_b32 v4, 0xffff0000, v97
    v_mul_f32 v7, v209, v4
    v_mul_f32 v209, v209, v1
    v_fma_f32 v209, -v225, v4, v209
    v_mfma_f32_32x32x16_bf16 v[152:167], v[68:71], v[244:247], v[152:167]
    v_fma_f32 v225, v225, v1, v7
    v_lshlrev_b32 v1, 16, v98
    v_and_b32 v4, 0xffff0000, v98
    v_mul_f32 v7, v210, v4
    v_mul_f32 v210, v210, v1
    v_fma_f32 v210, -v226, v4, v210
    v_fma_f32 v226, v226, v1, v7
    v_lshlrev_b32 v1, 16, v99
    v_and_b32 v4, 0xffff0000, v99
    v_mul_f32 v7, v211, v4
    v_mul_f32 v211, v211, v1
    v_fma_f32 v211, -v227, v4, v211
    v_mfma_f32_32x32x16_bf16 v[136:151], v[68:71], v[252:255], v[136:151]
    v_fma_f32 v227, v227, v1, v7
    v_lshlrev_b32 v1, 16, v100
    v_and_b32 v4, 0xffff0000, v100
    v_mul_f32 v7, v212, v4
    v_mul_f32 v212, v212, v1
    v_fma_f32 v212, -v228, v4, v212
    v_fma_f32 v228, v228, v1, v7
    v_lshlrev_b32 v1, 16, v101
    v_and_b32 v4, 0xffff0000, v101
    v_mul_f32 v7, v213, v4
    v_mul_f32 v213, v213, v1
    v_fma_f32 v213, -v229, v4, v213
    v_mfma_f32_32x32x16_bf16 v[152:167], v[64:67], v[248:251], v[152:167]
    v_fma_f32 v229, v229, v1, v7
    v_lshlrev_b32 v1, 16, v102
    v_and_b32 v4, 0xffff0000, v102
    v_mul_f32 v7, v214, v4
    v_mul_f32 v214, v214, v1
    v_fma_f32 v214, -v230, v4, v214
    v_fma_f32 v230, v230, v1, v7
    v_lshlrev_b32 v1, 16, v103
    v_and_b32 v4, 0xffff0000, v103
    v_mul_f32 v7, v215, v4
    v_mul_f32 v215, v215, v1
    v_fma_f32 v215, -v231, v4, v215
    v_fma_f32 v231, v231, v1, v7
    v_cvt_pk_bf16_f32 v72, v168, v169
    v_cvt_pk_bf16_f32 v73, v170, v171
    v_cvt_pk_bf16_f32 v74, v172, v173
    v_cvt_pk_bf16_f32 v75, v174, v175
    v_cvt_pk_bf16_f32 v80, v176, v177
    v_cvt_pk_bf16_f32 v81, v178, v179
    v_cvt_pk_bf16_f32 v82, v180, v181
    v_cvt_pk_bf16_f32 v83, v182, v183
    v_cvt_pk_bf16_f32 v76, v184, v185
    v_cvt_pk_bf16_f32 v77, v186, v187
    v_cvt_pk_bf16_f32 v78, v188, v189
    v_cvt_pk_bf16_f32 v79, v190, v191
    v_cvt_pk_bf16_f32 v84, v192, v193
    v_cvt_pk_bf16_f32 v85, v194, v195
    v_cvt_pk_bf16_f32 v86, v196, v197
    v_cvt_pk_bf16_f32 v87, v198, v199
    v_cvt_pk_bf16_f32 v88, v200, v201
    v_cvt_pk_bf16_f32 v89, v202, v203
    v_cvt_pk_bf16_f32 v90, v204, v205
    v_cvt_pk_bf16_f32 v91, v206, v207
    v_cvt_pk_bf16_f32 v96, v208, v209
    v_cvt_pk_bf16_f32 v97, v210, v211
    v_cvt_pk_bf16_f32 v98, v212, v213
    v_cvt_pk_bf16_f32 v99, v214, v215
    v_cvt_pk_bf16_f32 v92, v216, v217
    v_cvt_pk_bf16_f32 v93, v218, v219
    v_cvt_pk_bf16_f32 v94, v220, v221
    v_cvt_pk_bf16_f32 v95, v222, v223
    v_cvt_pk_bf16_f32 v100, v224, v225
    v_cvt_pk_bf16_f32 v101, v226, v227
    v_cvt_pk_bf16_f32 v102, v228, v229
    v_cvt_pk_bf16_f32 v103, v230, v231
    v_and_b32 v6, 31, v2
    v_bfe_u32 v7, v2, 1, 3
    v_xor_b32 v7, s20, v7
    v_lshlrev_b32 v7, 3, v7
    v_lshl_add_u32 v6, v6, 6, v7
    v_lshrrev_b32 v7, 5, v2
    v_lshl_add_u32 v6, v7, 14, v6
    v_add_u32 v2, 0x10000, v6
    s_barrier
    s_waitcnt lgkmcnt(0)
    ds_read_b128 v[244:247], v5 offset:1024
    ds_read_b128 v[248:251], v5 offset:3072
    ds_read_b128 v[252:255], v5 offset:5120
    v_mfma_f32_32x32x16_bf16 v[168:183], v[72:75], v[232:235], 0
    v_add_f32 v1, v104, v136
    v_add_f32 v4, v120, v152
    v_sub_f32 v7, v104, v136
    v_sub_f32 v152, v120, v152
    v_mul_f32 v104, v1, v8
    v_mul_f32 v120, v4, v8
    v_mul_f32 v136, v7, v8
    v_fma_f32 v104, -v4, v24, v104
    v_fma_f32 v120, v1, v24, v120
    v_fma_f32 v136, -v152, v24, v136
    v_mul_f32 v152, v152, v8
    v_fma_f32 v152, v7, v24, v152
    v_mfma_f32_32x32x16_bf16 v[184:199], v[76:79], v[232:235], 0
    v_add_f32 v1, v105, v137
    v_add_f32 v4, v121, v153
    v_sub_f32 v7, v105, v137
    v_sub_f32 v153, v121, v153
    v_mul_f32 v105, v1, v9
    v_mul_f32 v121, v4, v9
    v_mul_f32 v137, v7, v9
    v_fma_f32 v105, -v4, v25, v105
    v_fma_f32 v121, v1, v25, v121
    v_fma_f32 v137, -v153, v25, v137
    v_mul_f32 v153, v153, v9
    v_fma_f32 v153, v7, v25, v153
    v_mfma_f32_32x32x16_bf16 v[168:183], v[76:79], v[240:243], v[168:183]
    v_add_f32 v1, v106, v138
    v_add_f32 v4, v122, v154
    v_sub_f32 v7, v106, v138
    v_sub_f32 v154, v122, v154
    v_mul_f32 v106, v1, v10
    v_mul_f32 v122, v4, v10
    v_mul_f32 v138, v7, v10
    v_fma_f32 v106, -v4, v26, v106
    v_fma_f32 v122, v1, v26, v122
    v_fma_f32 v138, -v154, v26, v138
    v_mul_f32 v154, v154, v10
    v_fma_f32 v154, v7, v26, v154
    v_mfma_f32_32x32x16_bf16 v[184:199], v[72:75], v[236:239], v[184:199]
    v_add_f32 v1, v107, v139
    v_add_f32 v4, v123, v155
    v_sub_f32 v7, v107, v139
    v_sub_f32 v155, v123, v155
    v_mul_f32 v107, v1, v11
    v_mul_f32 v123, v4, v11
    v_mul_f32 v139, v7, v11
    v_fma_f32 v107, -v4, v27, v107
    v_fma_f32 v123, v1, v27, v123
    v_fma_f32 v139, -v155, v27, v139
    v_mul_f32 v155, v155, v11
    v_fma_f32 v155, v7, v27, v155
    s_waitcnt lgkmcnt(0)
    ds_read_b128 v[232:235], v5 offset:12288
    ds_read_b128 v[236:239], v5 offset:14336
    ds_read_b128 v[240:243], v5 offset:16384
    v_mfma_f32_32x32x16_bf16 v[168:183], v[80:83], v[244:247], v[168:183]
    v_add_f32 v1, v108, v140
    v_add_f32 v4, v124, v156
    v_sub_f32 v7, v108, v140
    v_sub_f32 v156, v124, v156
    v_mul_f32 v108, v1, v12
    v_mul_f32 v124, v4, v12
    v_mul_f32 v140, v7, v12
    v_fma_f32 v108, -v4, v28, v108
    v_fma_f32 v124, v1, v28, v124
    v_fma_f32 v140, -v156, v28, v140
    v_mul_f32 v156, v156, v12
    v_fma_f32 v156, v7, v28, v156
    v_mfma_f32_32x32x16_bf16 v[184:199], v[84:87], v[244:247], v[184:199]
    v_add_f32 v1, v109, v141
    v_add_f32 v4, v125, v157
    v_sub_f32 v7, v109, v141
    v_sub_f32 v157, v125, v157
    v_mul_f32 v109, v1, v13
    v_mul_f32 v125, v4, v13
    v_mul_f32 v141, v7, v13
    v_fma_f32 v109, -v4, v29, v109
    v_fma_f32 v125, v1, v29, v125
    v_fma_f32 v141, -v157, v29, v141
    v_mul_f32 v157, v157, v13
    v_fma_f32 v157, v7, v29, v157
    v_mfma_f32_32x32x16_bf16 v[168:183], v[84:87], v[252:255], v[168:183]
    v_add_f32 v1, v110, v142
    v_add_f32 v4, v126, v158
    v_sub_f32 v7, v110, v142
    v_sub_f32 v158, v126, v158
    v_mul_f32 v110, v1, v14
    v_mul_f32 v126, v4, v14
    v_mul_f32 v142, v7, v14
    v_fma_f32 v110, -v4, v30, v110
    v_fma_f32 v126, v1, v30, v126
    v_fma_f32 v142, -v158, v30, v142
    v_mul_f32 v158, v158, v14
    v_fma_f32 v158, v7, v30, v158
    v_mfma_f32_32x32x16_bf16 v[184:199], v[80:83], v[248:251], v[184:199]
    v_add_f32 v1, v111, v143
    v_add_f32 v4, v127, v159
    v_sub_f32 v7, v111, v143
    v_sub_f32 v159, v127, v159
    v_mul_f32 v111, v1, v15
    v_mul_f32 v127, v4, v15
    v_mul_f32 v143, v7, v15
    v_fma_f32 v111, -v4, v31, v111
    v_fma_f32 v127, v1, v31, v127
    v_fma_f32 v143, -v159, v31, v143
    v_mul_f32 v159, v159, v15
    s_waitcnt lgkmcnt(0)
    ds_read_b128 v[244:247], v5 offset:13312
    ds_read_b128 v[248:251], v5 offset:15360
    ds_read_b128 v[252:255], v5 offset:17408
    v_mfma_f32_32x32x16_bf16 v[200:215], v[88:91], v[232:235], 0
    v_fma_f32 v159, v7, v31, v159
    v_add_f32 v1, v112, v144
    v_add_f32 v4, v128, v160
    v_sub_f32 v7, v112, v144
    v_sub_f32 v160, v128, v160
    v_mul_f32 v112, v1, v16
    v_mul_f32 v128, v4, v16
    v_mul_f32 v144, v7, v16
    v_fma_f32 v112, -v4, v32, v112
    v_fma_f32 v128, v1, v32, v128
    v_fma_f32 v144, -v160, v32, v144
    v_mul_f32 v160, v160, v16
    v_mfma_f32_32x32x16_bf16 v[216:231], v[92:95], v[232:235], 0
    v_fma_f32 v160, v7, v32, v160
    v_add_f32 v1, v113, v145
    v_add_f32 v4, v129, v161
    v_sub_f32 v7, v113, v145
    v_sub_f32 v161, v129, v161
    v_mul_f32 v113, v1, v17
    v_mul_f32 v129, v4, v17
    v_mul_f32 v145, v7, v17
    v_fma_f32 v113, -v4, v33, v113
    v_fma_f32 v129, v1, v33, v129
    v_fma_f32 v145, -v161, v33, v145
    v_mul_f32 v161, v161, v17
    v_mfma_f32_32x32x16_bf16 v[200:215], v[92:95], v[240:243], v[200:215]
    v_fma_f32 v161, v7, v33, v161
    v_add_f32 v1, v114, v146
    v_add_f32 v4, v130, v162
    v_sub_f32 v7, v114, v146
    v_sub_f32 v162, v130, v162
    v_mul_f32 v114, v1, v18
    v_mul_f32 v130, v4, v18
    v_mul_f32 v146, v7, v18
    v_fma_f32 v114, -v4, v34, v114
    v_fma_f32 v130, v1, v34, v130
    v_fma_f32 v146, -v162, v34, v146
    v_mul_f32 v162, v162, v18
    v_mfma_f32_32x32x16_bf16 v[216:231], v[88:91], v[236:239], v[216:231]
    v_fma_f32 v162, v7, v34, v162
    v_add_f32 v1, v115, v147
    v_add_f32 v4, v131, v163
    v_sub_f32 v7, v115, v147
    v_sub_f32 v163, v131, v163
    v_mul_f32 v115, v1, v19
    v_mul_f32 v131, v4, v19
    v_mul_f32 v147, v7, v19
    v_fma_f32 v115, -v4, v35, v115
    v_fma_f32 v131, v1, v35, v131
    v_fma_f32 v147, -v163, v35, v147
    v_mul_f32 v163, v163, v19
    s_waitcnt lgkmcnt(0)
    ds_read_b128 v[232:235], v5 offset:0
    ds_read_b128 v[236:239], v5 offset:2048
    ds_read_b128 v[240:243], v5 offset:4096
    v_mfma_f32_32x32x16_bf16 v[200:215], v[96:99], v[244:247], v[200:215]
    v_fma_f32 v163, v7, v35, v163
    v_add_f32 v1, v116, v148
    v_add_f32 v4, v132, v164
    v_sub_f32 v7, v116, v148
    v_sub_f32 v164, v132, v164
    v_mul_f32 v116, v1, v20
    v_mul_f32 v132, v4, v20
    v_mul_f32 v148, v7, v20
    v_fma_f32 v116, -v4, v36, v116
    v_fma_f32 v132, v1, v36, v132
    v_fma_f32 v148, -v164, v36, v148
    v_mul_f32 v164, v164, v20
    v_mfma_f32_32x32x16_bf16 v[216:231], v[100:103], v[244:247], v[216:231]
    v_fma_f32 v164, v7, v36, v164
    v_add_f32 v1, v117, v149
    v_add_f32 v4, v133, v165
    v_sub_f32 v7, v117, v149
    v_sub_f32 v165, v133, v165
    v_mul_f32 v117, v1, v21
    v_mul_f32 v133, v4, v21
    v_mul_f32 v149, v7, v21
    v_fma_f32 v117, -v4, v37, v117
    v_fma_f32 v133, v1, v37, v133
    v_fma_f32 v149, -v165, v37, v149
    v_mul_f32 v165, v165, v21
    v_mfma_f32_32x32x16_bf16 v[200:215], v[100:103], v[252:255], v[200:215]
    v_fma_f32 v165, v7, v37, v165
    v_add_f32 v1, v118, v150
    v_add_f32 v4, v134, v166
    v_sub_f32 v7, v118, v150
    v_sub_f32 v166, v134, v166
    v_mul_f32 v118, v1, v22
    v_mul_f32 v134, v4, v22
    v_mul_f32 v150, v7, v22
    v_fma_f32 v118, -v4, v38, v118
    v_fma_f32 v134, v1, v38, v134
    v_fma_f32 v150, -v166, v38, v150
    v_mul_f32 v166, v166, v22
    v_mfma_f32_32x32x16_bf16 v[216:231], v[96:99], v[248:251], v[216:231]
    v_fma_f32 v166, v7, v38, v166
    v_add_f32 v1, v119, v151
    v_add_f32 v4, v135, v167
    v_sub_f32 v7, v119, v151
    v_sub_f32 v167, v135, v167
    v_mul_f32 v119, v1, v23
    v_mul_f32 v135, v4, v23
    v_mul_f32 v151, v7, v23
    v_fma_f32 v119, -v4, v39, v119
    v_fma_f32 v135, v1, v39, v135
    v_fma_f32 v151, -v167, v39, v151
    v_mul_f32 v167, v167, v23
    v_fma_f32 v167, v7, v39, v167
    v_cvt_pk_bf16_f32 v40, v104, v105
    v_cvt_pk_bf16_f32 v41, v106, v107
    v_cvt_pk_bf16_f32 v42, v108, v109
    v_cvt_pk_bf16_f32 v43, v110, v111
    v_cvt_pk_bf16_f32 v48, v112, v113
    v_cvt_pk_bf16_f32 v49, v114, v115
    v_cvt_pk_bf16_f32 v50, v116, v117
    v_cvt_pk_bf16_f32 v51, v118, v119
    v_cvt_pk_bf16_f32 v44, v120, v121
    v_cvt_pk_bf16_f32 v45, v122, v123
    v_cvt_pk_bf16_f32 v46, v124, v125
    v_cvt_pk_bf16_f32 v47, v126, v127
    v_cvt_pk_bf16_f32 v52, v128, v129
    v_cvt_pk_bf16_f32 v53, v130, v131
    v_cvt_pk_bf16_f32 v54, v132, v133
    v_cvt_pk_bf16_f32 v55, v134, v135
    v_cvt_pk_bf16_f32 v56, v136, v137
    v_cvt_pk_bf16_f32 v57, v138, v139
    v_cvt_pk_bf16_f32 v58, v140, v141
    v_cvt_pk_bf16_f32 v59, v142, v143
    v_cvt_pk_bf16_f32 v64, v144, v145
    v_cvt_pk_bf16_f32 v65, v146, v147
    v_cvt_pk_bf16_f32 v66, v148, v149
    v_cvt_pk_bf16_f32 v67, v150, v151
    v_cvt_pk_bf16_f32 v60, v152, v153
    v_cvt_pk_bf16_f32 v61, v154, v155
    v_cvt_pk_bf16_f32 v62, v156, v157
    v_cvt_pk_bf16_f32 v63, v158, v159
    v_cvt_pk_bf16_f32 v68, v160, v161
    v_cvt_pk_bf16_f32 v69, v162, v163
    v_cvt_pk_bf16_f32 v70, v164, v165
    v_cvt_pk_bf16_f32 v71, v166, v167
    s_waitcnt lgkmcnt(0)
    ds_read_b128 v[244:247], v5 offset:1024
    ds_read_b128 v[248:251], v5 offset:3072
    ds_read_b128 v[252:255], v5 offset:5120
    v_mfma_f32_32x32x16_bf16 v[104:119], v[232:235], v[40:43], 0
    v_add_f32 v1, v168, v200
    v_add_f32 v4, v184, v216
    v_sub_f32 v7, v168, v200
    v_sub_f32 v216, v184, v216
    v_mul_f32 v168, v1, v8
    v_mul_f32 v184, v4, v8
    v_mul_f32 v200, v7, v8
    v_fma_f32 v168, -v4, v24, v168
    v_fma_f32 v184, v1, v24, v184
    v_fma_f32 v200, -v216, v24, v200
    v_mul_f32 v216, v216, v8
    v_fma_f32 v216, v7, v24, v216
    v_mfma_f32_32x32x16_bf16 v[120:135], v[232:235], v[44:47], 0
    v_add_f32 v1, v169, v201
    v_add_f32 v4, v185, v217
    v_sub_f32 v7, v169, v201
    v_sub_f32 v217, v185, v217
    v_mul_f32 v169, v1, v9
    v_mul_f32 v185, v4, v9
    v_mul_f32 v201, v7, v9
    v_fma_f32 v169, -v4, v25, v169
    v_fma_f32 v185, v1, v25, v185
    v_fma_f32 v201, -v217, v25, v201
    v_mul_f32 v217, v217, v9
    v_fma_f32 v217, v7, v25, v217
    v_mfma_f32_32x32x16_bf16 v[104:119], v[240:243], v[44:47], v[104:119]
    v_add_f32 v1, v170, v202
    v_add_f32 v4, v186, v218
    v_sub_f32 v7, v170, v202
    v_sub_f32 v218, v186, v218
    v_mul_f32 v170, v1, v10
    v_mul_f32 v186, v4, v10
    v_mul_f32 v202, v7, v10
    v_fma_f32 v170, -v4, v26, v170
    v_fma_f32 v186, v1, v26, v186
    v_fma_f32 v202, -v218, v26, v202
    v_mul_f32 v218, v218, v10
    v_fma_f32 v218, v7, v26, v218
    v_mfma_f32_32x32x16_bf16 v[120:135], v[236:239], v[40:43], v[120:135]
    v_add_f32 v1, v171, v203
    v_add_f32 v4, v187, v219
    v_sub_f32 v7, v171, v203
    v_sub_f32 v219, v187, v219
    v_mul_f32 v171, v1, v11
    v_mul_f32 v187, v4, v11
    v_mul_f32 v203, v7, v11
    v_fma_f32 v171, -v4, v27, v171
    v_fma_f32 v187, v1, v27, v187
    v_fma_f32 v203, -v219, v27, v203
    v_mul_f32 v219, v219, v11
    v_fma_f32 v219, v7, v27, v219
    s_waitcnt lgkmcnt(0)
    ds_read_b128 v[232:235], v5 offset:6144
    ds_read_b128 v[236:239], v5 offset:8192
    ds_read_b128 v[240:243], v5 offset:10240
    v_mfma_f32_32x32x16_bf16 v[104:119], v[244:247], v[48:51], v[104:119]
    v_add_f32 v1, v172, v204
    v_add_f32 v4, v188, v220
    v_sub_f32 v7, v172, v204
    v_sub_f32 v220, v188, v220
    v_mul_f32 v172, v1, v12
    v_mul_f32 v188, v4, v12
    v_mul_f32 v204, v7, v12
    v_fma_f32 v172, -v4, v28, v172
    v_fma_f32 v188, v1, v28, v188
    v_fma_f32 v204, -v220, v28, v204
    v_mul_f32 v220, v220, v12
    v_fma_f32 v220, v7, v28, v220
    v_mfma_f32_32x32x16_bf16 v[120:135], v[244:247], v[52:55], v[120:135]
    v_add_f32 v1, v173, v205
    v_add_f32 v4, v189, v221
    v_sub_f32 v7, v173, v205
    v_sub_f32 v221, v189, v221
    v_mul_f32 v173, v1, v13
    v_mul_f32 v189, v4, v13
    v_mul_f32 v205, v7, v13
    v_fma_f32 v173, -v4, v29, v173
    v_fma_f32 v189, v1, v29, v189
    v_fma_f32 v205, -v221, v29, v205
    v_mul_f32 v221, v221, v13
    v_fma_f32 v221, v7, v29, v221
    v_mfma_f32_32x32x16_bf16 v[104:119], v[252:255], v[52:55], v[104:119]
    v_add_f32 v1, v174, v206
    v_add_f32 v4, v190, v222
    v_sub_f32 v7, v174, v206
    v_sub_f32 v222, v190, v222
    v_mul_f32 v174, v1, v14
    v_mul_f32 v190, v4, v14
    v_mul_f32 v206, v7, v14
    v_fma_f32 v174, -v4, v30, v174
    v_fma_f32 v190, v1, v30, v190
    v_fma_f32 v206, -v222, v30, v206
    v_mul_f32 v222, v222, v14
    v_fma_f32 v222, v7, v30, v222
    v_mfma_f32_32x32x16_bf16 v[120:135], v[248:251], v[48:51], v[120:135]
    v_add_f32 v1, v175, v207
    v_add_f32 v4, v191, v223
    v_sub_f32 v7, v175, v207
    v_sub_f32 v223, v191, v223
    v_mul_f32 v175, v1, v15
    v_mul_f32 v191, v4, v15
    v_mul_f32 v207, v7, v15
    v_fma_f32 v175, -v4, v31, v175
    v_fma_f32 v191, v1, v31, v191
    v_fma_f32 v207, -v223, v31, v207
    v_mul_f32 v223, v223, v15
    s_waitcnt lgkmcnt(0)
    ds_read_b128 v[244:247], v5 offset:7168
    ds_read_b128 v[248:251], v5 offset:9216
    ds_read_b128 v[252:255], v5 offset:11264
    v_mfma_f32_32x32x16_bf16 v[136:151], v[232:235], v[56:59], 0
    v_fma_f32 v223, v7, v31, v223
    v_add_f32 v1, v176, v208
    v_add_f32 v4, v192, v224
    v_sub_f32 v7, v176, v208
    v_sub_f32 v224, v192, v224
    v_mul_f32 v176, v1, v16
    v_mul_f32 v192, v4, v16
    v_mul_f32 v208, v7, v16
    v_fma_f32 v176, -v4, v32, v176
    v_fma_f32 v192, v1, v32, v192
    v_fma_f32 v208, -v224, v32, v208
    v_mul_f32 v224, v224, v16
    v_mfma_f32_32x32x16_bf16 v[152:167], v[232:235], v[60:63], 0
    v_fma_f32 v224, v7, v32, v224
    v_add_f32 v1, v177, v209
    v_add_f32 v4, v193, v225
    v_sub_f32 v7, v177, v209
    v_sub_f32 v225, v193, v225
    v_mul_f32 v177, v1, v17
    v_mul_f32 v193, v4, v17
    v_mul_f32 v209, v7, v17
    v_fma_f32 v177, -v4, v33, v177
    v_fma_f32 v193, v1, v33, v193
    v_fma_f32 v209, -v225, v33, v209
    v_mul_f32 v225, v225, v17
    v_mfma_f32_32x32x16_bf16 v[136:151], v[240:243], v[60:63], v[136:151]
    v_fma_f32 v225, v7, v33, v225
    v_add_f32 v1, v178, v210
    v_add_f32 v4, v194, v226
    v_sub_f32 v7, v178, v210
    v_sub_f32 v226, v194, v226
    v_mul_f32 v178, v1, v18
    v_mul_f32 v194, v4, v18
    v_mul_f32 v210, v7, v18
    v_fma_f32 v178, -v4, v34, v178
    v_fma_f32 v194, v1, v34, v194
    v_fma_f32 v210, -v226, v34, v210
    v_mul_f32 v226, v226, v18
    v_mfma_f32_32x32x16_bf16 v[152:167], v[236:239], v[56:59], v[152:167]
    v_fma_f32 v226, v7, v34, v226
    v_add_f32 v1, v179, v211
    v_add_f32 v4, v195, v227
    v_sub_f32 v7, v179, v211
    v_sub_f32 v227, v195, v227
    v_mul_f32 v179, v1, v19
    v_mul_f32 v195, v4, v19
    v_mul_f32 v211, v7, v19
    v_fma_f32 v179, -v4, v35, v179
    v_fma_f32 v195, v1, v35, v195
    v_fma_f32 v211, -v227, v35, v211
    v_mul_f32 v227, v227, v19
    s_waitcnt lgkmcnt(0)
    ds_read_b128 v[232:235], v5 offset:0
    ds_read_b128 v[236:239], v5 offset:2048
    ds_read_b128 v[240:243], v5 offset:4096
    v_mfma_f32_32x32x16_bf16 v[136:151], v[244:247], v[64:67], v[136:151]
    v_fma_f32 v227, v7, v35, v227
    v_add_f32 v1, v180, v212
    v_add_f32 v4, v196, v228
    v_sub_f32 v7, v180, v212
    v_sub_f32 v228, v196, v228
    v_mul_f32 v180, v1, v20
    v_mul_f32 v196, v4, v20
    v_mul_f32 v212, v7, v20
    v_fma_f32 v180, -v4, v36, v180
    v_fma_f32 v196, v1, v36, v196
    v_fma_f32 v212, -v228, v36, v212
    v_mul_f32 v228, v228, v20
    v_mfma_f32_32x32x16_bf16 v[152:167], v[244:247], v[68:71], v[152:167]
    v_fma_f32 v228, v7, v36, v228
    v_add_f32 v1, v181, v213
    v_add_f32 v4, v197, v229
    v_sub_f32 v7, v181, v213
    v_sub_f32 v229, v197, v229
    v_mul_f32 v181, v1, v21
    v_mul_f32 v197, v4, v21
    v_mul_f32 v213, v7, v21
    v_fma_f32 v181, -v4, v37, v181
    v_fma_f32 v197, v1, v37, v197
    v_fma_f32 v213, -v229, v37, v213
    v_mul_f32 v229, v229, v21
    v_mfma_f32_32x32x16_bf16 v[136:151], v[252:255], v[68:71], v[136:151]
    v_fma_f32 v229, v7, v37, v229
    v_add_f32 v1, v182, v214
    v_add_f32 v4, v198, v230
    v_sub_f32 v7, v182, v214
    v_sub_f32 v230, v198, v230
    v_mul_f32 v182, v1, v22
    v_mul_f32 v198, v4, v22
    v_mul_f32 v214, v7, v22
    v_fma_f32 v182, -v4, v38, v182
    v_fma_f32 v198, v1, v38, v198
    v_fma_f32 v214, -v230, v38, v214
    v_mul_f32 v230, v230, v22
    v_mfma_f32_32x32x16_bf16 v[152:167], v[248:251], v[64:67], v[152:167]
    v_fma_f32 v230, v7, v38, v230
    v_add_f32 v1, v183, v215
    v_add_f32 v4, v199, v231
    v_sub_f32 v7, v183, v215
    v_sub_f32 v231, v199, v231
    v_mul_f32 v183, v1, v23
    v_mul_f32 v199, v4, v23
    v_mul_f32 v215, v7, v23
    v_fma_f32 v183, -v4, v39, v183
    v_fma_f32 v199, v1, v39, v199
    v_fma_f32 v215, -v231, v39, v215
    v_mul_f32 v231, v231, v23
    v_fma_f32 v231, v7, v39, v231
    v_cvt_pk_bf16_f32 v72, v168, v169
    v_cvt_pk_bf16_f32 v73, v170, v171
    v_cvt_pk_bf16_f32 v74, v172, v173
    v_cvt_pk_bf16_f32 v75, v174, v175
    v_cvt_pk_bf16_f32 v80, v176, v177
    v_cvt_pk_bf16_f32 v81, v178, v179
    v_cvt_pk_bf16_f32 v82, v180, v181
    v_cvt_pk_bf16_f32 v83, v182, v183
    v_cvt_pk_bf16_f32 v76, v184, v185
    v_cvt_pk_bf16_f32 v77, v186, v187
    v_cvt_pk_bf16_f32 v78, v188, v189
    v_cvt_pk_bf16_f32 v79, v190, v191
    v_cvt_pk_bf16_f32 v84, v192, v193
    v_cvt_pk_bf16_f32 v85, v194, v195
    v_cvt_pk_bf16_f32 v86, v196, v197
    v_cvt_pk_bf16_f32 v87, v198, v199
    v_cvt_pk_bf16_f32 v88, v200, v201
    v_cvt_pk_bf16_f32 v89, v202, v203
    v_cvt_pk_bf16_f32 v90, v204, v205
    v_cvt_pk_bf16_f32 v91, v206, v207
    v_cvt_pk_bf16_f32 v96, v208, v209
    v_cvt_pk_bf16_f32 v97, v210, v211
    v_cvt_pk_bf16_f32 v98, v212, v213
    v_cvt_pk_bf16_f32 v99, v214, v215
    v_cvt_pk_bf16_f32 v92, v216, v217
    v_cvt_pk_bf16_f32 v93, v218, v219
    v_cvt_pk_bf16_f32 v94, v220, v221
    v_cvt_pk_bf16_f32 v95, v222, v223
    v_cvt_pk_bf16_f32 v100, v224, v225
    v_cvt_pk_bf16_f32 v101, v226, v227
    v_cvt_pk_bf16_f32 v102, v228, v229
    v_cvt_pk_bf16_f32 v103, v230, v231
    s_cmp_lg_u32 s28, 0
    s_cbranch_scc1 L_aux_nsp2
    v_lshlrev_b32 v0, 3, v3
    s_mov_b32 s24, 0
    buffer_load_dwordx4 v[40:43], v0, s[4:7], s24 offen offset:16 sc1
    s_mov_b32 s24, 8192
    buffer_load_dwordx4 v[48:51], v0, s[4:7], s24 offen offset:16 sc1
    s_mov_b32 s24, 16384
    buffer_load_dwordx4 v[56:59], v0, s[4:7], s24 offen offset:16 sc1
    s_mov_b32 s24, 24576
    buffer_load_dwordx4 v[64:67], v0, s[4:7], s24 offen offset:16 sc1
L_aux_nsp2:
    s_waitcnt lgkmcnt(0)
    ds_read_b128 v[244:247], v5 offset:1024
    ds_read_b128 v[248:251], v5 offset:3072
    ds_read_b128 v[252:255], v5 offset:5120
    v_mfma_f32_32x32x16_bf16 v[168:183], v[232:235], v[72:75], 0
    v_cvt_pk_bf16_f32 v104, v104, v120
    ds_write_b32 v6, v104 offset:0
    v_cvt_pk_bf16_f32 v105, v105, v121
    v_mfma_f32_32x32x16_bf16 v[184:199], v[232:235], v[76:79], 0
    ds_write_b32 v6, v105 offset:4096
    v_cvt_pk_bf16_f32 v106, v106, v122
    v_mfma_f32_32x32x16_bf16 v[168:183], v[240:243], v[76:79], v[168:183]
    ds_write_b32 v6, v106 offset:8192
    v_cvt_pk_bf16_f32 v107, v107, v123
    ds_write_b32 v6, v107 offset:12288
    v_mfma_f32_32x32x16_bf16 v[184:199], v[236:239], v[72:75], v[184:199]
    v_cvt_pk_bf16_f32 v108, v108, v124
    ds_write_b32 v6, v108 offset:32768
    s_waitcnt lgkmcnt(0)
    ds_read_b128 v[232:235], v5 offset:6144
    ds_read_b128 v[236:239], v5 offset:8192
    ds_read_b128 v[240:243], v5 offset:10240
    v_mfma_f32_32x32x16_bf16 v[168:183], v[244:247], v[80:83], v[168:183]
    v_cvt_pk_bf16_f32 v109, v109, v125
    ds_write_b32 v6, v109 offset:36864
    v_mfma_f32_32x32x16_bf16 v[184:199], v[244:247], v[84:87], v[184:199]
    v_cvt_pk_bf16_f32 v110, v110, v126
    ds_write_b32 v6, v110 offset:40960
    v_cvt_pk_bf16_f32 v111, v111, v127
    v_mfma_f32_32x32x16_bf16 v[168:183], v[252:255], v[84:87], v[168:183]
    ds_write_b32 v6, v111 offset:45056
    v_cvt_pk_bf16_f32 v112, v112, v128
    v_mfma_f32_32x32x16_bf16 v[184:199], v[248:251], v[80:83], v[184:199]
    ds_write_b32 v2, v112 offset:0
    v_cvt_pk_bf16_f32 v113, v113, v129
    s_waitcnt lgkmcnt(0)
    ds_read_b128 v[244:247], v5 offset:7168
    ds_read_b128 v[248:251], v5 offset:9216
    ds_read_b128 v[252:255], v5 offset:11264
    v_mfma_f32_32x32x16_bf16 v[200:215], v[232:235], v[88:91], 0
    ds_write_b32 v2, v113 offset:4096
    v_cvt_pk_bf16_f32 v114, v114, v130
    ds_write_b32 v2, v114 offset:8192
    v_mfma_f32_32x32x16_bf16 v[216:231], v[232:235], v[92:95], 0
    v_cvt_pk_bf16_f32 v115, v115, v131
    ds_write_b32 v2, v115 offset:12288
    v_mfma_f32_32x32x16_bf16 v[200:215], v[240:243], v[92:95], v[200:215]
    v_cvt_pk_bf16_f32 v116, v116, v132
    ds_write_b32 v2, v116 offset:32768
    v_cvt_pk_bf16_f32 v117, v117, v133
    v_mfma_f32_32x32x16_bf16 v[216:231], v[236:239], v[88:91], v[216:231]
    ds_write_b32 v2, v117 offset:36864
    v_cvt_pk_bf16_f32 v118, v118, v134
    s_waitcnt lgkmcnt(0)
    ds_read_b128 v[232:235], v5 offset:0
    ds_read_b128 v[236:239], v5 offset:2048
    ds_read_b128 v[240:243], v5 offset:4096
    v_mfma_f32_32x32x16_bf16 v[200:215], v[244:247], v[96:99], v[200:215]
    ds_write_b32 v2, v118 offset:40960
    v_cvt_pk_bf16_f32 v119, v119, v135
    v_mfma_f32_32x32x16_bf16 v[216:231], v[244:247], v[100:103], v[216:231]
    ds_write_b32 v2, v119 offset:45056
    v_cvt_pk_bf16_f32 v136, v136, v152
    ds_write_b32 v6, v136 offset:2048
    v_mfma_f32_32x32x16_bf16 v[200:215], v[252:255], v[100:103], v[200:215]
    v_cvt_pk_bf16_f32 v137, v137, v153
    ds_write_b32 v6, v137 offset:6144
    v_mfma_f32_32x32x16_bf16 v[216:231], v[248:251], v[96:99], v[216:231]
    v_cvt_pk_bf16_f32 v138, v138, v154
    ds_write_b32 v6, v138 offset:10240
    v_cvt_pk_bf16_f32 v139, v139, v155
    ds_write_b32 v6, v139 offset:14336
    v_cvt_pk_bf16_f32 v140, v140, v156
    ds_write_b32 v6, v140 offset:34816
    v_cvt_pk_bf16_f32 v141, v141, v157
    ds_write_b32 v6, v141 offset:38912
    v_cvt_pk_bf16_f32 v142, v142, v158
    ds_write_b32 v6, v142 offset:43008
    v_cvt_pk_bf16_f32 v143, v143, v159
    ds_write_b32 v6, v143 offset:47104
    v_cvt_pk_bf16_f32 v144, v144, v160
    ds_write_b32 v2, v144 offset:2048
    v_cvt_pk_bf16_f32 v145, v145, v161
    ds_write_b32 v2, v145 offset:6144
    v_cvt_pk_bf16_f32 v146, v146, v162
    ds_write_b32 v2, v146 offset:10240
    v_cvt_pk_bf16_f32 v147, v147, v163
    ds_write_b32 v2, v147 offset:14336
    v_cvt_pk_bf16_f32 v148, v148, v164
    ds_write_b32 v2, v148 offset:34816
    v_cvt_pk_bf16_f32 v149, v149, v165
    ds_write_b32 v2, v149 offset:38912
    v_cvt_pk_bf16_f32 v150, v150, v166
    ds_write_b32 v2, v150 offset:43008
    v_cvt_pk_bf16_f32 v151, v151, v167
    ds_write_b32 v2, v151 offset:47104
    s_nop 11
    v_cvt_pk_bf16_f32 v168, v168, v184
    ds_write_b32 v6, v168 offset:4
    v_cvt_pk_bf16_f32 v169, v169, v185
    ds_write_b32 v6, v169 offset:4100
    v_cvt_pk_bf16_f32 v170, v170, v186
    ds_write_b32 v6, v170 offset:8196
    v_cvt_pk_bf16_f32 v171, v171, v187
    ds_write_b32 v6, v171 offset:12292
    v_cvt_pk_bf16_f32 v172, v172, v188
    ds_write_b32 v6, v172 offset:32772
    v_cvt_pk_bf16_f32 v173, v173, v189
    ds_write_b32 v6, v173 offset:36868
    v_cvt_pk_bf16_f32 v174, v174, v190
    ds_write_b32 v6, v174 offset:40964
    v_cvt_pk_bf16_f32 v175, v175, v191
    ds_write_b32 v6, v175 offset:45060
    v_cvt_pk_bf16_f32 v176, v176, v192
    ds_write_b32 v2, v176 offset:4
    v_cvt_pk_bf16_f32 v177, v177, v193
    ds_write_b32 v2, v177 offset:4100
    v_cvt_pk_bf16_f32 v178, v178, v194
    ds_write_b32 v2, v178 offset:8196
    v_cvt_pk_bf16_f32 v179, v179, v195
    ds_write_b32 v2, v179 offset:12292
    v_cvt_pk_bf16_f32 v180, v180, v196
    ds_write_b32 v2, v180 offset:32772
    v_cvt_pk_bf16_f32 v181, v181, v197
    ds_write_b32 v2, v181 offset:36868
    v_cvt_pk_bf16_f32 v182, v182, v198
    ds_write_b32 v2, v182 offset:40964
    v_cvt_pk_bf16_f32 v183, v183, v199
    ds_write_b32 v2, v183 offset:45060
    v_cvt_pk_bf16_f32 v200, v200, v216
    ds_write_b32 v6, v200 offset:2052
    v_cvt_pk_bf16_f32 v201, v201, v217
    ds_write_b32 v6, v201 offset:6148
    v_cvt_pk_bf16_f32 v202, v202, v218
    ds_write_b32 v6, v202 offset:10244
    v_cvt_pk_bf16_f32 v203, v203, v219
    ds_write_b32 v6, v203 offset:14340
    v_cvt_pk_bf16_f32 v204, v204, v220
    ds_write_b32 v6, v204 offset:34820
    v_cvt_pk_bf16_f32 v205, v205, v221
    ds_write_b32 v6, v205 offset:38916
    v_cvt_pk_bf16_f32 v206, v206, v222
    ds_write_b32 v6, v206 offset:43012
    v_cvt_pk_bf16_f32 v207, v207, v223
    ds_write_b32 v6, v207 offset:47108
    v_cvt_pk_bf16_f32 v208, v208, v224
    ds_write_b32 v2, v208 offset:2052
    v_cvt_pk_bf16_f32 v209, v209, v225
    ds_write_b32 v2, v209 offset:6148
    v_cvt_pk_bf16_f32 v210, v210, v226
    ds_write_b32 v2, v210 offset:10244
    v_cvt_pk_bf16_f32 v211, v211, v227
    ds_write_b32 v2, v211 offset:14340
    v_cvt_pk_bf16_f32 v212, v212, v228
    ds_write_b32 v2, v212 offset:34820
    v_cvt_pk_bf16_f32 v213, v213, v229
    ds_write_b32 v2, v213 offset:38916
    v_cvt_pk_bf16_f32 v214, v214, v230
    ds_write_b32 v2, v214 offset:43012
    v_cvt_pk_bf16_f32 v215, v215, v231
    ds_write_b32 v2, v215 offset:47108
    s_cmp_lg_u32 s28, 0
    s_cbranch_scc1 L_aux_nsp3
    v_mov_b32 v44, 0
    v_mov_b32 v45, 0
    v_mov_b32 v46, 0
    v_mov_b32 v47, 0
    v_mov_b32 v52, 0
    v_mov_b32 v53, 0
    v_mov_b32 v54, 0
    v_mov_b32 v55, 0
    v_mov_b32 v60, 0
    v_mov_b32 v61, 0
    v_mov_b32 v62, 0
    v_mov_b32 v63, 0
    v_mov_b32 v68, 0
    v_mov_b32 v69, 0
    v_mov_b32 v70, 0
    v_mov_b32 v71, 0
    v_add_u32 v0, 149504, v3
    s_waitcnt vmcnt(0)
    s_waitcnt lgkmcnt(0)
    ds_read_b128 v[244:247], v5 offset:1024
    ds_read_b128 v[248:251], v5 offset:3072
    ds_read_b128 v[252:255], v5 offset:5120
    v_mfma_f32_32x32x16_bf16 v[104:119], v[40:43], v[232:235], 0
    v_mfma_f32_32x32x16_bf16 v[120:135], v[44:47], v[232:235], 0
    v_mfma_f32_32x32x16_bf16 v[104:119], v[44:47], v[236:239], v[104:119]
    v_mfma_f32_32x32x16_bf16 v[120:135], v[40:43], v[240:243], v[120:135]
    s_waitcnt lgkmcnt(0)
    ds_read_b128 v[232:235], v5 offset:12288
    ds_read_b128 v[236:239], v5 offset:14336
    ds_read_b128 v[240:243], v5 offset:16384
    v_mfma_f32_32x32x16_bf16 v[104:119], v[48:51], v[244:247], v[104:119]
    v_mfma_f32_32x32x16_bf16 v[120:135], v[52:55], v[244:247], v[120:135]
    v_mfma_f32_32x32x16_bf16 v[104:119], v[52:55], v[248:251], v[104:119]
    v_mfma_f32_32x32x16_bf16 v[120:135], v[48:51], v[252:255], v[120:135]
    s_waitcnt lgkmcnt(0)
    ds_read_b128 v[244:247], v5 offset:13312
    ds_read_b128 v[248:251], v5 offset:15360
    ds_read_b128 v[252:255], v5 offset:17408
    v_mfma_f32_32x32x16_bf16 v[136:151], v[56:59], v[232:235], 0
    v_mfma_f32_32x32x16_bf16 v[152:167], v[60:63], v[232:235], 0
    v_mfma_f32_32x32x16_bf16 v[136:151], v[60:63], v[236:239], v[136:151]
    v_mfma_f32_32x32x16_bf16 v[152:167], v[56:59], v[240:243], v[152:167]
    s_waitcnt lgkmcnt(0)
    ds_read_b128 v[232:235], v5 offset:0
    ds_read_b128 v[236:239], v5 offset:2048
    ds_read_b128 v[240:243], v5 offset:4096
    v_mfma_f32_32x32x16_bf16 v[136:151], v[64:67], v[244:247], v[136:151]
    v_mfma_f32_32x32x16_bf16 v[152:167], v[68:71], v[244:247], v[152:167]
    v_mfma_f32_32x32x16_bf16 v[136:151], v[68:71], v[248:251], v[136:151]
    v_mfma_f32_32x32x16_bf16 v[152:167], v[64:67], v[252:255], v[152:167]
    s_nop 11
    v_add_f32 v1, v104, v136
    v_add_f32 v4, v120, v152
    v_sub_f32 v7, v104, v136
    v_sub_f32 v152, v120, v152
    v_mul_f32 v104, v1, v8
    v_mul_f32 v120, v4, v8
    v_mul_f32 v136, v7, v8
    v_fma_f32 v104, v4, v24, v104
    v_fma_f32 v120, -v1, v24, v120
    v_fma_f32 v136, v152, v24, v136
    v_mul_f32 v152, v152, v8
    v_fma_f32 v152, -v7, v24, v152
    v_add_f32 v1, v105, v137
    v_add_f32 v4, v121, v153
    v_sub_f32 v7, v105, v137
    v_sub_f32 v153, v121, v153
    v_mul_f32 v105, v1, v9
    v_mul_f32 v121, v4, v9
    v_mul_f32 v137, v7, v9
    v_fma_f32 v105, v4, v25, v105
    v_fma_f32 v121, -v1, v25, v121
    v_fma_f32 v137, v153, v25, v137
    v_mul_f32 v153, v153, v9
    v_fma_f32 v153, -v7, v25, v153
    v_add_f32 v1, v106, v138
    v_add_f32 v4, v122, v154
    v_sub_f32 v7, v106, v138
    v_sub_f32 v154, v122, v154
    v_mul_f32 v106, v1, v10
    v_mul_f32 v122, v4, v10
    v_mul_f32 v138, v7, v10
    v_fma_f32 v106, v4, v26, v106
    v_fma_f32 v122, -v1, v26, v122
    v_fma_f32 v138, v154, v26, v138
    v_mul_f32 v154, v154, v10
    v_fma_f32 v154, -v7, v26, v154
    v_add_f32 v1, v107, v139
    v_add_f32 v4, v123, v155
    v_sub_f32 v7, v107, v139
    v_sub_f32 v155, v123, v155
    v_mul_f32 v107, v1, v11
    v_mul_f32 v123, v4, v11
    v_mul_f32 v139, v7, v11
    v_fma_f32 v107, v4, v27, v107
    v_fma_f32 v123, -v1, v27, v123
    v_fma_f32 v139, v155, v27, v139
    v_mul_f32 v155, v155, v11
    v_fma_f32 v155, -v7, v27, v155
    v_add_f32 v1, v108, v140
    v_add_f32 v4, v124, v156
    v_sub_f32 v7, v108, v140
    v_sub_f32 v156, v124, v156
    v_mul_f32 v108, v1, v12
    v_mul_f32 v124, v4, v12
    v_mul_f32 v140, v7, v12
    v_fma_f32 v108, v4, v28, v108
    v_fma_f32 v124, -v1, v28, v124
    v_fma_f32 v140, v156, v28, v140
    v_mul_f32 v156, v156, v12
    v_fma_f32 v156, -v7, v28, v156
    v_add_f32 v1, v109, v141
    v_add_f32 v4, v125, v157
    v_sub_f32 v7, v109, v141
    v_sub_f32 v157, v125, v157
    v_mul_f32 v109, v1, v13
    v_mul_f32 v125, v4, v13
    v_mul_f32 v141, v7, v13
    v_fma_f32 v109, v4, v29, v109
    v_fma_f32 v125, -v1, v29, v125
    v_fma_f32 v141, v157, v29, v141
    v_mul_f32 v157, v157, v13
    v_fma_f32 v157, -v7, v29, v157
    v_add_f32 v1, v110, v142
    v_add_f32 v4, v126, v158
    v_sub_f32 v7, v110, v142
    v_sub_f32 v158, v126, v158
    v_mul_f32 v110, v1, v14
    v_mul_f32 v126, v4, v14
    v_mul_f32 v142, v7, v14
    v_fma_f32 v110, v4, v30, v110
    v_fma_f32 v126, -v1, v30, v126
    v_fma_f32 v142, v158, v30, v142
    v_mul_f32 v158, v158, v14
    v_fma_f32 v158, -v7, v30, v158
    v_add_f32 v1, v111, v143
    v_add_f32 v4, v127, v159
    v_sub_f32 v7, v111, v143
    v_sub_f32 v159, v127, v159
    v_mul_f32 v111, v1, v15
    v_mul_f32 v127, v4, v15
    v_mul_f32 v143, v7, v15
    v_fma_f32 v111, v4, v31, v111
    v_fma_f32 v127, -v1, v31, v127
    v_fma_f32 v143, v159, v31, v143
    v_mul_f32 v159, v159, v15
    v_fma_f32 v159, -v7, v31, v159
    v_add_f32 v1, v112, v144
    v_add_f32 v4, v128, v160
    v_sub_f32 v7, v112, v144
    v_sub_f32 v160, v128, v160
    v_mul_f32 v112, v1, v16
    v_mul_f32 v128, v4, v16
    v_mul_f32 v144, v7, v16
    v_fma_f32 v112, v4, v32, v112
    v_fma_f32 v128, -v1, v32, v128
    v_fma_f32 v144, v160, v32, v144
    v_mul_f32 v160, v160, v16
    v_fma_f32 v160, -v7, v32, v160
    v_add_f32 v1, v113, v145
    v_add_f32 v4, v129, v161
    v_sub_f32 v7, v113, v145
    v_sub_f32 v161, v129, v161
    v_mul_f32 v113, v1, v17
    v_mul_f32 v129, v4, v17
    v_mul_f32 v145, v7, v17
    v_fma_f32 v113, v4, v33, v113
    v_fma_f32 v129, -v1, v33, v129
    v_fma_f32 v145, v161, v33, v145
    v_mul_f32 v161, v161, v17
    v_fma_f32 v161, -v7, v33, v161
    v_add_f32 v1, v114, v146
    v_add_f32 v4, v130, v162
    v_sub_f32 v7, v114, v146
    v_sub_f32 v162, v130, v162
    v_mul_f32 v114, v1, v18
    v_mul_f32 v130, v4, v18
    v_mul_f32 v146, v7, v18
    v_fma_f32 v114, v4, v34, v114
    v_fma_f32 v130, -v1, v34, v130
    v_fma_f32 v146, v162, v34, v146
    v_mul_f32 v162, v162, v18
    v_fma_f32 v162, -v7, v34, v162
    v_add_f32 v1, v115, v147
    v_add_f32 v4, v131, v163
    v_sub_f32 v7, v115, v147
    v_sub_f32 v163, v131, v163
    v_mul_f32 v115, v1, v19
    v_mul_f32 v131, v4, v19
    v_mul_f32 v147, v7, v19
    v_fma_f32 v115, v4, v35, v115
    v_fma_f32 v131, -v1, v35, v131
    v_fma_f32 v147, v163, v35, v147
    v_mul_f32 v163, v163, v19
    v_fma_f32 v163, -v7, v35, v163
    v_add_f32 v1, v116, v148
    v_add_f32 v4, v132, v164
    v_sub_f32 v7, v116, v148
    v_sub_f32 v164, v132, v164
    v_mul_f32 v116, v1, v20
    v_mul_f32 v132, v4, v20
    v_mul_f32 v148, v7, v20
    v_fma_f32 v116, v4, v36, v116
    v_fma_f32 v132, -v1, v36, v132
    v_fma_f32 v148, v164, v36, v148
    v_mul_f32 v164, v164, v20
    v_fma_f32 v164, -v7, v36, v164
    v_add_f32 v1, v117, v149
    v_add_f32 v4, v133, v165
    v_sub_f32 v7, v117, v149
    v_sub_f32 v165, v133, v165
    v_mul_f32 v117, v1, v21
    v_mul_f32 v133, v4, v21
    v_mul_f32 v149, v7, v21
    v_fma_f32 v117, v4, v37, v117
    v_fma_f32 v133, -v1, v37, v133
    v_fma_f32 v149, v165, v37, v149
    v_mul_f32 v165, v165, v21
    v_fma_f32 v165, -v7, v37, v165
    v_add_f32 v1, v118, v150
    v_add_f32 v4, v134, v166
    v_sub_f32 v7, v118, v150
    v_sub_f32 v166, v134, v166
    v_mul_f32 v118, v1, v22
    v_mul_f32 v134, v4, v22
    v_mul_f32 v150, v7, v22
    v_fma_f32 v118, v4, v38, v118
    v_fma_f32 v134, -v1, v38, v134
    v_fma_f32 v150, v166, v38, v150
    v_mul_f32 v166, v166, v22
    v_fma_f32 v166, -v7, v38, v166
    v_add_f32 v1, v119, v151
    v_add_f32 v4, v135, v167
    v_sub_f32 v7, v119, v151
    v_sub_f32 v167, v135, v167
    v_mul_f32 v119, v1, v23
    v_mul_f32 v135, v4, v23
    v_mul_f32 v151, v7, v23
    v_fma_f32 v119, v4, v39, v119
    v_fma_f32 v135, -v1, v39, v135
    v_fma_f32 v151, v167, v39, v151
    v_mul_f32 v167, v167, v23
    v_fma_f32 v167, -v7, v39, v167
    v_cvt_pk_bf16_f32 v40, v104, v105
    v_cvt_pk_bf16_f32 v41, v106, v107
    v_cvt_pk_bf16_f32 v42, v108, v109
    v_cvt_pk_bf16_f32 v43, v110, v111
    v_cvt_pk_bf16_f32 v48, v112, v113
    v_cvt_pk_bf16_f32 v49, v114, v115
    v_cvt_pk_bf16_f32 v50, v116, v117
    v_cvt_pk_bf16_f32 v51, v118, v119
    v_cvt_pk_bf16_f32 v44, v120, v121
    v_cvt_pk_bf16_f32 v45, v122, v123
    v_cvt_pk_bf16_f32 v46, v124, v125
    v_cvt_pk_bf16_f32 v47, v126, v127
    v_cvt_pk_bf16_f32 v52, v128, v129
    v_cvt_pk_bf16_f32 v53, v130, v131
    v_cvt_pk_bf16_f32 v54, v132, v133
    v_cvt_pk_bf16_f32 v55, v134, v135
    v_cvt_pk_bf16_f32 v56, v136, v137
    v_cvt_pk_bf16_f32 v57, v138, v139
    v_cvt_pk_bf16_f32 v58, v140, v141
    v_cvt_pk_bf16_f32 v59, v142, v143
    v_cvt_pk_bf16_f32 v64, v144, v145
    v_cvt_pk_bf16_f32 v65, v146, v147
    v_cvt_pk_bf16_f32 v66, v148, v149
    v_cvt_pk_bf16_f32 v67, v150, v151
    v_cvt_pk_bf16_f32 v60, v152, v153
    v_cvt_pk_bf16_f32 v61, v154, v155
    v_cvt_pk_bf16_f32 v62, v156, v157
    v_cvt_pk_bf16_f32 v63, v158, v159
    v_cvt_pk_bf16_f32 v68, v160, v161
    v_cvt_pk_bf16_f32 v69, v162, v163
    v_cvt_pk_bf16_f32 v70, v164, v165
    v_cvt_pk_bf16_f32 v71, v166, v167
    s_nop 1
    s_waitcnt lgkmcnt(0)
    ds_read_b128 v[244:247], v5 offset:1024
    ds_read_b128 v[248:251], v5 offset:3072
    ds_read_b128 v[252:255], v5 offset:5120
    v_mfma_f32_32x32x16_bf16 v[104:119], v[232:235], v[40:43], 0
    v_mfma_f32_32x32x16_bf16 v[120:135], v[232:235], v[44:47], 0
    v_mfma_f32_32x32x16_bf16 v[104:119], v[236:239], v[44:47], v[104:119]
    v_mfma_f32_32x32x16_bf16 v[120:135], v[240:243], v[40:43], v[120:135]
    s_waitcnt lgkmcnt(0)
    ds_read_b128 v[232:235], v5 offset:6144
    ds_read_b128 v[236:239], v5 offset:8192
    ds_read_b128 v[240:243], v5 offset:10240
    v_mfma_f32_32x32x16_bf16 v[104:119], v[244:247], v[48:51], v[104:119]
    v_mfma_f32_32x32x16_bf16 v[120:135], v[244:247], v[52:55], v[120:135]
    v_mfma_f32_32x32x16_bf16 v[104:119], v[248:251], v[52:55], v[104:119]
    v_mfma_f32_32x32x16_bf16 v[120:135], v[252:255], v[48:51], v[120:135]
    s_waitcnt lgkmcnt(0)
    ds_read_b128 v[244:247], v5 offset:7168
    ds_read_b128 v[248:251], v5 offset:9216
    ds_read_b128 v[252:255], v5 offset:11264
    v_mfma_f32_32x32x16_bf16 v[136:151], v[232:235], v[56:59], 0
    v_mfma_f32_32x32x16_bf16 v[152:167], v[232:235], v[60:63], 0
    v_mfma_f32_32x32x16_bf16 v[136:151], v[236:239], v[60:63], v[136:151]
    v_mfma_f32_32x32x16_bf16 v[152:167], v[240:243], v[56:59], v[152:167]
    s_waitcnt lgkmcnt(0)
    ds_read_b128 v[232:235], v5 offset:0
    ds_read_b128 v[236:239], v5 offset:2048
    ds_read_b128 v[240:243], v5 offset:4096
    v_mfma_f32_32x32x16_bf16 v[136:151], v[244:247], v[64:67], v[136:151]
    v_mfma_f32_32x32x16_bf16 v[152:167], v[244:247], v[68:71], v[152:167]
    v_mfma_f32_32x32x16_bf16 v[136:151], v[248:251], v[68:71], v[136:151]
    v_mfma_f32_32x32x16_bf16 v[152:167], v[252:255], v[64:67], v[152:167]
    ds_read_b128 v[40:43], v0 offset:0
    ds_read_b128 v[44:47], v0 offset:1024
    ds_read_b128 v[48:51], v0 offset:2048
    ds_read_b128 v[52:55], v0 offset:3072
    ds_read_b128 v[56:59], v0 offset:4096
    ds_read_b128 v[60:63], v0 offset:5120
    ds_read_b128 v[64:67], v0 offset:6144
    ds_read_b128 v[68:71], v0 offset:7168
    s_nop 3
    s_waitcnt lgkmcnt(0)
    v_lshlrev_b32 v1, 16, v40
    v_and_b32 v4, 0xffff0000, v40
    v_mul_f32 v7, v104, v4
    v_mul_f32 v104, v104, v1
    v_fma_f32 v104, -v120, v4, v104
    v_fma_f32 v120, v120, v1, v7
    v_lshlrev_b32 v1, 16, v41
    v_and_b32 v4, 0xffff0000, v41
    v_mul_f32 v7, v105, v4
    v_mul_f32 v105, v105, v1
    v_fma_f32 v105, -v121, v4, v105
    v_fma_f32 v121, v121, v1, v7
    v_lshlrev_b32 v1, 16, v42
    v_and_b32 v4, 0xffff0000, v42
    v_mul_f32 v7, v106, v4
    v_mul_f32 v106, v106, v1
    v_fma_f32 v106, -v122, v4, v106
    v_fma_f32 v122, v122, v1, v7
    v_lshlrev_b32 v1, 16, v43
    v_and_b32 v4, 0xffff0000, v43
    v_mul_f32 v7, v107, v4
    v_mul_f32 v107, v107, v1
    v_fma_f32 v107, -v123, v4, v107
    v_fma_f32 v123, v123, v1, v7
    v_lshlrev_b32 v1, 16, v44
    v_and_b32 v4, 0xffff0000, v44
    v_mul_f32 v7, v108, v4
    v_mul_f32 v108, v108, v1
    v_fma_f32 v108, -v124, v4, v108
    v_fma_f32 v124, v124, v1, v7
    v_lshlrev_b32 v1, 16, v45
    v_and_b32 v4, 0xffff0000, v45
    v_mul_f32 v7, v109, v4
    v_mul_f32 v109, v109, v1
    v_fma_f32 v109, -v125, v4, v109
    v_fma_f32 v125, v125, v1, v7
    v_lshlrev_b32 v1, 16, v46
    v_and_b32 v4, 0xffff0000, v46
    v_mul_f32 v7, v110, v4
    v_mul_f32 v110, v110, v1
    v_fma_f32 v110, -v126, v4, v110
    v_fma_f32 v126, v126, v1, v7
    v_lshlrev_b32 v1, 16, v47
    v_and_b32 v4, 0xffff0000, v47
    v_mul_f32 v7, v111, v4
    v_mul_f32 v111, v111, v1
    v_fma_f32 v111, -v127, v4, v111
    v_fma_f32 v127, v127, v1, v7
    v_lshlrev_b32 v1, 16, v48
    v_and_b32 v4, 0xffff0000, v48
    v_mul_f32 v7, v112, v4
    v_mul_f32 v112, v112, v1
    v_fma_f32 v112, -v128, v4, v112
    v_fma_f32 v128, v128, v1, v7
    v_lshlrev_b32 v1, 16, v49
    v_and_b32 v4, 0xffff0000, v49
    v_mul_f32 v7, v113, v4
    v_mul_f32 v113, v113, v1
    v_fma_f32 v113, -v129, v4, v113
    v_fma_f32 v129, v129, v1, v7
    v_lshlrev_b32 v1, 16, v50
    v_and_b32 v4, 0xffff0000, v50
    v_mul_f32 v7, v114, v4
    v_mul_f32 v114, v114, v1
    v_fma_f32 v114, -v130, v4, v114
    v_fma_f32 v130, v130, v1, v7
    v_lshlrev_b32 v1, 16, v51
    v_and_b32 v4, 0xffff0000, v51
    v_mul_f32 v7, v115, v4
    v_mul_f32 v115, v115, v1
    v_fma_f32 v115, -v131, v4, v115
    v_fma_f32 v131, v131, v1, v7
    v_lshlrev_b32 v1, 16, v52
    v_and_b32 v4, 0xffff0000, v52
    v_mul_f32 v7, v116, v4
    v_mul_f32 v116, v116, v1
    v_fma_f32 v116, -v132, v4, v116
    v_fma_f32 v132, v132, v1, v7
    v_lshlrev_b32 v1, 16, v53
    v_and_b32 v4, 0xffff0000, v53
    v_mul_f32 v7, v117, v4
    v_mul_f32 v117, v117, v1
    v_fma_f32 v117, -v133, v4, v117
    v_fma_f32 v133, v133, v1, v7
    v_lshlrev_b32 v1, 16, v54
    v_and_b32 v4, 0xffff0000, v54
    v_mul_f32 v7, v118, v4
    v_mul_f32 v118, v118, v1
    v_fma_f32 v118, -v134, v4, v118
    v_fma_f32 v134, v134, v1, v7
    v_lshlrev_b32 v1, 16, v55
    v_and_b32 v4, 0xffff0000, v55
    v_mul_f32 v7, v119, v4
    v_mul_f32 v119, v119, v1
    v_fma_f32 v119, -v135, v4, v119
    v_fma_f32 v135, v135, v1, v7
    v_lshlrev_b32 v1, 16, v56
    v_and_b32 v4, 0xffff0000, v56
    v_mul_f32 v7, v136, v4
    v_mul_f32 v136, v136, v1
    v_fma_f32 v136, -v152, v4, v136
    v_fma_f32 v152, v152, v1, v7
    v_lshlrev_b32 v1, 16, v57
    v_and_b32 v4, 0xffff0000, v57
    v_mul_f32 v7, v137, v4
    v_mul_f32 v137, v137, v1
    v_fma_f32 v137, -v153, v4, v137
    v_fma_f32 v153, v153, v1, v7
    v_lshlrev_b32 v1, 16, v58
    v_and_b32 v4, 0xffff0000, v58
    v_mul_f32 v7, v138, v4
    v_mul_f32 v138, v138, v1
    v_fma_f32 v138, -v154, v4, v138
    v_fma_f32 v154, v154, v1, v7
    v_lshlrev_b32 v1, 16, v59
    v_and_b32 v4, 0xffff0000, v59
    v_mul_f32 v7, v139, v4
    v_mul_f32 v139, v139, v1
    v_fma_f32 v139, -v155, v4, v139
    v_fma_f32 v155, v155, v1, v7
    v_lshlrev_b32 v1, 16, v60
    v_and_b32 v4, 0xffff0000, v60
    v_mul_f32 v7, v140, v4
    v_mul_f32 v140, v140, v1
    v_fma_f32 v140, -v156, v4, v140
    v_fma_f32 v156, v156, v1, v7
    v_lshlrev_b32 v1, 16, v61
    v_and_b32 v4, 0xffff0000, v61
    v_mul_f32 v7, v141, v4
    v_mul_f32 v141, v141, v1
    v_fma_f32 v141, -v157, v4, v141
    v_fma_f32 v157, v157, v1, v7
    v_lshlrev_b32 v1, 16, v62
    v_and_b32 v4, 0xffff0000, v62
    v_mul_f32 v7, v142, v4
    v_mul_f32 v142, v142, v1
    v_fma_f32 v142, -v158, v4, v142
    v_fma_f32 v158, v158, v1, v7
    v_lshlrev_b32 v1, 16, v63
    v_and_b32 v4, 0xffff0000, v63
    v_mul_f32 v7, v143, v4
    v_mul_f32 v143, v143, v1
    v_fma_f32 v143, -v159, v4, v143
    v_fma_f32 v159, v159, v1, v7
    v_lshlrev_b32 v1, 16, v64
    v_and_b32 v4, 0xffff0000, v64
    v_mul_f32 v7, v144, v4
    v_mul_f32 v144, v144, v1
    v_fma_f32 v144, -v160, v4, v144
    v_fma_f32 v160, v160, v1, v7
    v_lshlrev_b32 v1, 16, v65
    v_and_b32 v4, 0xffff0000, v65
    v_mul_f32 v7, v145, v4
    v_mul_f32 v145, v145, v1
    v_fma_f32 v145, -v161, v4, v145
    v_fma_f32 v161, v161, v1, v7
    v_lshlrev_b32 v1, 16, v66
    v_and_b32 v4, 0xffff0000, v66
    v_mul_f32 v7, v146, v4
    v_mul_f32 v146, v146, v1
    v_fma_f32 v146, -v162, v4, v146
    v_fma_f32 v162, v162, v1, v7
    v_lshlrev_b32 v1, 16, v67
    v_and_b32 v4, 0xffff0000, v67
    v_mul_f32 v7, v147, v4
    v_mul_f32 v147, v147, v1
    v_fma_f32 v147, -v163, v4, v147
    v_fma_f32 v163, v163, v1, v7
    v_lshlrev_b32 v1, 16, v68
    v_and_b32 v4, 0xffff0000, v68
    v_mul_f32 v7, v148, v4
    v_mul_f32 v148, v148, v1
    v_fma_f32 v148, -v164, v4, v148
    v_fma_f32 v164, v164, v1, v7
    v_lshlrev_b32 v1, 16, v69
    v_and_b32 v4, 0xffff0000, v69
    v_mul_f32 v7, v149, v4
    v_mul_f32 v149, v149, v1
    v_fma_f32 v149, -v165, v4, v149
    v_fma_f32 v165, v165, v1, v7
    v_lshlrev_b32 v1, 16, v70
    v_and_b32 v4, 0xffff0000, v70
    v_mul_f32 v7, v150, v4
    v_mul_f32 v150, v150, v1
    v_fma_f32 v150, -v166, v4, v150
    v_fma_f32 v166, v166, v1, v7
    v_lshlrev_b32 v1, 16, v71
    v_and_b32 v4, 0xffff0000, v71
    v_mul_f32 v7, v151, v4
    v_mul_f32 v151, v151, v1
    v_fma_f32 v151, -v167, v4, v151
    v_fma_f32 v167, v167, v1, v7
    v_cvt_pk_bf16_f32 v40, v104, v105
    v_cvt_pk_bf16_f32 v41, v106, v107
    v_cvt_pk_bf16_f32 v42, v108, v109
    v_cvt_pk_bf16_f32 v43, v110, v111
    v_cvt_pk_bf16_f32 v48, v112, v113
    v_cvt_pk_bf16_f32 v49, v114, v115
    v_cvt_pk_bf16_f32 v50, v116, v117
    v_cvt_pk_bf16_f32 v51, v118, v119
    v_cvt_pk_bf16_f32 v44, v120, v121
    v_cvt_pk_bf16_f32 v45, v122, v123
    v_cvt_pk_bf16_f32 v46, v124, v125
    v_cvt_pk_bf16_f32 v47, v126, v127
    v_cvt_pk_bf16_f32 v52, v128, v129
    v_cvt_pk_bf16_f32 v53, v130, v131
    v_cvt_pk_bf16_f32 v54, v132, v133
    v_cvt_pk_bf16_f32 v55, v134, v135
    v_cvt_pk_bf16_f32 v56, v136, v137
    v_cvt_pk_bf16_f32 v57, v138, v139
    v_cvt_pk_bf16_f32 v58, v140, v141
    v_cvt_pk_bf16_f32 v59, v142, v143
    v_cvt_pk_bf16_f32 v64, v144, v145
    v_cvt_pk_bf16_f32 v65, v146, v147
    v_cvt_pk_bf16_f32 v66, v148, v149
    v_cvt_pk_bf16_f32 v67, v150, v151
    v_cvt_pk_bf16_f32 v60, v152, v153
    v_cvt_pk_bf16_f32 v61, v154, v155
    v_cvt_pk_bf16_f32 v62, v156, v157
    v_cvt_pk_bf16_f32 v63, v158, v159
    v_cvt_pk_bf16_f32 v68, v160, v161
    v_cvt_pk_bf16_f32 v69, v162, v163
    v_cvt_pk_bf16_f32 v70, v164, v165
    v_cvt_pk_bf16_f32 v71, v166, v167
    s_nop 1
    s_waitcnt lgkmcnt(0)
    ds_read_b128 v[244:247], v5 offset:1024
    ds_read_b128 v[248:251], v5 offset:3072
    ds_read_b128 v[252:255], v5 offset:5120
    v_mfma_f32_32x32x16_bf16 v[104:119], v[40:43], v[232:235], 0
    v_mfma_f32_32x32x16_bf16 v[120:135], v[44:47], v[232:235], 0
    v_mfma_f32_32x32x16_bf16 v[104:119], v[44:47], v[240:243], v[104:119]
    v_mfma_f32_32x32x16_bf16 v[120:135], v[40:43], v[236:239], v[120:135]
    s_waitcnt lgkmcnt(0)
    ds_read_b128 v[232:235], v5 offset:12288
    ds_read_b128 v[236:239], v5 offset:14336
    ds_read_b128 v[240:243], v5 offset:16384
    v_mfma_f32_32x32x16_bf16 v[104:119], v[48:51], v[244:247], v[104:119]
    v_mfma_f32_32x32x16_bf16 v[120:135], v[52:55], v[244:247], v[120:135]
    v_mfma_f32_32x32x16_bf16 v[104:119], v[52:55], v[252:255], v[104:119]
    v_mfma_f32_32x32x16_bf16 v[120:135], v[48:51], v[248:251], v[120:135]
    s_waitcnt lgkmcnt(0)
    ds_read_b128 v[244:247], v5 offset:13312
    ds_read_b128 v[248:251], v5 offset:15360
    ds_read_b128 v[252:255], v5 offset:17408
    v_mfma_f32_32x32x16_bf16 v[136:151], v[56:59], v[232:235], 0
    v_mfma_f32_32x32x16_bf16 v[152:167], v[60:63], v[232:235], 0
    v_mfma_f32_32x32x16_bf16 v[136:151], v[60:63], v[240:243], v[136:151]
    v_mfma_f32_32x32x16_bf16 v[152:167], v[56:59], v[236:239], v[152:167]
    s_waitcnt lgkmcnt(0)
    ds_read_b128 v[232:235], v5 offset:0
    ds_read_b128 v[236:239], v5 offset:2048
    ds_read_b128 v[240:243], v5 offset:4096
    v_mfma_f32_32x32x16_bf16 v[136:151], v[64:67], v[244:247], v[136:151]
    v_mfma_f32_32x32x16_bf16 v[152:167], v[68:71], v[244:247], v[152:167]
    v_mfma_f32_32x32x16_bf16 v[136:151], v[68:71], v[252:255], v[136:151]
    v_mfma_f32_32x32x16_bf16 v[152:167], v[64:67], v[248:251], v[152:167]
    s_nop 11
    v_add_f32 v1, v104, v136
    v_add_f32 v4, v120, v152
    v_sub_f32 v7, v104, v136
    v_sub_f32 v152, v120, v152
    v_mul_f32 v104, v1, v8
    v_mul_f32 v120, v4, v8
    v_mul_f32 v136, v7, v8
    v_fma_f32 v104, -v4, v24, v104
    v_fma_f32 v120, v1, v24, v120
    v_fma_f32 v136, -v152, v24, v136
    v_mul_f32 v152, v152, v8
    v_fma_f32 v152, v7, v24, v152
    v_add_f32 v1, v105, v137
    v_add_f32 v4, v121, v153
    v_sub_f32 v7, v105, v137
    v_sub_f32 v153, v121, v153
    v_mul_f32 v105, v1, v9
    v_mul_f32 v121, v4, v9
    v_mul_f32 v137, v7, v9
    v_fma_f32 v105, -v4, v25, v105
    v_fma_f32 v121, v1, v25, v121
    v_fma_f32 v137, -v153, v25, v137
    v_mul_f32 v153, v153, v9
    v_fma_f32 v153, v7, v25, v153
    v_add_f32 v1, v106, v138
    v_add_f32 v4, v122, v154
    v_sub_f32 v7, v106, v138
    v_sub_f32 v154, v122, v154
    v_mul_f32 v106, v1, v10
    v_mul_f32 v122, v4, v10
    v_mul_f32 v138, v7, v10
    v_fma_f32 v106, -v4, v26, v106
    v_fma_f32 v122, v1, v26, v122
    v_fma_f32 v138, -v154, v26, v138
    v_mul_f32 v154, v154, v10
    v_fma_f32 v154, v7, v26, v154
    v_add_f32 v1, v107, v139
    v_add_f32 v4, v123, v155
    v_sub_f32 v7, v107, v139
    v_sub_f32 v155, v123, v155
    v_mul_f32 v107, v1, v11
    v_mul_f32 v123, v4, v11
    v_mul_f32 v139, v7, v11
    v_fma_f32 v107, -v4, v27, v107
    v_fma_f32 v123, v1, v27, v123
    v_fma_f32 v139, -v155, v27, v139
    v_mul_f32 v155, v155, v11
    v_fma_f32 v155, v7, v27, v155
    v_add_f32 v1, v108, v140
    v_add_f32 v4, v124, v156
    v_sub_f32 v7, v108, v140
    v_sub_f32 v156, v124, v156
    v_mul_f32 v108, v1, v12
    v_mul_f32 v124, v4, v12
    v_mul_f32 v140, v7, v12
    v_fma_f32 v108, -v4, v28, v108
    v_fma_f32 v124, v1, v28, v124
    v_fma_f32 v140, -v156, v28, v140
    v_mul_f32 v156, v156, v12
    v_fma_f32 v156, v7, v28, v156
    v_add_f32 v1, v109, v141
    v_add_f32 v4, v125, v157
    v_sub_f32 v7, v109, v141
    v_sub_f32 v157, v125, v157
    v_mul_f32 v109, v1, v13
    v_mul_f32 v125, v4, v13
    v_mul_f32 v141, v7, v13
    v_fma_f32 v109, -v4, v29, v109
    v_fma_f32 v125, v1, v29, v125
    v_fma_f32 v141, -v157, v29, v141
    v_mul_f32 v157, v157, v13
    v_fma_f32 v157, v7, v29, v157
    v_add_f32 v1, v110, v142
    v_add_f32 v4, v126, v158
    v_sub_f32 v7, v110, v142
    v_sub_f32 v158, v126, v158
    v_mul_f32 v110, v1, v14
    v_mul_f32 v126, v4, v14
    v_mul_f32 v142, v7, v14
    v_fma_f32 v110, -v4, v30, v110
    v_fma_f32 v126, v1, v30, v126
    v_fma_f32 v142, -v158, v30, v142
    v_mul_f32 v158, v158, v14
    v_fma_f32 v158, v7, v30, v158
    v_add_f32 v1, v111, v143
    v_add_f32 v4, v127, v159
    v_sub_f32 v7, v111, v143
    v_sub_f32 v159, v127, v159
    v_mul_f32 v111, v1, v15
    v_mul_f32 v127, v4, v15
    v_mul_f32 v143, v7, v15
    v_fma_f32 v111, -v4, v31, v111
    v_fma_f32 v127, v1, v31, v127
    v_fma_f32 v143, -v159, v31, v143
    v_mul_f32 v159, v159, v15
    v_fma_f32 v159, v7, v31, v159
    v_add_f32 v1, v112, v144
    v_add_f32 v4, v128, v160
    v_sub_f32 v7, v112, v144
    v_sub_f32 v160, v128, v160
    v_mul_f32 v112, v1, v16
    v_mul_f32 v128, v4, v16
    v_mul_f32 v144, v7, v16
    v_fma_f32 v112, -v4, v32, v112
    v_fma_f32 v128, v1, v32, v128
    v_fma_f32 v144, -v160, v32, v144
    v_mul_f32 v160, v160, v16
    v_fma_f32 v160, v7, v32, v160
    v_add_f32 v1, v113, v145
    v_add_f32 v4, v129, v161
    v_sub_f32 v7, v113, v145
    v_sub_f32 v161, v129, v161
    v_mul_f32 v113, v1, v17
    v_mul_f32 v129, v4, v17
    v_mul_f32 v145, v7, v17
    v_fma_f32 v113, -v4, v33, v113
    v_fma_f32 v129, v1, v33, v129
    v_fma_f32 v145, -v161, v33, v145
    v_mul_f32 v161, v161, v17
    v_fma_f32 v161, v7, v33, v161
    v_add_f32 v1, v114, v146
    v_add_f32 v4, v130, v162
    v_sub_f32 v7, v114, v146
    v_sub_f32 v162, v130, v162
    v_mul_f32 v114, v1, v18
    v_mul_f32 v130, v4, v18
    v_mul_f32 v146, v7, v18
    v_fma_f32 v114, -v4, v34, v114
    v_fma_f32 v130, v1, v34, v130
    v_fma_f32 v146, -v162, v34, v146
    v_mul_f32 v162, v162, v18
    v_fma_f32 v162, v7, v34, v162
    v_add_f32 v1, v115, v147
    v_add_f32 v4, v131, v163
    v_sub_f32 v7, v115, v147
    v_sub_f32 v163, v131, v163
    v_mul_f32 v115, v1, v19
    v_mul_f32 v131, v4, v19
    v_mul_f32 v147, v7, v19
    v_fma_f32 v115, -v4, v35, v115
    v_fma_f32 v131, v1, v35, v131
    v_fma_f32 v147, -v163, v35, v147
    v_mul_f32 v163, v163, v19
    v_fma_f32 v163, v7, v35, v163
    v_add_f32 v1, v116, v148
    v_add_f32 v4, v132, v164
    v_sub_f32 v7, v116, v148
    v_sub_f32 v164, v132, v164
    v_mul_f32 v116, v1, v20
    v_mul_f32 v132, v4, v20
    v_mul_f32 v148, v7, v20
    v_fma_f32 v116, -v4, v36, v116
    v_fma_f32 v132, v1, v36, v132
    v_fma_f32 v148, -v164, v36, v148
    v_mul_f32 v164, v164, v20
    v_fma_f32 v164, v7, v36, v164
    v_add_f32 v1, v117, v149
    v_add_f32 v4, v133, v165
    v_sub_f32 v7, v117, v149
    v_sub_f32 v165, v133, v165
    v_mul_f32 v117, v1, v21
    v_mul_f32 v133, v4, v21
    v_mul_f32 v149, v7, v21
    v_fma_f32 v117, -v4, v37, v117
    v_fma_f32 v133, v1, v37, v133
    v_fma_f32 v149, -v165, v37, v149
    v_mul_f32 v165, v165, v21
    v_fma_f32 v165, v7, v37, v165
    v_add_f32 v1, v118, v150
    v_add_f32 v4, v134, v166
    v_sub_f32 v7, v118, v150
    v_sub_f32 v166, v134, v166
    v_mul_f32 v118, v1, v22
    v_mul_f32 v134, v4, v22
    v_mul_f32 v150, v7, v22
    v_fma_f32 v118, -v4, v38, v118
    v_fma_f32 v134, v1, v38, v134
    v_fma_f32 v150, -v166, v38, v150
    v_mul_f32 v166, v166, v22
    v_fma_f32 v166, v7, v38, v166
    v_add_f32 v1, v119, v151
    v_add_f32 v4, v135, v167
    v_sub_f32 v7, v119, v151
    v_sub_f32 v167, v135, v167
    v_mul_f32 v119, v1, v23
    v_mul_f32 v135, v4, v23
    v_mul_f32 v151, v7, v23
    v_fma_f32 v119, -v4, v39, v119
    v_fma_f32 v135, v1, v39, v135
    v_fma_f32 v151, -v167, v39, v151
    v_mul_f32 v167, v167, v23
    v_fma_f32 v167, v7, v39, v167
    v_cvt_pk_bf16_f32 v40, v104, v105
    v_cvt_pk_bf16_f32 v41, v106, v107
    v_cvt_pk_bf16_f32 v42, v108, v109
    v_cvt_pk_bf16_f32 v43, v110, v111
    v_cvt_pk_bf16_f32 v48, v112, v113
    v_cvt_pk_bf16_f32 v49, v114, v115
    v_cvt_pk_bf16_f32 v50, v116, v117
    v_cvt_pk_bf16_f32 v51, v118, v119
    v_cvt_pk_bf16_f32 v44, v120, v121
    v_cvt_pk_bf16_f32 v45, v122, v123
    v_cvt_pk_bf16_f32 v46, v124, v125
    v_cvt_pk_bf16_f32 v47, v126, v127
    v_cvt_pk_bf16_f32 v52, v128, v129
    v_cvt_pk_bf16_f32 v53, v130, v131
    v_cvt_pk_bf16_f32 v54, v132, v133
    v_cvt_pk_bf16_f32 v55, v134, v135
    v_cvt_pk_bf16_f32 v56, v136, v137
    v_cvt_pk_bf16_f32 v57, v138, v139
    v_cvt_pk_bf16_f32 v58, v140, v141
    v_cvt_pk_bf16_f32 v59, v142, v143
    v_cvt_pk_bf16_f32 v64, v144, v145
    v_cvt_pk_bf16_f32 v65, v146, v147
    v_cvt_pk_bf16_f32 v66, v148, v149
    v_cvt_pk_bf16_f32 v67, v150, v151
    v_cvt_pk_bf16_f32 v60, v152, v153
    v_cvt_pk_bf16_f32 v61, v154, v155
    v_cvt_pk_bf16_f32 v62, v156, v157
    v_cvt_pk_bf16_f32 v63, v158, v159
    v_cvt_pk_bf16_f32 v68, v160, v161
    v_cvt_pk_bf16_f32 v69, v162, v163
    v_cvt_pk_bf16_f32 v70, v164, v165
    v_cvt_pk_bf16_f32 v71, v166, v167
    s_nop 1
    s_waitcnt lgkmcnt(0)
    ds_read_b128 v[244:247], v5 offset:1024
    ds_read_b128 v[248:251], v5 offset:3072
    ds_read_b128 v[252:255], v5 offset:5120
    v_mfma_f32_32x32x16_bf16 v[104:119], v[232:235], v[40:43], 0
    v_mfma_f32_32x32x16_bf16 v[120:135], v[232:235], v[44:47], 0
    v_mfma_f32_32x32x16_bf16 v[104:119], v[240:243], v[44:47], v[104:119]
    v_mfma_f32_32x32x16_bf16 v[120:135], v[236:239], v[40:43], v[120:135]
    s_waitcnt lgkmcnt(0)
    ds_read_b128 v[232:235], v5 offset:6144
    ds_read_b128 v[236:239], v5 offset:8192
    ds_read_b128 v[240:243], v5 offset:10240
    v_mfma_f32_32x32x16_bf16 v[104:119], v[244:247], v[48:51], v[104:119]
    v_mfma_f32_32x32x16_bf16 v[120:135], v[244:247], v[52:55], v[120:135]
    v_mfma_f32_32x32x16_bf16 v[104:119], v[252:255], v[52:55], v[104:119]
    v_mfma_f32_32x32x16_bf16 v[120:135], v[248:251], v[48:51], v[120:135]
    s_waitcnt lgkmcnt(0)
    ds_read_b128 v[244:247], v5 offset:7168
    ds_read_b128 v[248:251], v5 offset:9216
    ds_read_b128 v[252:255], v5 offset:11264
    v_mfma_f32_32x32x16_bf16 v[136:151], v[232:235], v[56:59], 0
    v_mfma_f32_32x32x16_bf16 v[152:167], v[232:235], v[60:63], 0
    v_mfma_f32_32x32x16_bf16 v[136:151], v[240:243], v[60:63], v[136:151]
    v_mfma_f32_32x32x16_bf16 v[152:167], v[236:239], v[56:59], v[152:167]
    s_waitcnt lgkmcnt(0)
    ds_read_b128 v[232:235], v5 offset:0
    ds_read_b128 v[236:239], v5 offset:2048
    ds_read_b128 v[240:243], v5 offset:4096
    v_mfma_f32_32x32x16_bf16 v[136:151], v[244:247], v[64:67], v[136:151]
    v_mfma_f32_32x32x16_bf16 v[152:167], v[244:247], v[68:71], v[152:167]
    v_mfma_f32_32x32x16_bf16 v[136:151], v[252:255], v[68:71], v[136:151]
    v_mfma_f32_32x32x16_bf16 v[152:167], v[248:251], v[64:67], v[152:167]
    s_nop 11
    v_cvt_pk_bf16_f32 v104, v104, v104
    ds_write_b16 v6, v104 offset:2
    v_cvt_pk_bf16_f32 v105, v105, v105
    ds_write_b16 v6, v105 offset:4098
    v_cvt_pk_bf16_f32 v106, v106, v106
    ds_write_b16 v6, v106 offset:8194
    v_cvt_pk_bf16_f32 v107, v107, v107
    ds_write_b16 v6, v107 offset:12290
    v_cvt_pk_bf16_f32 v108, v108, v108
    ds_write_b16 v6, v108 offset:32770
    v_cvt_pk_bf16_f32 v109, v109, v109
    ds_write_b16 v6, v109 offset:36866
    v_cvt_pk_bf16_f32 v110, v110, v110
    ds_write_b16 v6, v110 offset:40962
    v_cvt_pk_bf16_f32 v111, v111, v111
    ds_write_b16 v6, v111 offset:45058
    v_cvt_pk_bf16_f32 v112, v112, v112
    ds_write_b16 v2, v112 offset:2
    v_cvt_pk_bf16_f32 v113, v113, v113
    ds_write_b16 v2, v113 offset:4098
    v_cvt_pk_bf16_f32 v114, v114, v114
    ds_write_b16 v2, v114 offset:8194
    v_cvt_pk_bf16_f32 v115, v115, v115
    ds_write_b16 v2, v115 offset:12290
    v_cvt_pk_bf16_f32 v116, v116, v116
    ds_write_b16 v2, v116 offset:32770
    v_cvt_pk_bf16_f32 v117, v117, v117
    ds_write_b16 v2, v117 offset:36866
    v_cvt_pk_bf16_f32 v118, v118, v118
    ds_write_b16 v2, v118 offset:40962
    v_cvt_pk_bf16_f32 v119, v119, v119
    ds_write_b16 v2, v119 offset:45058
    v_cvt_pk_bf16_f32 v136, v136, v136
    ds_write_b16 v6, v136 offset:2050
    v_cvt_pk_bf16_f32 v137, v137, v137
    ds_write_b16 v6, v137 offset:6146
    v_cvt_pk_bf16_f32 v138, v138, v138
    ds_write_b16 v6, v138 offset:10242
    v_cvt_pk_bf16_f32 v139, v139, v139
    ds_write_b16 v6, v139 offset:14338
    v_cvt_pk_bf16_f32 v140, v140, v140
    ds_write_b16 v6, v140 offset:34818
    v_cvt_pk_bf16_f32 v141, v141, v141
    ds_write_b16 v6, v141 offset:38914
    v_cvt_pk_bf16_f32 v142, v142, v142
    ds_write_b16 v6, v142 offset:43010
    v_cvt_pk_bf16_f32 v143, v143, v143
    ds_write_b16 v6, v143 offset:47106
    v_cvt_pk_bf16_f32 v144, v144, v144
    ds_write_b16 v2, v144 offset:2050
    v_cvt_pk_bf16_f32 v145, v145, v145
    ds_write_b16 v2, v145 offset:6146
    v_cvt_pk_bf16_f32 v146, v146, v146
    ds_write_b16 v2, v146 offset:10242
    v_cvt_pk_bf16_f32 v147, v147, v147
    ds_write_b16 v2, v147 offset:14338
    v_cvt_pk_bf16_f32 v148, v148, v148
    ds_write_b16 v2, v148 offset:34818
    v_cvt_pk_bf16_f32 v149, v149, v149
    ds_write_b16 v2, v149 offset:38914
    v_cvt_pk_bf16_f32 v150, v150, v150
    ds_write_b16 v2, v150 offset:43010
    v_cvt_pk_bf16_f32 v151, v151, v151
    ds_write_b16 v2, v151 offset:47106
L_aux_nsp3:
    v_lshrrev_b32 v2, 4, v3
    s_waitcnt lgkmcnt(0)
    s_barrier
    s_add_u32 s4, s98, 25165824
    s_addc_u32 s5, s99, 0
    s_mov_b32 s6, 4194304
    s_mov_b32 s7, 0x00020000
    v_add_u32 v6, s22, v3
    ds_read_b128 v[40:43], v6 offset:0
    ds_read_b128 v[44:47], v6 offset:1024
    ds_read_b128 v[48:51], v6 offset:2048
    ds_read_b128 v[52:55], v6 offset:3072
    ds_read_b128 v[56:59], v6 offset:4096
    ds_read_b128 v[60:63], v6 offset:5120
    ds_read_b128 v[64:67], v6 offset:6144
    ds_read_b128 v[68:71], v6 offset:7168
    ds_read_b128 v[72:75], v6 offset:8192
    ds_read_b128 v[76:79], v6 offset:9216
    ds_read_b128 v[80:83], v6 offset:10240
    ds_read_b128 v[84:87], v6 offset:11264
    ds_read_b128 v[88:91], v6 offset:12288
    ds_read_b128 v[92:95], v6 offset:13312
    ds_read_b128 v[96:99], v6 offset:14336
    ds_read_b128 v[100:103], v6 offset:15360
    s_add_u32 s24, s21, 0
    s_waitcnt lgkmcnt(15)
    buffer_store_dwordx4 v[40:43], v3, s[4:7], s24 offen offset:0 sc1
    s_waitcnt lgkmcnt(14)
    buffer_store_dwordx4 v[44:47], v3, s[4:7], s24 offen offset:1024 sc1
    s_waitcnt lgkmcnt(13)
    buffer_store_dwordx4 v[48:51], v3, s[4:7], s24 offen offset:2048 sc1
    s_waitcnt lgkmcnt(12)
    buffer_store_dwordx4 v[52:55], v3, s[4:7], s24 offen offset:3072 sc1
    s_add_u32 s24, s21, 4096
    s_waitcnt lgkmcnt(11)
    buffer_store_dwordx4 v[56:59], v3, s[4:7], s24 offen offset:0 sc1
    s_waitcnt lgkmcnt(10)
    buffer_store_dwordx4 v[60:63], v3, s[4:7], s24 offen offset:1024 sc1
    s_waitcnt lgkmcnt(9)
    buffer_store_dwordx4 v[64:67], v3, s[4:7], s24 offen offset:2048 sc1
    s_waitcnt lgkmcnt(8)
    buffer_store_dwordx4 v[68:71], v3, s[4:7], s24 offen offset:3072 sc1
    s_add_u32 s24, s21, 8192
    s_waitcnt lgkmcnt(7)
    buffer_store_dwordx4 v[72:75], v3, s[4:7], s24 offen offset:0 sc1
    s_waitcnt lgkmcnt(6)
    buffer_store_dwordx4 v[76:79], v3, s[4:7], s24 offen offset:1024 sc1
    s_waitcnt lgkmcnt(5)
    buffer_store_dwordx4 v[80:83], v3, s[4:7], s24 offen offset:2048 sc1
    s_waitcnt lgkmcnt(4)
    buffer_store_dwordx4 v[84:87], v3, s[4:7], s24 offen offset:3072 sc1
    s_add_u32 s24, s21, 12288
    s_waitcnt lgkmcnt(3)
    buffer_store_dwordx4 v[88:91], v3, s[4:7], s24 offen offset:0 sc1
    s_waitcnt lgkmcnt(2)
    buffer_store_dwordx4 v[92:95], v3, s[4:7], s24 offen offset:1024 sc1
    s_waitcnt lgkmcnt(1)
    buffer_store_dwordx4 v[96:99], v3, s[4:7], s24 offen offset:2048 sc1
    s_waitcnt lgkmcnt(0)
    buffer_store_dwordx4 v[100:103], v3, s[4:7], s24 offen offset:3072 sc1
    s_and_b32 s21, s2, 7
    s_lshr_b32 s22, s2, 3
    s_lshr_b32 s44, s21, 1
    s_lshl_b32 s44, s44, 2
    s_and_b32 s45, s22, 3
    s_add_u32 s44, s44, s45
    s_and_b32 s45, s21, 1
    s_lshl_b32 s45, s45, 3
    s_lshr_b32 s21, s22, 2
    s_add_u32 s45, s45, s21
    s_lshl_b32 s21, s45, 7
    s_add_u32 s8, s92, s21
    s_addc_u32 s9, s93, 0
    s_sub_u32 s10, 7340032, s21
    s_mov_b32 s11, 0x00020000
    v_lshrrev_b32 v14, 3, v2
    s_lshl_b32 s21, s20, 3
    v_add_u32 v14, s21, v14
    v_lshlrev_b32 v14, 11, v14
    v_bfe_u32 v15, v2, 4, 1
    v_lshlrev_b32 v15, 2, v15
    v_and_b32 v1, 7, v2
    v_xor_b32 v15, v15, v1
    v_lshl_add_u32 v14, v15, 4, v14
    s_lshl_b32 s46, s20, 10
    s_mov_b32 s47, 0
    s_waitcnt vmcnt(0)
    s_barrier
    s_cmp_lg_u32 s20, 0
    s_cbranch_scc1 L_aux_nosig2
    v_mov_b32 v12, 6144
    v_mov_b32 v13, 1
    s_mov_b64 s[78:79], exec
    s_mov_b64 exec, 1
    buffer_atomic_add v13, v12, s[48:51], 0 offen
    s_mov_b64 exec, s[78:79]
L_aux_nosig2:
    s_add_u32 m0, s46, 0
    s_nop 0
    buffer_load_dwordx4 v14, s[8:11], s47 offen lds
    s_add_u32 s47, s47, 131072
    s_add_u32 m0, s46, 8192
    s_nop 0
    buffer_load_dwordx4 v14, s[8:11], s47 offen lds
    s_add_u32 s47, s47, 131072
    s_add_u32 m0, s46, 16384
    s_nop 0
    buffer_load_dwordx4 v14, s[8:11], s47 offen lds
    s_add_u32 s47, s47, 131072
    s_add_u32 m0, s46, 24576
    s_nop 0
    buffer_load_dwordx4 v14, s[8:11], s47 offen lds
    s_add_u32 s47, s47, 131072
    s_add_u32 m0, s46, 32768
    s_nop 0
    buffer_load_dwordx4 v14, s[8:11], s47 offen lds
    s_add_u32 s47, s47, 131072
    s_add_u32 m0, s46, 40960
    s_nop 0
    buffer_load_dwordx4 v14, s[8:11], s47 offen lds
    s_add_u32 s47, s47, 131072
    s_add_u32 m0, s46, 49152
    s_nop 0
    buffer_load_dwordx4 v14, s[8:11], s47 offen lds
    s_add_u32 s47, s47, 131072
    s_add_u32 m0, s46, 57344
    s_nop 0
    buffer_load_dwordx4 v14, s[8:11], s47 offen lds
    s_add_u32 s47, s47, 131072
    s_add_u32 m0, s46, 65536
    s_nop 0
    buffer_load_dwordx4 v14, s[8:11], s47 offen lds
    s_add_u32 s47, s47, 131072
    s_add_u32 m0, s46, 73728
    s_nop 0
    buffer_load_dwordx4 v14, s[8:11], s47 offen lds
    s_add_u32 s47, s47, 131072
    s_add_u32 m0, s46, 81920
    s_nop 0
    buffer_load_dwordx4 v14, s[8:11], s47 offen lds
    s_add_u32 s47, s47, 131072
    s_add_u32 m0, s46, 90112
    s_nop 0
    buffer_load_dwordx4 v14, s[8:11], s47 offen lds
    s_add_u32 s47, s47, 131072
    s_add_u32 m0, s46, 98304
    s_nop 0
    buffer_load_dwordx4 v14, s[8:11], s47 offen lds
    s_add_u32 s47, s47, 131072
    s_add_u32 m0, s46, 106496
    s_nop 0
    buffer_load_dwordx4 v14, s[8:11], s47 offen lds
    s_add_u32 s47, s47, 131072
    s_add_u32 m0, s46, 114688
    s_nop 0
    buffer_load_dwordx4 v14, s[8:11], s47 offen lds
    s_add_u32 s47, s47, 131072
    s_add_u32 m0, s46, 122880
    s_nop 0
    buffer_load_dwordx4 v14, s[8:11], s47 offen lds
    s_add_u32 s47, s47, 131072
    s_mov_b32 s59, -1
    s_cmp_lg_u32 s20, 0
    s_cbranch_scc1 L_pza_done
    v_mov_b32 v12, 6144
    s_mov_b32 s58, 0
L_pza:
    buffer_load_dword v13, v12, s[48:51], 0 offen sc1
    s_waitcnt vmcnt(0)
    v_cmp_gt_u32 vcc, 32, v13
    s_nop 1
    s_cmp_eq_u64 vcc, 0
    s_cbranch_scc1 L_pza_done
    s_sleep 1
    s_add_u32 s58, s58, 1
    s_cmp_lt_u32 s58, 0x80000
    s_cbranch_scc1 L_pza
L_pza_done:
    s_mov_b32 s56, 1
L_phase2:
    s_lshr_b32 s21, s20, 2
    s_and_b32 s22, s20, 3
    s_lshl_b32 s25, s44, 4
    s_add_u32 s25, s25, s45
    s_lshr_b32 s26, s25, 7
    s_lshl_b32 s26, s26, 4
    s_add_u32 s26, s26, s27
    s_bfe_u32 s28, s25, 0x10006
    s_lshl_b32 s28, s28, 2
    s_add_u32 s26, s26, s28
    s_lshl_b32 s26, s26, 6
    s_and_b32 s28, s25, 63
    s_add_u32 s26, s26, s28
    v_lshrrev_b32 v7, 5, v2
    v_bfe_u32 v6, v2, 4, 1
    v_lshl_add_u32 v6, v7, 3, v6
    v_lshlrev_b32 v6, 17, v6
    v_and_b32 v8, 15, v2
    v_lshl_add_u32 v6, v8, 2, v6
    s_bfe_u32 s28, s26, 0x30001
    s_lshl_b32 s28, s28, 3
    v_xor_b32 v6, s28, v6
    s_lshl_b32 s28, s26, 6
    s_lshl_b32 s29, s26, 11
    v_and_b32 v8, 31, v2
    v_lshlrev_b32 v8, 6, v8
    v_lshl_add_u32 v8, v7, 4, v8
    s_add_u32 s12, s98, 25165824
    s_addc_u32 s13, s99, 0
    s_mov_b32 s14, 4194304
    s_mov_b32 s15, 0x00020000
    s_mov_b32 s16, s80
    s_mov_b32 s17, s81
    s_mov_b32 s18, 4194304
    s_mov_b32 s19, 0x00020000
    v_lshlrev_b32 v144, 2, v7
    v_add_u32 v145, s27, v144
    v_cvt_f32_u32 v145, v145
    v_add_f32 v146, 0x41800000, v145
    v_and_b32 v149, 31, v2
    v_cvt_f32_u32 v149, v149
    v_mul_f32 v150, 0x3d000000, v149
    s_lshr_b32 s30, s20, 1
    v_add_u32 v153, s30, v144
    v_cvt_f32_u32 v153, v153
    v_add_f32 v154, 0x41000000, v153
    s_and_b32 s30, s20, 1
    v_cvt_f32_u32 v155, s30
    v_mul_f32 v155, 0x3e800000, v155
    v_add_f32 v156, 0xbe800000, v155
    v_mov_b32 v157, 0
    v_mov_b32 v158, 0x3e800000
    s_mov_b32 s35, 0x3fcfef9e
    s_lshl_b32 s30, s20, 1
    s_add_u32 s30, s30, 131072
    v_add_u32 v9, s30, v3
    v_fma_f32 v160, v150, v153, v155
    v_fma_f32 v161, v150, v154, v155
    v_fma_f32 v162, v150, v153, v156
    v_fma_f32 v163, v150, v154, v156
    v_fma_f32 v164, v150, v145, v157
    v_fma_f32 v165, v150, v146, v157
    v_fma_f32 v166, v150, v145, v158
    v_fma_f32 v167, v150, v146, v158
    v_cos_f32 v160, v160
    v_cos_f32 v161, v161
    v_cos_f32 v162, v162
    v_cos_f32 v163, v163
    v_cos_f32 v164, v164
    v_cos_f32 v165, v165
    v_cos_f32 v166, v166
    v_cos_f32 v167, v167
    v_mul_f32 v160, s35, v160
    v_mul_f32 v161, s35, v161
    v_mul_f32 v162, s35, v162
    v_mul_f32 v163, s35, v163
    v_mul_f32 v164, s35, v164
    v_mul_f32 v165, s35, v165
    v_mul_f32 v166, s35, v166
    v_mul_f32 v167, s35, v167
    v_cvt_pk_bf16_f32 v160, v160, v160
    v_cvt_pk_bf16_f32 v161, v161, v161
    v_cvt_pk_bf16_f32 v162, v162, v162
    v_cvt_pk_bf16_f32 v163, v163, v163
    v_cvt_pk_bf16_f32 v164, v164, v164
    v_cvt_pk_bf16_f32 v165, v165, v165
    v_cvt_pk_bf16_f32 v166, v166, v166
    v_cvt_pk_bf16_f32 v167, v167, v167
    ds_write_b16 v9, v160 offset:0
    ds_write_b16 v9, v161 offset:1024
    ds_write_b16 v9, v162 offset:2048
    ds_write_b16 v9, v163 offset:3072
    ds_write_b16 v9, v164 offset:4096
    ds_write_b16 v9, v165 offset:5120
    ds_write_b16 v9, v166 offset:6144
    ds_write_b16 v9, v167 offset:7168
    s_waitcnt vmcnt(0) lgkmcnt(0)
    s_barrier
    s_mov_b32 s57, 0
    s_cmp_lg_u32 s20, 0
    s_cbranch_scc1 L_p2_nosig
    s_cmp_eq_u32 s59, -1
    s_cbranch_scc1 L_p2_nosig
    v_mov_b32 v10, s59
    v_mov_b32 v11, 1
    s_mov_b64 s[78:79], exec
    s_mov_b64 exec, 1
    buffer_atomic_add v11, v10, s[48:51], 0 offen
    s_mov_b64 exec, s[78:79]
    s_mov_b32 s57, 1
L_p2_nosig:
    buffer_load_dwordx4 v[248:251], v8, s[16:19], s29 offen
    buffer_load_dwordx4 v[252:255], v8, s[16:19], s29 offen offset:32
    s_cmp_eq_u32 s56, 0
    s_cbranch_scc1 L_p2_noz
    s_add_u32 s30, s28, 0
    buffer_load_dword v240, v6, s[12:15], s30 offen sc1
    s_add_u32 s30, s28, 262144
    buffer_load_dword v241, v6, s[12:15], s30 offen sc1
    s_add_u32 s30, s28, 524288
    buffer_load_dword v242, v6, s[12:15], s30 offen sc1
    s_add_u32 s30, s28, 786432
    buffer_load_dword v243, v6, s[12:15], s30 offen sc1
    s_add_u32 s30, s28, 2097152
    buffer_load_dword v244, v6, s[12:15], s30 offen sc1
    s_add_u32 s30, s28, 2359296
    buffer_load_dword v245, v6, s[12:15], s30 offen sc1
    s_add_u32 s30, s28, 2621440
    buffer_load_dword v246, v6, s[12:15], s30 offen sc1
    s_add_u32 s30, s28, 2883584
    buffer_load_dword v247, v6, s[12:15], s30 offen sc1
L_p2_noz:
    s_mov_b32 s57, 0
    s_mov_b32 s36, s92
    s_mov_b32 s37, s93
    s_mov_b32 s38, 7340032
    s_mov_b32 s39, 0x00020000
    s_lshr_b32 s30, s2, 3
    s_lshl_b32 s30, s30, 3
    s_add_u32 s30, s30, s20
    s_lshl_b32 s31, s30, 3
    v_and_b32 v10, 7, v2
    v_add_u32 v10, s31, v10
    v_lshlrev_b32 v10, 11, v10
    s_lshr_b32 s33, s45, 3
    s_lshl_b32 s33, s33, 10
    s_add_u32 s33, s33, 384
    buffer_load_dword v238, v10, s[36:39], s33 offen
    s_mul_i32 s31, s30, 6
    s_add_u32 s31, s31, 2048
    v_min_u32 v239, 5, v2
    v_add_u32 v239, s31, v239
    v_lshlrev_b32 v239, 11, v239
    s_lshl_b32 s31, s2, 3
    s_add_u32 s31, s31, s20
    s_mul_i32 s31, s31, 1536
    s_add_u32 s31, s31, 4194304
    v_min_u32 v235, 11, v2
    v_lshlrev_b32 v235, 7, v235
    v_add_u32 v235, s31, v235
    v_add_u32 v9, 131072, v3
    ds_read_b128 v[80:83], v9 offset:0
    ds_read_b128 v[84:87], v9 offset:1024
    ds_read_b128 v[88:91], v9 offset:2048
    ds_read_b128 v[92:95], v9 offset:3072
    ds_read_b128 v[96:99], v9 offset:4096
    ds_read_b128 v[100:103], v9 offset:5120
    ds_read_b128 v[104:107], v9 offset:6144
    ds_read_b128 v[108:111], v9 offset:7168
    v_and_b32 v10, 31, v2
    v_cvt_f32_u32 v10, v10
    v_mul_f32 v10, 0x3a800000, v10
    v_lshrrev_b32 v11, 5, v2
    v_lshlrev_b32 v11, 2, v11
    v_cvt_f32_u32 v11, v11
    v_mul_f32 v11, v10, v11
    v_mov_b32 v1, 0x00000000
    v_fma_f32 v192, v10, v1, v11
    v_mov_b32 v1, 0x3f800000
    v_fma_f32 v193, v10, v1, v11
    v_mov_b32 v1, 0x40000000
    v_fma_f32 v194, v10, v1, v11
    v_mov_b32 v1, 0x40400000
    v_fma_f32 v195, v10, v1, v11
    v_mov_b32 v1, 0x41000000
    v_fma_f32 v196, v10, v1, v11
    v_mov_b32 v1, 0x41100000
    v_fma_f32 v197, v10, v1, v11
    v_mov_b32 v1, 0x41200000
    v_fma_f32 v198, v10, v1, v11
    v_mov_b32 v1, 0x41300000
    v_fma_f32 v199, v10, v1, v11
    v_mov_b32 v1, 0x41800000
    v_fma_f32 v200, v10, v1, v11
    v_mov_b32 v1, 0x41880000
    v_fma_f32 v201, v10, v1, v11
    v_mov_b32 v1, 0x41900000
    v_fma_f32 v202, v10, v1, v11
    v_mov_b32 v1, 0x41980000
    v_fma_f32 v203, v10, v1, v11
    v_mov_b32 v1, 0x41c00000
    v_fma_f32 v204, v10, v1, v11
    v_mov_b32 v1, 0x41c80000
    v_fma_f32 v205, v10, v1, v11
    v_mov_b32 v1, 0x41d00000
    v_fma_f32 v206, v10, v1, v11
    v_mov_b32 v1, 0x41d80000
    v_fma_f32 v207, v10, v1, v11
    v_cos_f32 v176, v192
    v_cos_f32 v177, v193
    v_cos_f32 v178, v194
    v_cos_f32 v179, v195
    v_cos_f32 v180, v196
    v_cos_f32 v181, v197
    v_cos_f32 v182, v198
    v_cos_f32 v183, v199
    v_cos_f32 v184, v200
    v_cos_f32 v185, v201
    v_cos_f32 v186, v202
    v_cos_f32 v187, v203
    v_cos_f32 v188, v204
    v_cos_f32 v189, v205
    v_cos_f32 v190, v206
    v_cos_f32 v191, v207
    v_sin_f32 v192, v192
    v_sin_f32 v193, v193
    v_sin_f32 v194, v194
    v_sin_f32 v195, v195
    v_sin_f32 v196, v196
    v_sin_f32 v197, v197
    v_sin_f32 v198, v198
    v_sin_f32 v199, v199
    v_sin_f32 v200, v200
    v_sin_f32 v201, v201
    v_sin_f32 v202, v202
    v_sin_f32 v203, v203
    v_sin_f32 v204, v204
    v_sin_f32 v205, v205
    v_sin_f32 v206, v206
    v_sin_f32 v207, v207
    s_cmp_eq_u32 s56, 1
    s_cbranch_scc1 L_p2_zok
    v_mov_b32 v12, 6144
    s_mov_b32 s58, 0
L_pz:
    buffer_load_dword v13, v12, s[48:51], 0 offen sc1
    s_waitcnt vmcnt(0)
    v_cmp_gt_u32 vcc, 32, v13
    s_nop 1
    s_cmp_eq_u64 vcc, 0
    s_cbranch_scc1 L_pz_done
    s_sleep 1
    s_add_u32 s58, s58, 1
    s_cmp_lt_u32 s58, 0x80000
    s_cbranch_scc1 L_pz
L_pz_done:
    s_add_u32 s30, s28, 0
    buffer_load_dword v240, v6, s[12:15], s30 offen sc1
    s_add_u32 s30, s28, 262144
    buffer_load_dword v241, v6, s[12:15], s30 offen sc1
    s_add_u32 s30, s28, 524288
    buffer_load_dword v242, v6, s[12:15], s30 offen sc1
    s_add_u32 s30, s28, 786432
    buffer_load_dword v243, v6, s[12:15], s30 offen sc1
    s_add_u32 s30, s28, 2097152
    buffer_load_dword v244, v6, s[12:15], s30 offen sc1
    s_add_u32 s30, s28, 2359296
    buffer_load_dword v245, v6, s[12:15], s30 offen sc1
    s_add_u32 s30, s28, 2621440
    buffer_load_dword v246, v6, s[12:15], s30 offen sc1
    s_add_u32 s30, s28, 2883584
    buffer_load_dword v247, v6, s[12:15], s30 offen sc1
    s_waitcnt vmcnt(0)
L_p2_zok:
    s_add_u32 s12, s98, 29360128
    s_addc_u32 s13, s99, 0
    s_mov_b32 s14, 4194304
    s_mov_b32 s15, 0x00020000
    s_mov_b32 s16, s94
    s_mov_b32 s17, s95
    s_mov_b32 s18, 4194304
    s_mov_b32 s19, 0x00020000
    v_cmp_gt_u32 vcc, 32, v2
    v_mov_b32 v10, 0xbf500000
    v_and_b32 v11, 1, v2
    v_lshlrev_b32 v12, 31, v11
    v_xor_b32 v12, 0x3f4fef9e, v12
    v_cndmask_b32 v10, 0, v10, vcc
    v_cndmask_b32 v12, 0, v12, vcc
    s_mov_b32 s35, 0x32a8e6a8
    s_waitcnt vmcnt(2) lgkmcnt(0)
    s_cmp_eq_u32 s57, 1
    s_cbranch_scc1 L_p2_w1
    s_waitcnt vmcnt(1)
L_p2_w1:
    v_mfma_f32_32x32x16_bf16 v[144:159], v[240:243], v[80:83], 0
    v_mfma_f32_32x32x16_bf16 v[160:175], v[240:243], v[88:91], 0
    v_mfma_f32_32x32x16_bf16 v[144:159], v[244:247], v[84:87], v[144:159]
    v_mfma_f32_32x32x16_bf16 v[160:175], v[244:247], v[92:95], v[160:175]
    v_readlane_b32 s30, v240, 0
    v_permlane32_swap_b32 v248, v250
    v_permlane32_swap_b32 v249, v251
    v_permlane32_swap_b32 v252, v254
    v_permlane32_swap_b32 v253, v255
    s_lshl_b32 s34, s30, 16
    s_and_b32 s30, s30, 0xffff0000
    s_lshr_b32 s25, s44, 1
    s_add_u32 s25, s25, 16
    s_lshl_b32 s25, s25, 8
    v_mov_b32 v0, s25
    s_nop 2
    v_fma_f32 v144, v10, s34, v144
    v_fma_f32 v144, v12, s30, v144
    v_mul_f32 v1, v144, v192
    v_mul_f32 v144, v144, v176
    v_fma_f32 v144, -v160, v192, v144
    v_fma_f32 v160, v160, v176, v1
    v_mul_f32 v1, v145, v193
    v_mul_f32 v145, v145, v177
    v_fma_f32 v145, -v161, v193, v145
    v_fma_f32 v161, v161, v177, v1
    v_mul_f32 v1, v146, v194
    v_mul_f32 v146, v146, v178
    v_fma_f32 v146, -v162, v194, v146
    v_fma_f32 v162, v162, v178, v1
    v_mul_f32 v1, v147, v195
    v_mul_f32 v147, v147, v179
    v_fma_f32 v147, -v163, v195, v147
    v_fma_f32 v163, v163, v179, v1
    v_mul_f32 v1, v148, v196
    v_mul_f32 v148, v148, v180
    v_fma_f32 v148, -v164, v196, v148
    v_fma_f32 v164, v164, v180, v1
    v_mul_f32 v1, v149, v197
    v_mul_f32 v149, v149, v181
    v_fma_f32 v149, -v165, v197, v149
    v_fma_f32 v165, v165, v181, v1
    v_mul_f32 v1, v150, v198
    v_mul_f32 v150, v150, v182
    v_fma_f32 v150, -v166, v198, v150
    v_fma_f32 v166, v166, v182, v1
    v_mul_f32 v1, v151, v199
    v_mul_f32 v151, v151, v183
    v_fma_f32 v151, -v167, v199, v151
    v_fma_f32 v167, v167, v183, v1
    v_mul_f32 v1, v152, v200
    v_mul_f32 v152, v152, v184
    v_fma_f32 v152, -v168, v200, v152
    v_fma_f32 v168, v168, v184, v1
    v_mul_f32 v1, v153, v201
    v_mul_f32 v153, v153, v185
    v_fma_f32 v153, -v169, v201, v153
    v_fma_f32 v169, v169, v185, v1
    v_mul_f32 v1, v154, v202
    v_mul_f32 v154, v154, v186
    v_fma_f32 v154, -v170, v202, v154
    v_fma_f32 v170, v170, v186, v1
    v_mul_f32 v1, v155, v203
    v_mul_f32 v155, v155, v187
    v_fma_f32 v155, -v171, v203, v155
    v_fma_f32 v171, v171, v187, v1
    v_mul_f32 v1, v156, v204
    v_mul_f32 v156, v156, v188
    v_fma_f32 v156, -v172, v204, v156
    v_fma_f32 v172, v172, v188, v1
    v_mul_f32 v1, v157, v205
    v_mul_f32 v157, v157, v189
    v_fma_f32 v157, -v173, v205, v157
    v_fma_f32 v173, v173, v189, v1
    v_mul_f32 v1, v158, v206
    v_mul_f32 v158, v158, v190
    v_fma_f32 v158, -v174, v206, v158
    v_fma_f32 v174, v174, v190, v1
    v_mul_f32 v1, v159, v207
    v_mul_f32 v159, v159, v191
    v_fma_f32 v159, -v175, v207, v159
    v_fma_f32 v175, v175, v191, v1
    v_cvt_pk_bf16_f32 v208, v144, v145
    v_cvt_pk_bf16_f32 v209, v146, v147
    v_cvt_pk_bf16_f32 v210, v148, v149
    v_cvt_pk_bf16_f32 v211, v150, v151
    v_cvt_pk_bf16_f32 v212, v152, v153
    v_cvt_pk_bf16_f32 v213, v154, v155
    v_cvt_pk_bf16_f32 v214, v156, v157
    v_cvt_pk_bf16_f32 v215, v158, v159
    v_cvt_pk_bf16_f32 v216, v160, v161
    v_cvt_pk_bf16_f32 v217, v162, v163
    v_cvt_pk_bf16_f32 v218, v164, v165
    v_cvt_pk_bf16_f32 v219, v166, v167
    v_cvt_pk_bf16_f32 v220, v168, v169
    v_cvt_pk_bf16_f32 v221, v170, v171
    v_cvt_pk_bf16_f32 v222, v172, v173
    v_cvt_pk_bf16_f32 v223, v174, v175
    s_nop 1
    v_mfma_f32_32x32x16_bf16 v[144:159], v[208:211], v[96:99], 0
    v_mfma_f32_32x32x16_bf16 v[144:159], v[212:215], v[100:103], v[144:159]
    v_mfma_f32_32x32x16_bf16 v[144:159], v[216:219], v[104:107], v[144:159]
    v_mfma_f32_32x32x16_bf16 v[144:159], v[220:223], v[108:111], v[144:159]
    s_lshl_b32 s30, s27, 10
    v_add_u32 v4, s30, v3
    v_lshrrev_b32 v5, 3, v2
    v_cmp_eq_u32 vcc, 3, v5
    v_add_u32 v5, 0, v4
    s_nop 0
    v_cndmask_b32 v4, v4, v5, vcc
    v_add_u32 v5, 4096, v4
    v_bfe_u32 v9, v2, 2, 2
    v_lshlrev_b32 v13, 9, v7
    v_lshl_add_u32 v13, v9, 7, v13
    v_lshrrev_b32 v9, 1, v9
    v_lshl_add_u32 v13, v9, 6, v13
    v_bfe_u32 v9, v2, 4, 1
    v_lshl_add_u32 v13, v9, 5, v13
    v_and_b32 v9, 3, v2
    v_lshl_add_u32 v13, v9, 3, v13
    s_lshl_b32 s30, s21, 12
    v_add_u32 v13, s30, v13
    v_xor_b32 v15, 64, v13
    s_mul_i32 s30, s44, 917504
    s_add_u32 s30, s30, 4194304
    s_add_u32 s4, s98, s30
    s_addc_u32 s5, s99, 0
    s_mov_b32 s6, 917504
    s_mov_b32 s7, 0x00020000
    v_mul_f32 v144, s35, v144
    v_mul_f32 v145, s35, v145
    v_cvt_pk_bf16_f32 v1, v144, v145
    v_lshlrev_b32 v9, 16, v248
    v_and_b32 v10, 0xffff0000, v248
    v_lshlrev_b32 v11, 16, v1
    v_and_b32 v1, 0xffff0000, v1
    v_add_f32 v9, v9, v11
    v_add_f32 v10, v10, v1
    v_cvt_pk_bf16_f32 v248, v9, v10
    v_mul_f32 v146, s35, v146
    v_mul_f32 v147, s35, v147
    v_cvt_pk_bf16_f32 v1, v146, v147
    v_lshlrev_b32 v9, 16, v249
    v_and_b32 v10, 0xffff0000, v249
    v_lshlrev_b32 v11, 16, v1
    v_and_b32 v1, 0xffff0000, v1
    v_add_f32 v9, v9, v11
    v_add_f32 v10, v10, v1
    v_cvt_pk_bf16_f32 v249, v9, v10
    v_mul_f32 v148, s35, v148
    v_mul_f32 v149, s35, v149
    v_cvt_pk_bf16_f32 v1, v148, v149
    v_lshlrev_b32 v9, 16, v250
    v_and_b32 v10, 0xffff0000, v250
    v_lshlrev_b32 v11, 16, v1
    v_and_b32 v1, 0xffff0000, v1
    v_add_f32 v9, v9, v11
    v_add_f32 v10, v10, v1
    v_cvt_pk_bf16_f32 v250, v9, v10
    v_mul_f32 v150, s35, v150
    v_mul_f32 v151, s35, v151
    v_cvt_pk_bf16_f32 v1, v150, v151
    v_lshlrev_b32 v9, 16, v251
    v_and_b32 v10, 0xffff0000, v251
    v_lshlrev_b32 v11, 16, v1
    v_and_b32 v1, 0xffff0000, v1
    v_add_f32 v9, v9, v11
    v_add_f32 v10, v10, v1
    v_cvt_pk_bf16_f32 v251, v9, v10
    v_mul_f32 v152, s35, v152
    v_mul_f32 v153, s35, v153
    v_cvt_pk_bf16_f32 v1, v152, v153
    v_lshlrev_b32 v9, 16, v252
    v_and_b32 v10, 0xffff0000, v252
    v_lshlrev_b32 v11, 16, v1
    v_and_b32 v1, 0xffff0000, v1
    v_add_f32 v9, v9, v11
    v_add_f32 v10, v10, v1
    v_cvt_pk_bf16_f32 v252, v9, v10
    v_mul_f32 v154, s35, v154
    v_mul_f32 v155, s35, v155
    v_cvt_pk_bf16_f32 v1, v154, v155
    v_lshlrev_b32 v9, 16, v253
    v_and_b32 v10, 0xffff0000, v253
    v_lshlrev_b32 v11, 16, v1
    v_and_b32 v1, 0xffff0000, v1
    v_add_f32 v9, v9, v11
    v_add_f32 v10, v10, v1
    v_cvt_pk_bf16_f32 v253, v9, v10
    v_mul_f32 v156, s35, v156
    v_mul_f32 v157, s35, v157
    v_cvt_pk_bf16_f32 v1, v156, v157
    v_lshlrev_b32 v9, 16, v254
    v_and_b32 v10, 0xffff0000, v254
    v_lshlrev_b32 v11, 16, v1
    v_and_b32 v1, 0xffff0000, v1
    v_add_f32 v9, v9, v11
    v_add_f32 v10, v10, v1
    v_cvt_pk_bf16_f32 v254, v9, v10
    v_mul_f32 v158, s35, v158
    v_mul_f32 v159, s35, v159
    v_cvt_pk_bf16_f32 v1, v158, v159
    v_lshlrev_b32 v9, 16, v255
    v_and_b32 v10, 0xffff0000, v255
    v_lshlrev_b32 v11, 16, v1
    v_and_b32 v1, 0xffff0000, v1
    v_add_f32 v9, v9, v11
    v_add_f32 v10, v10, v1
    v_cvt_pk_bf16_f32 v255, v9, v10
    buffer_store_dwordx4 v[248:251], v3, s[12:15], s29 offen sc1
    buffer_store_dwordx4 v[252:255], v3, s[12:15], s29 offen offset:1024 sc1
    s_cmp_lg_u32 s20, 0
    s_cbranch_scc1 L_ph_done
    s_mov_b32 s58, 0
L_ph:
    buffer_load_dword v1, v0, s[48:51], 0 offen sc1
    s_waitcnt vmcnt(0)
    v_cmp_gt_u32 vcc, 28, v1
    s_nop 1
    s_cmp_eq_u64 vcc, 0
    s_cbranch_scc1 L_ph_done
    s_sleep 1
    s_add_u32 s58, s58, 1
    s_cmp_lt_u32 s58, 0x80000
    s_cbranch_scc1 L_ph
L_ph_done:
    s_waitcnt vmcnt(0)
    s_barrier
    s_mov_b32 s32, 0
    buffer_load_dwordx4 v[80:83], v4, s[4:7], s32 offen sc1
    buffer_load_dwordx4 v[84:87], v5, s[4:7], s32 offen sc1
    s_add_u32 s32, s32, 16384
    buffer_load_dwordx4 v[88:91], v4, s[4:7], s32 offen sc1
    buffer_load_dwordx4 v[92:95], v5, s[4:7], s32 offen sc1
    s_add_u32 s32, s32, 16384
    buffer_load_dwordx4 v[96:99], v4, s[4:7], s32 offen sc1
    buffer_load_dwordx4 v[100:103], v5, s[4:7], s32 offen sc1
    s_add_u32 s32, s32, 16384
    buffer_load_dwordx4 v[104:107], v4, s[4:7], s32 offen sc1
    buffer_load_dwordx4 v[108:111], v5, s[4:7], s32 offen sc1
    s_add_u32 s32, s32, 16384
    s_lshl_b32 s26, s44, 7
    s_lshl_b32 s25, s22, 5
    s_add_u32 s26, s26, s25
    v_and_b32 v8, 31, v2
    v_add_u32 v8, s26, v8
    v_bfe_u32 v9, v8, 3, 6
    v_and_b32 v10, 3, v8
    v_lshl_add_u32 v9, v10, 6, v9
    v_bfe_u32 v10, v8, 9, 1
    v_lshl_add_u32 v9, v10, 8, v9
    v_bfe_u32 v10, v8, 2, 1
    v_lshl_add_u32 v9, v10, 9, v9
    v_bfe_u32 v10, v8, 10, 1
    v_lshl_add_u32 v9, v10, 10, v9
    v_lshlrev_b32 v9, 11, v9
    v_lshl_add_u32 v10, v7, 9, v9
    v_lshl_add_u32 v11, v7, 4, v9
    s_lshl_b32 s25, s45, 1
    s_add_u32 s25, s25, s21
    s_lshl_b32 s26, s25, 6
    s_lshl_b32 s25, s25, 4
    s_add_u32 s28, s44, 32
    s_lshl_b32 s28, s28, 8
    v_mov_b32 v12, s28
    v_add_u32 v6, 0x10000, v13
    v_add_u32 v7, 0x10000, v15
    v_add_u32 v236, 0x20000, v13
    v_add_u32 v237, 0x20000, v15
    v_mov_b32 v16, 0
    v_mov_b32 v17, 0
    v_mov_b32 v18, 0
    v_mov_b32 v19, 0
    v_mov_b32 v20, 0
    v_mov_b32 v21, 0
    v_mov_b32 v22, 0
    v_mov_b32 v23, 0
    v_mov_b32 v24, 0
    v_mov_b32 v25, 0
    v_mov_b32 v26, 0
    v_mov_b32 v27, 0
    v_mov_b32 v28, 0
    v_mov_b32 v29, 0
    v_mov_b32 v30, 0
    v_mov_b32 v31, 0
    v_mov_b32 v32, 0
    v_mov_b32 v33, 0
    v_mov_b32 v34, 0
    v_mov_b32 v35, 0
    v_mov_b32 v36, 0
    v_mov_b32 v37, 0
    v_mov_b32 v38, 0
    v_mov_b32 v39, 0
    v_mov_b32 v40, 0
    v_mov_b32 v41, 0
    v_mov_b32 v42, 0
    v_mov_b32 v43, 0
    v_mov_b32 v44, 0
    v_mov_b32 v45, 0
    v_mov_b32 v46, 0
    v_mov_b32 v47, 0
    s_cmp_lg_u32 s20, 0
    s_cbranch_scc1 L_p2_nosy
    v_mov_b32 v8, s28
    v_mov_b32 v9, 1
    s_mov_b64 s[78:79], exec
    s_mov_b64 exec, 1
    buffer_atomic_add v9, v8, s[48:51], 0 offen
    s_mov_b64 exec, s[78:79]
L_p2_nosy:
    ds_read_b64_tr_b16 v[48:49], v13 offset:0
    ds_read_b64_tr_b16 v[50:51], v13 offset:2048
    ds_read_b64_tr_b16 v[52:53], v15 offset:0
    ds_read_b64_tr_b16 v[54:55], v15 offset:2048
    ds_read_b64_tr_b16 v[56:57], v13 offset:1024
    ds_read_b64_tr_b16 v[58:59], v13 offset:3072
    ds_read_b64_tr_b16 v[60:61], v15 offset:1024
    ds_read_b64_tr_b16 v[62:63], v15 offset:3072
    s_mov_b32 s57, 0
    s_waitcnt vmcnt(6) lgkmcnt(0)
    s_barrier
    s_add_u32 m0, s46, 0
    v_mfma_f32_32x32x16_bf16 v[16:31], v[48:51], v[80:83], v[16:31]
    buffer_load_dwordx4 v14, s[8:11], s47 offen lds
    ds_read_b64_tr_b16 v[64:65], v13 offset:8192
    ds_read_b64_tr_b16 v[66:67], v13 offset:10240
    ds_read_b64_tr_b16 v[68:69], v15 offset:8192
    v_mfma_f32_32x32x16_bf16 v[32:47], v[52:55], v[80:83], v[32:47]
    ds_read_b64_tr_b16 v[70:71], v15 offset:10240
    ds_read_b64_tr_b16 v[72:73], v13 offset:9216
    ds_read_b64_tr_b16 v[74:75], v13 offset:11264
    v_mfma_f32_32x32x16_bf16 v[16:31], v[56:59], v[84:87], v[16:31]
    buffer_load_dwordx4 v[80:83], v4, s[4:7], s32 offen sc1
    ds_read_b64_tr_b16 v[76:77], v15 offset:9216
    ds_read_b64_tr_b16 v[78:79], v15 offset:11264
    v_mfma_f32_32x32x16_bf16 v[32:47], v[60:63], v[84:87], v[32:47]
    buffer_load_dwordx4 v[84:87], v5, s[4:7], s32 offen sc1
    s_add_u32 s32, s32, 16384
    s_add_u32 s47, s47, 131072
    s_waitcnt vmcnt(7) lgkmcnt(0)
    s_barrier
    s_add_u32 m0, s46, 8192
    v_mfma_f32_32x32x16_bf16 v[16:31], v[64:67], v[88:91], v[16:31]
    buffer_load_dwordx4 v14, s[8:11], s47 offen lds
    ds_read_b64_tr_b16 v[48:49], v13 offset:16384
    ds_read_b64_tr_b16 v[50:51], v13 offset:18432
    ds_read_b64_tr_b16 v[52:53], v15 offset:16384
    v_mfma_f32_32x32x16_bf16 v[32:47], v[68:71], v[88:91], v[32:47]
    ds_read_b64_tr_b16 v[54:55], v15 offset:18432
    ds_read_b64_tr_b16 v[56:57], v13 offset:17408
    ds_read_b64_tr_b16 v[58:59], v13 offset:19456
    v_mfma_f32_32x32x16_bf16 v[16:31], v[72:75], v[92:95], v[16:31]
    buffer_load_dwordx4 v[88:91], v4, s[4:7], s32 offen sc1
    ds_read_b64_tr_b16 v[60:61], v15 offset:17408
    ds_read_b64_tr_b16 v[62:63], v15 offset:19456
    v_mfma_f32_32x32x16_bf16 v[32:47], v[76:79], v[92:95], v[32:47]
    buffer_load_dwordx4 v[92:95], v5, s[4:7], s32 offen sc1
    s_add_u32 s32, s32, 16384
    s_add_u32 s47, s47, 131072
    s_waitcnt vmcnt(8) lgkmcnt(0)
    s_barrier
    s_add_u32 m0, s46, 16384
    v_mfma_f32_32x32x16_bf16 v[16:31], v[48:51], v[96:99], v[16:31]
    buffer_load_dwordx4 v14, s[8:11], s47 offen lds
    ds_read_b64_tr_b16 v[64:65], v13 offset:24576
    ds_read_b64_tr_b16 v[66:67], v13 offset:26624
    ds_read_b64_tr_b16 v[68:69], v15 offset:24576
    v_mfma_f32_32x32x16_bf16 v[32:47], v[52:55], v[96:99], v[32:47]
    ds_read_b64_tr_b16 v[70:71], v15 offset:26624
    ds_read_b64_tr_b16 v[72:73], v13 offset:25600
    ds_read_b64_tr_b16 v[74:75], v13 offset:27648
    v_mfma_f32_32x32x16_bf16 v[16:31], v[56:59], v[100:103], v[16:31]
    buffer_load_dwordx4 v[96:99], v4, s[4:7], s32 offen sc1
    ds_read_b64_tr_b16 v[76:77], v15 offset:25600
    ds_read_b64_tr_b16 v[78:79], v15 offset:27648
    v_mfma_f32_32x32x16_bf16 v[32:47], v[60:63], v[100:103], v[32:47]
    buffer_load_dwordx4 v[100:103], v5, s[4:7], s32 offen sc1
    s_add_u32 s32, s32, 16384
    s_add_u32 s47, s47, 131072
    s_waitcnt vmcnt(9) lgkmcnt(0)
    s_barrier
    s_add_u32 m0, s46, 24576
    v_mfma_f32_32x32x16_bf16 v[16:31], v[64:67], v[104:107], v[16:31]
    buffer_load_dwordx4 v14, s[8:11], s47 offen lds
    ds_read_b64_tr_b16 v[48:49], v13 offset:32768
    ds_read_b64_tr_b16 v[50:51], v13 offset:34816
    ds_read_b64_tr_b16 v[52:53], v15 offset:32768
    v_mfma_f32_32x32x16_bf16 v[32:47], v[68:71], v[104:107], v[32:47]
    ds_read_b64_tr_b16 v[54:55], v15 offset:34816
    ds_read_b64_tr_b16 v[56:57], v13 offset:33792
    ds_read_b64_tr_b16 v[58:59], v13 offset:35840
    v_mfma_f32_32x32x16_bf16 v[16:31], v[72:75], v[108:111], v[16:31]
    buffer_load_dwordx4 v[104:107], v4, s[4:7], s32 offen sc1
    ds_read_b64_tr_b16 v[60:61], v15 offset:33792
    ds_read_b64_tr_b16 v[62:63], v15 offset:35840
    v_mfma_f32_32x32x16_bf16 v[32:47], v[76:79], v[108:111], v[32:47]
    buffer_load_dwordx4 v[108:111], v5, s[4:7], s32 offen sc1
    s_add_u32 s32, s32, 16384
    s_add_u32 s47, s47, 131072
    s_waitcnt vmcnt(9) lgkmcnt(0)
    s_barrier
    s_add_u32 m0, s46, 32768
    v_mfma_f32_32x32x16_bf16 v[16:31], v[48:51], v[80:83], v[16:31]
    buffer_load_dwordx4 v14, s[8:11], s47 offen lds
    ds_read_b64_tr_b16 v[64:65], v13 offset:40960
    ds_read_b64_tr_b16 v[66:67], v13 offset:43008
    ds_read_b64_tr_b16 v[68:69], v15 offset:40960
    v_mfma_f32_32x32x16_bf16 v[32:47], v[52:55], v[80:83], v[32:47]
    ds_read_b64_tr_b16 v[70:71], v15 offset:43008
    ds_read_b64_tr_b16 v[72:73], v13 offset:41984
    ds_read_b64_tr_b16 v[74:75], v13 offset:44032
    v_mfma_f32_32x32x16_bf16 v[16:31], v[56:59], v[84:87], v[16:31]
    buffer_load_dwordx4 v[80:83], v4, s[4:7], s32 offen sc1
    ds_read_b64_tr_b16 v[76:77], v15 offset:41984
    ds_read_b64_tr_b16 v[78:79], v15 offset:44032
    v_mfma_f32_32x32x16_bf16 v[32:47], v[60:63], v[84:87], v[32:47]
    buffer_load_dwordx4 v[84:87], v5, s[4:7], s32 offen sc1
    s_add_u32 s32, s32, 16384
    s_add_u32 s47, s47, 131072
    s_waitcnt vmcnt(9) lgkmcnt(0)
    s_barrier
    s_add_u32 m0, s46, 40960
    v_mfma_f32_32x32x16_bf16 v[16:31], v[64:67], v[88:91], v[16:31]
    buffer_load_dwordx4 v14, s[8:11], s47 offen lds
    ds_read_b64_tr_b16 v[48:49], v13 offset:49152
    ds_read_b64_tr_b16 v[50:51], v13 offset:51200
    ds_read_b64_tr_b16 v[52:53], v15 offset:49152
    v_mfma_f32_32x32x16_bf16 v[32:47], v[68:71], v[88:91], v[32:47]
    ds_read_b64_tr_b16 v[54:55], v15 offset:51200
    ds_read_b64_tr_b16 v[56:57], v13 offset:50176
    ds_read_b64_tr_b16 v[58:59], v13 offset:52224
    v_mfma_f32_32x32x16_bf16 v[16:31], v[72:75], v[92:95], v[16:31]
    buffer_load_dwordx4 v[88:91], v4, s[4:7], s32 offen sc1
    ds_read_b64_tr_b16 v[60:61], v15 offset:50176
    ds_read_b64_tr_b16 v[62:63], v15 offset:52224
    v_mfma_f32_32x32x16_bf16 v[32:47], v[76:79], v[92:95], v[32:47]
    buffer_load_dwordx4 v[92:95], v5, s[4:7], s32 offen sc1
    s_add_u32 s32, s32, 16384
    s_add_u32 s47, s47, 131072
    s_waitcnt vmcnt(9) lgkmcnt(0)
    s_barrier
    s_add_u32 m0, s46, 49152
    v_mfma_f32_32x32x16_bf16 v[16:31], v[48:51], v[96:99], v[16:31]
    buffer_load_dwordx4 v14, s[8:11], s47 offen lds
    ds_read_b64_tr_b16 v[64:65], v13 offset:57344
    ds_read_b64_tr_b16 v[66:67], v13 offset:59392
    ds_read_b64_tr_b16 v[68:69], v15 offset:57344
    v_mfma_f32_32x32x16_bf16 v[32:47], v[52:55], v[96:99], v[32:47]
    ds_read_b64_tr_b16 v[70:71], v15 offset:59392
    ds_read_b64_tr_b16 v[72:73], v13 offset:58368
    ds_read_b64_tr_b16 v[74:75], v13 offset:60416
    v_mfma_f32_32x32x16_bf16 v[16:31], v[56:59], v[100:103], v[16:31]
    buffer_load_dwordx4 v[96:99], v4, s[4:7], s32 offen sc1
    ds_read_b64_tr_b16 v[76:77], v15 offset:58368
    ds_read_b64_tr_b16 v[78:79], v15 offset:60416
    v_mfma_f32_32x32x16_bf16 v[32:47], v[60:63], v[100:103], v[32:47]
    buffer_load_dwordx4 v[100:103], v5, s[4:7], s32 offen sc1
    s_add_u32 s32, s32, 16384
    s_add_u32 s47, s47, 131072
    s_waitcnt vmcnt(9) lgkmcnt(0)
    s_barrier
    s_add_u32 m0, s46, 57344
    v_mfma_f32_32x32x16_bf16 v[16:31], v[64:67], v[104:107], v[16:31]
    buffer_load_dwordx4 v14, s[8:11], s47 offen lds
    ds_read_b64_tr_b16 v[48:49], v6 offset:0
    ds_read_b64_tr_b16 v[50:51], v6 offset:2048
    ds_read_b64_tr_b16 v[52:53], v7 offset:0
    v_mfma_f32_32x32x16_bf16 v[32:47], v[68:71], v[104:107], v[32:47]
    ds_read_b64_tr_b16 v[54:55], v7 offset:2048
    ds_read_b64_tr_b16 v[56:57], v6 offset:1024
    ds_read_b64_tr_b16 v[58:59], v6 offset:3072
    v_mfma_f32_32x32x16_bf16 v[16:31], v[72:75], v[108:111], v[16:31]
    buffer_load_dwordx4 v[104:107], v4, s[4:7], s32 offen sc1
    ds_read_b64_tr_b16 v[60:61], v7 offset:1024
    ds_read_b64_tr_b16 v[62:63], v7 offset:3072
    v_mfma_f32_32x32x16_bf16 v[32:47], v[76:79], v[108:111], v[32:47]
    buffer_load_dwordx4 v[108:111], v5, s[4:7], s32 offen sc1
    s_add_u32 s32, s32, 16384
    s_add_u32 s47, s47, 131072
    s_waitcnt vmcnt(9) lgkmcnt(0)
    s_barrier
    s_add_u32 m0, s46, 65536
    v_mfma_f32_32x32x16_bf16 v[16:31], v[48:51], v[80:83], v[16:31]
    buffer_load_dwordx4 v14, s[8:11], s47 offen lds
    ds_read_b64_tr_b16 v[64:65], v6 offset:8192
    ds_read_b64_tr_b16 v[66:67], v6 offset:10240
    ds_read_b64_tr_b16 v[68:69], v7 offset:8192
    v_mfma_f32_32x32x16_bf16 v[32:47], v[52:55], v[80:83], v[32:47]
    ds_read_b64_tr_b16 v[70:71], v7 offset:10240
    ds_read_b64_tr_b16 v[72:73], v6 offset:9216
    ds_read_b64_tr_b16 v[74:75], v6 offset:11264
    v_mfma_f32_32x32x16_bf16 v[16:31], v[56:59], v[84:87], v[16:31]
    buffer_load_dwordx4 v[80:83], v4, s[4:7], s32 offen sc1
    ds_read_b64_tr_b16 v[76:77], v7 offset:9216
    ds_read_b64_tr_b16 v[78:79], v7 offset:11264
    v_mfma_f32_32x32x16_bf16 v[32:47], v[60:63], v[84:87], v[32:47]
    buffer_load_dwordx4 v[84:87], v5, s[4:7], s32 offen sc1
    s_add_u32 s32, s32, 16384
    s_add_u32 s47, s47, 131072
    s_waitcnt vmcnt(9) lgkmcnt(0)
    s_barrier
    s_add_u32 m0, s46, 73728
    v_mfma_f32_32x32x16_bf16 v[16:31], v[64:67], v[88:91], v[16:31]
    buffer_load_dwordx4 v14, s[8:11], s47 offen lds
    ds_read_b64_tr_b16 v[48:49], v6 offset:16384
    ds_read_b64_tr_b16 v[50:51], v6 offset:18432
    ds_read_b64_tr_b16 v[52:53], v7 offset:16384
    v_mfma_f32_32x32x16_bf16 v[32:47], v[68:71], v[88:91], v[32:47]
    ds_read_b64_tr_b16 v[54:55], v7 offset:18432
    ds_read_b64_tr_b16 v[56:57], v6 offset:17408
    ds_read_b64_tr_b16 v[58:59], v6 offset:19456
    v_mfma_f32_32x32x16_bf16 v[16:31], v[72:75], v[92:95], v[16:31]
    buffer_load_dwordx4 v[88:91], v4, s[4:7], s32 offen sc1
    ds_read_b64_tr_b16 v[60:61], v7 offset:17408
    ds_read_b64_tr_b16 v[62:63], v7 offset:19456
    v_mfma_f32_32x32x16_bf16 v[32:47], v[76:79], v[92:95], v[32:47]
    buffer_load_dwordx4 v[92:95], v5, s[4:7], s32 offen sc1
    s_add_u32 s32, s32, 16384
    s_add_u32 s47, s47, 131072
    s_waitcnt vmcnt(9) lgkmcnt(0)
    s_barrier
    s_add_u32 m0, s46, 81920
    v_mfma_f32_32x32x16_bf16 v[16:31], v[48:51], v[96:99], v[16:31]
    buffer_load_dwordx4 v14, s[8:11], s47 offen lds
    ds_read_b64_tr_b16 v[64:65], v6 offset:24576
    ds_read_b64_tr_b16 v[66:67], v6 offset:26624
    ds_read_b64_tr_b16 v[68:69], v7 offset:24576
    v_mfma_f32_32x32x16_bf16 v[32:47], v[52:55], v[96:99], v[32:47]
    ds_read_b64_tr_b16 v[70:71], v7 offset:26624
    ds_read_b64_tr_b16 v[72:73], v6 offset:25600
    ds_read_b64_tr_b16 v[74:75], v6 offset:27648
    v_mfma_f32_32x32x16_bf16 v[16:31], v[56:59], v[100:103], v[16:31]
    buffer_load_dwordx4 v[96:99], v4, s[4:7], s32 offen sc1
    ds_read_b64_tr_b16 v[76:77], v7 offset:25600
    ds_read_b64_tr_b16 v[78:79], v7 offset:27648
    v_mfma_f32_32x32x16_bf16 v[32:47], v[60:63], v[100:103], v[32:47]
    buffer_load_dwordx4 v[100:103], v5, s[4:7], s32 offen sc1
    s_add_u32 s32, s32, 16384
    s_add_u32 s47, s47, 131072
    s_waitcnt vmcnt(9) lgkmcnt(0)
    s_barrier
    s_add_u32 m0, s46, 90112
    v_mfma_f32_32x32x16_bf16 v[16:31], v[64:67], v[104:107], v[16:31]
    buffer_load_dwordx4 v14, s[8:11], s47 offen lds
    ds_read_b64_tr_b16 v[48:49], v6 offset:32768
    ds_read_b64_tr_b16 v[50:51], v6 offset:34816
    ds_read_b64_tr_b16 v[52:53], v7 offset:32768
    v_mfma_f32_32x32x16_bf16 v[32:47], v[68:71], v[104:107], v[32:47]
    ds_read_b64_tr_b16 v[54:55], v7 offset:34816
    ds_read_b64_tr_b16 v[56:57], v6 offset:33792
    ds_read_b64_tr_b16 v[58:59], v6 offset:35840
    v_mfma_f32_32x32x16_bf16 v[16:31], v[72:75], v[108:111], v[16:31]
    buffer_load_dwordx4 v[104:107], v4, s[4:7], s32 offen sc1
    ds_read_b64_tr_b16 v[60:61], v7 offset:33792
    ds_read_b64_tr_b16 v[62:63], v7 offset:35840
    v_mfma_f32_32x32x16_bf16 v[32:47], v[76:79], v[108:111], v[32:47]
    buffer_load_dwordx4 v[108:111], v5, s[4:7], s32 offen sc1
    s_add_u32 s32, s32, 16384
    s_add_u32 s47, s47, 131072
    s_waitcnt vmcnt(9) lgkmcnt(0)
    s_barrier
    s_add_u32 m0, s46, 98304
    v_mfma_f32_32x32x16_bf16 v[16:31], v[48:51], v[80:83], v[16:31]
    buffer_load_dwordx4 v14, s[8:11], s47 offen lds
    ds_read_b64_tr_b16 v[64:65], v6 offset:40960
    ds_read_b64_tr_b16 v[66:67], v6 offset:43008
    ds_read_b64_tr_b16 v[68:69], v7 offset:40960
    v_mfma_f32_32x32x16_bf16 v[32:47], v[52:55], v[80:83], v[32:47]
    ds_read_b64_tr_b16 v[70:71], v7 offset:43008
    ds_read_b64_tr_b16 v[72:73], v6 offset:41984
    ds_read_b64_tr_b16 v[74:75], v6 offset:44032
    v_mfma_f32_32x32x16_bf16 v[16:31], v[56:59], v[84:87], v[16:31]
    buffer_load_dwordx4 v[80:83], v4, s[4:7], s32 offen sc1
    ds_read_b64_tr_b16 v[76:77], v7 offset:41984
    ds_read_b64_tr_b16 v[78:79], v7 offset:44032
    v_mfma_f32_32x32x16_bf16 v[32:47], v[60:63], v[84:87], v[32:47]
    buffer_load_dwordx4 v[84:87], v5, s[4:7], s32 offen sc1
    s_add_u32 s32, s32, 16384
    s_add_u32 s47, s47, 131072
    s_waitcnt vmcnt(9) lgkmcnt(0)
    s_barrier
    s_add_u32 m0, s46, 106496
    v_mfma_f32_32x32x16_bf16 v[16:31], v[64:67], v[88:91], v[16:31]
    buffer_load_dwordx4 v14, s[8:11], s47 offen lds
    ds_read_b64_tr_b16 v[48:49], v6 offset:49152
    ds_read_b64_tr_b16 v[50:51], v6 offset:51200
    ds_read_b64_tr_b16 v[52:53], v7 offset:49152
    v_mfma_f32_32x32x16_bf16 v[32:47], v[68:71], v[88:91], v[32:47]
    ds_read_b64_tr_b16 v[54:55], v7 offset:51200
    ds_read_b64_tr_b16 v[56:57], v6 offset:50176
    ds_read_b64_tr_b16 v[58:59], v6 offset:52224
    v_mfma_f32_32x32x16_bf16 v[16:31], v[72:75], v[92:95], v[16:31]
    buffer_load_dwordx4 v[88:91], v4, s[4:7], s32 offen sc1
    ds_read_b64_tr_b16 v[60:61], v7 offset:50176
    ds_read_b64_tr_b16 v[62:63], v7 offset:52224
    v_mfma_f32_32x32x16_bf16 v[32:47], v[76:79], v[92:95], v[32:47]
    buffer_load_dwordx4 v[92:95], v5, s[4:7], s32 offen sc1
    s_add_u32 s32, s32, 16384
    s_add_u32 s47, s47, 131072
    s_waitcnt vmcnt(9) lgkmcnt(0)
    s_barrier
    s_add_u32 m0, s46, 114688
    v_mfma_f32_32x32x16_bf16 v[16:31], v[48:51], v[96:99], v[16:31]
    buffer_load_dwordx4 v14, s[8:11], s47 offen lds
    ds_read_b64_tr_b16 v[64:65], v6 offset:57344
    ds_read_b64_tr_b16 v[66:67], v6 offset:59392
    ds_read_b64_tr_b16 v[68:69], v7 offset:57344
    v_mfma_f32_32x32x16_bf16 v[32:47], v[52:55], v[96:99], v[32:47]
    ds_read_b64_tr_b16 v[70:71], v7 offset:59392
    ds_read_b64_tr_b16 v[72:73], v6 offset:58368
    ds_read_b64_tr_b16 v[74:75], v6 offset:60416
    v_mfma_f32_32x32x16_bf16 v[16:31], v[56:59], v[100:103], v[16:31]
    buffer_load_dwordx4 v[96:99], v4, s[4:7], s32 offen sc1
    ds_read_b64_tr_b16 v[76:77], v7 offset:58368
    ds_read_b64_tr_b16 v[78:79], v7 offset:60416
    v_mfma_f32_32x32x16_bf16 v[32:47], v[60:63], v[100:103], v[32:47]
    buffer_load_dwordx4 v[100:103], v5, s[4:7], s32 offen sc1
    s_add_u32 s32, s32, 16384
    s_add_u32 s47, s47, 131072
    buffer_load_dword v238, v239, s[36:39], s33 offen
    s_waitcnt vmcnt(10) lgkmcnt(0)
    s_barrier
    s_add_u32 m0, s46, 122880
    v_mfma_f32_32x32x16_bf16 v[16:31], v[64:67], v[104:107], v[16:31]
    buffer_load_dwordx4 v14, s[8:11], s47 offen lds
    ds_read_b64_tr_b16 v[48:49], v13 offset:0
    ds_read_b64_tr_b16 v[50:51], v13 offset:2048
    ds_read_b64_tr_b16 v[52:53], v15 offset:0
    v_mfma_f32_32x32x16_bf16 v[32:47], v[68:71], v[104:107], v[32:47]
    ds_read_b64_tr_b16 v[54:55], v15 offset:2048
    ds_read_b64_tr_b16 v[56:57], v13 offset:1024
    ds_read_b64_tr_b16 v[58:59], v13 offset:3072
    v_mfma_f32_32x32x16_bf16 v[16:31], v[72:75], v[108:111], v[16:31]
    buffer_load_dwordx4 v[104:107], v4, s[4:7], s32 offen sc1
    ds_read_b64_tr_b16 v[60:61], v15 offset:1024
    ds_read_b64_tr_b16 v[62:63], v15 offset:3072
    v_mfma_f32_32x32x16_bf16 v[32:47], v[76:79], v[108:111], v[32:47]
    buffer_load_dwordx4 v[108:111], v5, s[4:7], s32 offen sc1
    s_add_u32 s32, s32, 16384
    s_add_u32 s47, s47, 131072
    s_waitcnt vmcnt(10) lgkmcnt(0)
    s_barrier
    s_add_u32 m0, s46, 0
    v_mfma_f32_32x32x16_bf16 v[16:31], v[48:51], v[80:83], v[16:31]
    buffer_load_dwordx4 v14, s[8:11], s47 offen lds
    ds_read_b64_tr_b16 v[64:65], v13 offset:8192
    ds_read_b64_tr_b16 v[66:67], v13 offset:10240
    ds_read_b64_tr_b16 v[68:69], v15 offset:8192
    v_mfma_f32_32x32x16_bf16 v[32:47], v[52:55], v[80:83], v[32:47]
    ds_read_b64_tr_b16 v[70:71], v15 offset:10240
    ds_read_b64_tr_b16 v[72:73], v13 offset:9216
    ds_read_b64_tr_b16 v[74:75], v13 offset:11264
    v_mfma_f32_32x32x16_bf16 v[16:31], v[56:59], v[84:87], v[16:31]
    buffer_load_dwordx4 v[80:83], v4, s[4:7], s32 offen sc1
    ds_read_b64_tr_b16 v[76:77], v15 offset:9216
    ds_read_b64_tr_b16 v[78:79], v15 offset:11264
    v_mfma_f32_32x32x16_bf16 v[32:47], v[60:63], v[84:87], v[32:47]
    buffer_load_dwordx4 v[84:87], v5, s[4:7], s32 offen sc1
    s_add_u32 s32, s32, 16384
    s_add_u32 s47, s47, 131072
    s_waitcnt vmcnt(10) lgkmcnt(0)
    s_barrier
    s_add_u32 m0, s46, 8192
    v_mfma_f32_32x32x16_bf16 v[16:31], v[64:67], v[88:91], v[16:31]
    buffer_load_dwordx4 v14, s[8:11], s47 offen lds
    ds_read_b64_tr_b16 v[48:49], v13 offset:16384
    ds_read_b64_tr_b16 v[50:51], v13 offset:18432
    ds_read_b64_tr_b16 v[52:53], v15 offset:16384
    v_mfma_f32_32x32x16_bf16 v[32:47], v[68:71], v[88:91], v[32:47]
    ds_read_b64_tr_b16 v[54:55], v15 offset:18432
    ds_read_b64_tr_b16 v[56:57], v13 offset:17408
    ds_read_b64_tr_b16 v[58:59], v13 offset:19456
    v_mfma_f32_32x32x16_bf16 v[16:31], v[72:75], v[92:95], v[16:31]
    buffer_load_dwordx4 v[88:91], v4, s[4:7], s32 offen sc1
    ds_read_b64_tr_b16 v[60:61], v15 offset:17408
    ds_read_b64_tr_b16 v[62:63], v15 offset:19456
    v_mfma_f32_32x32x16_bf16 v[32:47], v[76:79], v[92:95], v[32:47]
    buffer_load_dwordx4 v[92:95], v5, s[4:7], s32 offen sc1
    s_add_u32 s32, s32, 16384
    s_add_u32 s47, s47, 131072
    s_waitcnt vmcnt(10) lgkmcnt(0)
    s_barrier
    s_add_u32 m0, s46, 16384
    v_mfma_f32_32x32x16_bf16 v[16:31], v[48:51], v[96:99], v[16:31]
    buffer_load_dwordx4 v14, s[8:11], s47 offen lds
    ds_read_b64_tr_b16 v[64:65], v13 offset:24576
    ds_read_b64_tr_b16 v[66:67], v13 offset:26624
    ds_read_b64_tr_b16 v[68:69], v15 offset:24576
    v_mfma_f32_32x32x16_bf16 v[32:47], v[52:55], v[96:99], v[32:47]
    ds_read_b64_tr_b16 v[70:71], v15 offset:26624
    ds_read_b64_tr_b16 v[72:73], v13 offset:25600
    ds_read_b64_tr_b16 v[74:75], v13 offset:27648
    v_mfma_f32_32x32x16_bf16 v[16:31], v[56:59], v[100:103], v[16:31]
    buffer_load_dwordx4 v[96:99], v4, s[4:7], s32 offen sc1
    ds_read_b64_tr_b16 v[76:77], v15 offset:25600
    ds_read_b64_tr_b16 v[78:79], v15 offset:27648
    v_mfma_f32_32x32x16_bf16 v[32:47], v[60:63], v[100:103], v[32:47]
    buffer_load_dwordx4 v[100:103], v5, s[4:7], s32 offen sc1
    s_add_u32 s32, s32, 16384
    s_add_u32 s47, s47, 131072
    s_waitcnt vmcnt(9) lgkmcnt(0)
    s_barrier
    s_add_u32 m0, s46, 24576
    v_mfma_f32_32x32x16_bf16 v[16:31], v[64:67], v[104:107], v[16:31]
    buffer_load_dwordx4 v14, s[8:11], s47 offen lds
    ds_read_b64_tr_b16 v[48:49], v13 offset:32768
    ds_read_b64_tr_b16 v[50:51], v13 offset:34816
    ds_read_b64_tr_b16 v[52:53], v15 offset:32768
    v_mfma_f32_32x32x16_bf16 v[32:47], v[68:71], v[104:107], v[32:47]
    ds_read_b64_tr_b16 v[54:55], v15 offset:34816
    ds_read_b64_tr_b16 v[56:57], v13 offset:33792
    ds_read_b64_tr_b16 v[58:59], v13 offset:35840
    v_mfma_f32_32x32x16_bf16 v[16:31], v[72:75], v[108:111], v[16:31]
    buffer_load_dwordx4 v[104:107], v4, s[4:7], s32 offen sc1
    ds_read_b64_tr_b16 v[60:61], v15 offset:33792
    ds_read_b64_tr_b16 v[62:63], v15 offset:35840
    v_mfma_f32_32x32x16_bf16 v[32:47], v[76:79], v[108:111], v[32:47]
    buffer_load_dwordx4 v[108:111], v5, s[4:7], s32 offen sc1
    s_add_u32 s32, s32, 16384
    s_add_u32 s47, s47, 131072
    s_waitcnt vmcnt(9) lgkmcnt(0)
    s_barrier
    s_add_u32 m0, s46, 32768
    v_mfma_f32_32x32x16_bf16 v[16:31], v[48:51], v[80:83], v[16:31]
    buffer_load_dwordx4 v14, s[8:11], s47 offen lds
    ds_read_b64_tr_b16 v[64:65], v13 offset:40960
    ds_read_b64_tr_b16 v[66:67], v13 offset:43008
    ds_read_b64_tr_b16 v[68:69], v15 offset:40960
    v_mfma_f32_32x32x16_bf16 v[32:47], v[52:55], v[80:83], v[32:47]
    ds_read_b64_tr_b16 v[70:71], v15 offset:43008
    ds_read_b64_tr_b16 v[72:73], v13 offset:41984
    ds_read_b64_tr_b16 v[74:75], v13 offset:44032
    v_mfma_f32_32x32x16_bf16 v[16:31], v[56:59], v[84:87], v[16:31]
    buffer_load_dwordx4 v[80:83], v4, s[4:7], s32 offen sc1
    ds_read_b64_tr_b16 v[76:77], v15 offset:41984
    ds_read_b64_tr_b16 v[78:79], v15 offset:44032
    v_mfma_f32_32x32x16_bf16 v[32:47], v[60:63], v[84:87], v[32:47]
    buffer_load_dwordx4 v[84:87], v5, s[4:7], s32 offen sc1
    s_add_u32 s32, s32, 16384
    s_add_u32 s47, s47, 131072
    s_waitcnt vmcnt(9) lgkmcnt(0)
    s_barrier
    s_add_u32 m0, s46, 40960
    v_mfma_f32_32x32x16_bf16 v[16:31], v[64:67], v[88:91], v[16:31]
    buffer_load_dwordx4 v14, s[8:11], s47 offen lds
    ds_read_b64_tr_b16 v[48:49], v13 offset:49152
    ds_read_b64_tr_b16 v[50:51], v13 offset:51200
    ds_read_b64_tr_b16 v[52:53], v15 offset:49152
    v_mfma_f32_32x32x16_bf16 v[32:47], v[68:71], v[88:91], v[32:47]
    ds_read_b64_tr_b16 v[54:55], v15 offset:51200
    ds_read_b64_tr_b16 v[56:57], v13 offset:50176
    ds_read_b64_tr_b16 v[58:59], v13 offset:52224
    v_mfma_f32_32x32x16_bf16 v[16:31], v[72:75], v[92:95], v[16:31]
    buffer_load_dwordx4 v[88:91], v4, s[4:7], s32 offen sc1
    ds_read_b64_tr_b16 v[60:61], v15 offset:50176
    ds_read_b64_tr_b16 v[62:63], v15 offset:52224
    v_mfma_f32_32x32x16_bf16 v[32:47], v[76:79], v[92:95], v[32:47]
    buffer_load_dwordx4 v[92:95], v5, s[4:7], s32 offen sc1
    s_add_u32 s32, s32, 16384
    s_add_u32 s47, s47, 131072
    s_waitcnt vmcnt(9) lgkmcnt(0)
    s_barrier
    s_add_u32 m0, s46, 49152
    v_mfma_f32_32x32x16_bf16 v[16:31], v[48:51], v[96:99], v[16:31]
    buffer_load_dwordx4 v14, s[8:11], s47 offen lds
    ds_read_b64_tr_b16 v[64:65], v13 offset:57344
    ds_read_b64_tr_b16 v[66:67], v13 offset:59392
    ds_read_b64_tr_b16 v[68:69], v15 offset:57344
    v_mfma_f32_32x32x16_bf16 v[32:47], v[52:55], v[96:99], v[32:47]
    ds_read_b64_tr_b16 v[70:71], v15 offset:59392
    ds_read_b64_tr_b16 v[72:73], v13 offset:58368
    ds_read_b64_tr_b16 v[74:75], v13 offset:60416
    v_mfma_f32_32x32x16_bf16 v[16:31], v[56:59], v[100:103], v[16:31]
    buffer_load_dwordx4 v[96:99], v4, s[4:7], s32 offen sc1
    ds_read_b64_tr_b16 v[76:77], v15 offset:58368
    ds_read_b64_tr_b16 v[78:79], v15 offset:60416
    v_mfma_f32_32x32x16_bf16 v[32:47], v[60:63], v[100:103], v[32:47]
    buffer_load_dwordx4 v[100:103], v5, s[4:7], s32 offen sc1
    s_add_u32 s32, s32, 16384
    s_add_u32 s47, s47, 131072
    s_waitcnt vmcnt(9) lgkmcnt(0)
    s_barrier
    s_add_u32 m0, s46, 57344
    v_mfma_f32_32x32x16_bf16 v[16:31], v[64:67], v[104:107], v[16:31]
    buffer_load_dwordx4 v14, s[8:11], s47 offen lds
    ds_read_b64_tr_b16 v[48:49], v6 offset:0
    ds_read_b64_tr_b16 v[50:51], v6 offset:2048
    ds_read_b64_tr_b16 v[52:53], v7 offset:0
    v_mfma_f32_32x32x16_bf16 v[32:47], v[68:71], v[104:107], v[32:47]
    ds_read_b64_tr_b16 v[54:55], v7 offset:2048
    ds_read_b64_tr_b16 v[56:57], v6 offset:1024
    ds_read_b64_tr_b16 v[58:59], v6 offset:3072
    v_mfma_f32_32x32x16_bf16 v[16:31], v[72:75], v[108:111], v[16:31]
    buffer_load_dwordx4 v[104:107], v4, s[4:7], s32 offen sc1
    ds_read_b64_tr_b16 v[60:61], v7 offset:1024
    ds_read_b64_tr_b16 v[62:63], v7 offset:3072
    v_mfma_f32_32x32x16_bf16 v[32:47], v[76:79], v[108:111], v[32:47]
    buffer_load_dwordx4 v[108:111], v5, s[4:7], s32 offen sc1
    s_add_u32 s32, s32, 16384
    s_add_u32 s47, s47, 131072
    s_waitcnt vmcnt(9) lgkmcnt(0)
    s_barrier
    s_add_u32 m0, s46, 65536
    v_mfma_f32_32x32x16_bf16 v[16:31], v[48:51], v[80:83], v[16:31]
    buffer_load_dwordx4 v14, s[8:11], s47 offen lds
    ds_read_b64_tr_b16 v[64:65], v6 offset:8192
    ds_read_b64_tr_b16 v[66:67], v6 offset:10240
    ds_read_b64_tr_b16 v[68:69], v7 offset:8192
    v_mfma_f32_32x32x16_bf16 v[32:47], v[52:55], v[80:83], v[32:47]
    ds_read_b64_tr_b16 v[70:71], v7 offset:10240
    ds_read_b64_tr_b16 v[72:73], v6 offset:9216
    ds_read_b64_tr_b16 v[74:75], v6 offset:11264
    v_mfma_f32_32x32x16_bf16 v[16:31], v[56:59], v[84:87], v[16:31]
    buffer_load_dwordx4 v[80:83], v4, s[4:7], s32 offen sc1
    ds_read_b64_tr_b16 v[76:77], v7 offset:9216
    ds_read_b64_tr_b16 v[78:79], v7 offset:11264
    v_mfma_f32_32x32x16_bf16 v[32:47], v[60:63], v[84:87], v[32:47]
    buffer_load_dwordx4 v[84:87], v5, s[4:7], s32 offen sc1
    s_add_u32 s32, s32, 16384
    s_add_u32 s47, s47, 131072
    s_waitcnt vmcnt(9) lgkmcnt(0)
    s_barrier
    s_add_u32 m0, s46, 73728
    v_mfma_f32_32x32x16_bf16 v[16:31], v[64:67], v[88:91], v[16:31]
    buffer_load_dwordx4 v14, s[8:11], s47 offen lds
    ds_read_b64_tr_b16 v[48:49], v6 offset:16384
    ds_read_b64_tr_b16 v[50:51], v6 offset:18432
    ds_read_b64_tr_b16 v[52:53], v7 offset:16384
    v_mfma_f32_32x32x16_bf16 v[32:47], v[68:71], v[88:91], v[32:47]
    ds_read_b64_tr_b16 v[54:55], v7 offset:18432
    ds_read_b64_tr_b16 v[56:57], v6 offset:17408
    ds_read_b64_tr_b16 v[58:59], v6 offset:19456
    v_mfma_f32_32x32x16_bf16 v[16:31], v[72:75], v[92:95], v[16:31]
    buffer_load_dwordx4 v[88:91], v4, s[4:7], s32 offen sc1
    ds_read_b64_tr_b16 v[60:61], v7 offset:17408
    ds_read_b64_tr_b16 v[62:63], v7 offset:19456
    v_mfma_f32_32x32x16_bf16 v[32:47], v[76:79], v[92:95], v[32:47]
    buffer_load_dwordx4 v[92:95], v5, s[4:7], s32 offen sc1
    s_add_u32 s32, s32, 16384
    s_add_u32 s47, s47, 131072
    s_waitcnt vmcnt(9) lgkmcnt(0)
    s_barrier
    s_add_u32 m0, s46, 81920
    v_mfma_f32_32x32x16_bf16 v[16:31], v[48:51], v[96:99], v[16:31]
    buffer_load_dwordx4 v14, s[8:11], s47 offen lds
    ds_read_b64_tr_b16 v[64:65], v6 offset:24576
    ds_read_b64_tr_b16 v[66:67], v6 offset:26624
    ds_read_b64_tr_b16 v[68:69], v7 offset:24576
    v_mfma_f32_32x32x16_bf16 v[32:47], v[52:55], v[96:99], v[32:47]
    ds_read_b64_tr_b16 v[70:71], v7 offset:26624
    ds_read_b64_tr_b16 v[72:73], v6 offset:25600
    ds_read_b64_tr_b16 v[74:75], v6 offset:27648
    v_mfma_f32_32x32x16_bf16 v[16:31], v[56:59], v[100:103], v[16:31]
    buffer_load_dwordx4 v[96:99], v4, s[4:7], s32 offen sc1
    ds_read_b64_tr_b16 v[76:77], v7 offset:25600
    ds_read_b64_tr_b16 v[78:79], v7 offset:27648
    v_mfma_f32_32x32x16_bf16 v[32:47], v[60:63], v[100:103], v[32:47]
    buffer_load_dwordx4 v[100:103], v5, s[4:7], s32 offen sc1
    s_add_u32 s32, s32, 16384
    s_add_u32 s47, s47, 131072
    buffer_load_dword v9, v12, s[48:51], 0 offen sc1
    s_waitcnt vmcnt(10) lgkmcnt(0)
    s_barrier
    s_add_u32 m0, s46, 90112
    v_mfma_f32_32x32x16_bf16 v[16:31], v[64:67], v[104:107], v[16:31]
    buffer_load_dwordx4 v14, s[8:11], s47 offen lds
    ds_read_b64_tr_b16 v[48:49], v6 offset:32768
    ds_read_b64_tr_b16 v[50:51], v6 offset:34816
    ds_read_b64_tr_b16 v[52:53], v7 offset:32768
    v_mfma_f32_32x32x16_bf16 v[32:47], v[68:71], v[104:107], v[32:47]
    ds_read_b64_tr_b16 v[54:55], v7 offset:34816
    ds_read_b64_tr_b16 v[56:57], v6 offset:33792
    ds_read_b64_tr_b16 v[58:59], v6 offset:35840
    v_mfma_f32_32x32x16_bf16 v[16:31], v[72:75], v[108:111], v[16:31]
    buffer_load_dwordx4 v[104:107], v4, s[4:7], s32 offen sc1
    ds_read_b64_tr_b16 v[60:61], v7 offset:33792
    ds_read_b64_tr_b16 v[62:63], v7 offset:35840
    v_mfma_f32_32x32x16_bf16 v[32:47], v[76:79], v[108:111], v[32:47]
    buffer_load_dwordx4 v[108:111], v5, s[4:7], s32 offen sc1
    s_add_u32 s32, s32, 16384
    s_add_u32 s47, s47, 131072
    s_waitcnt vmcnt(10) lgkmcnt(0)
    s_barrier
    s_add_u32 m0, s46, 98304
    v_mfma_f32_32x32x16_bf16 v[16:31], v[48:51], v[80:83], v[16:31]
    buffer_load_dwordx4 v14, s[8:11], s47 offen lds
    ds_read_b64_tr_b16 v[64:65], v6 offset:40960
    ds_read_b64_tr_b16 v[66:67], v6 offset:43008
    ds_read_b64_tr_b16 v[68:69], v7 offset:40960
    v_mfma_f32_32x32x16_bf16 v[32:47], v[52:55], v[80:83], v[32:47]
    ds_read_b64_tr_b16 v[70:71], v7 offset:43008
    ds_read_b64_tr_b16 v[72:73], v6 offset:41984
    ds_read_b64_tr_b16 v[74:75], v6 offset:44032
    v_mfma_f32_32x32x16_bf16 v[16:31], v[56:59], v[84:87], v[16:31]
    buffer_load_dwordx4 v[80:83], v4, s[4:7], s32 offen sc1
    ds_read_b64_tr_b16 v[76:77], v7 offset:41984
    ds_read_b64_tr_b16 v[78:79], v7 offset:44032
    v_mfma_f32_32x32x16_bf16 v[32:47], v[60:63], v[84:87], v[32:47]
    buffer_load_dwordx4 v[84:87], v5, s[4:7], s32 offen sc1
    s_add_u32 s32, s32, 16384
    s_add_u32 s47, s47, 131072
    s_waitcnt vmcnt(10) lgkmcnt(0)
    s_barrier
    s_add_u32 m0, s46, 106496
    v_mfma_f32_32x32x16_bf16 v[16:31], v[64:67], v[88:91], v[16:31]
    buffer_load_dwordx4 v14, s[8:11], s47 offen lds
    ds_read_b64_tr_b16 v[48:49], v6 offset:49152
    ds_read_b64_tr_b16 v[50:51], v6 offset:51200
    ds_read_b64_tr_b16 v[52:53], v7 offset:49152
    v_mfma_f32_32x32x16_bf16 v[32:47], v[68:71], v[88:91], v[32:47]
    ds_read_b64_tr_b16 v[54:55], v7 offset:51200
    ds_read_b64_tr_b16 v[56:57], v6 offset:50176
    ds_read_b64_tr_b16 v[58:59], v6 offset:52224
    v_mfma_f32_32x32x16_bf16 v[16:31], v[72:75], v[92:95], v[16:31]
    buffer_load_dwordx4 v[88:91], v4, s[4:7], s32 offen sc1
    ds_read_b64_tr_b16 v[60:61], v7 offset:50176
    ds_read_b64_tr_b16 v[62:63], v7 offset:52224
    v_mfma_f32_32x32x16_bf16 v[32:47], v[76:79], v[92:95], v[32:47]
    buffer_load_dwordx4 v[92:95], v5, s[4:7], s32 offen sc1
    s_add_u32 s32, s32, 16384
    s_add_u32 s47, s47, 131072
    s_waitcnt vmcnt(10) lgkmcnt(0)
    s_barrier
    s_add_u32 m0, s46, 114688
    v_mfma_f32_32x32x16_bf16 v[16:31], v[48:51], v[96:99], v[16:31]
    buffer_load_dwordx4 v14, s[8:11], s47 offen lds
    ds_read_b64_tr_b16 v[64:65], v6 offset:57344
    ds_read_b64_tr_b16 v[66:67], v6 offset:59392
    ds_read_b64_tr_b16 v[68:69], v7 offset:57344
    v_mfma_f32_32x32x16_bf16 v[32:47], v[52:55], v[96:99], v[32:47]
    ds_read_b64_tr_b16 v[70:71], v7 offset:59392
    ds_read_b64_tr_b16 v[72:73], v6 offset:58368
    ds_read_b64_tr_b16 v[74:75], v6 offset:60416
    v_mfma_f32_32x32x16_bf16 v[16:31], v[56:59], v[100:103], v[16:31]
    buffer_load_dwordx4 v[96:99], v4, s[4:7], s32 offen sc1
    ds_read_b64_tr_b16 v[76:77], v7 offset:58368
    ds_read_b64_tr_b16 v[78:79], v7 offset:60416
    v_mfma_f32_32x32x16_bf16 v[32:47], v[60:63], v[100:103], v[32:47]
    buffer_load_dwordx4 v[100:103], v5, s[4:7], s32 offen sc1
    s_add_u32 s32, s32, 16384
    s_add_u32 s47, s47, 131072
    s_waitcnt vmcnt(9) lgkmcnt(0)
    s_barrier
    s_add_u32 m0, s46, 122880
    v_mfma_f32_32x32x16_bf16 v[16:31], v[64:67], v[104:107], v[16:31]
    buffer_load_dwordx4 v14, s[8:11], s47 offen lds
    ds_read_b64_tr_b16 v[48:49], v13 offset:0
    ds_read_b64_tr_b16 v[50:51], v13 offset:2048
    ds_read_b64_tr_b16 v[52:53], v15 offset:0
    v_mfma_f32_32x32x16_bf16 v[32:47], v[68:71], v[104:107], v[32:47]
    ds_read_b64_tr_b16 v[54:55], v15 offset:2048
    ds_read_b64_tr_b16 v[56:57], v13 offset:1024
    ds_read_b64_tr_b16 v[58:59], v13 offset:3072
    v_mfma_f32_32x32x16_bf16 v[16:31], v[72:75], v[108:111], v[16:31]
    buffer_load_dwordx4 v[104:107], v4, s[4:7], s32 offen sc1
    ds_read_b64_tr_b16 v[60:61], v15 offset:1024
    ds_read_b64_tr_b16 v[62:63], v15 offset:3072
    v_mfma_f32_32x32x16_bf16 v[32:47], v[76:79], v[108:111], v[32:47]
    buffer_load_dwordx4 v[108:111], v5, s[4:7], s32 offen sc1
    s_add_u32 s32, s32, 16384
    s_add_u32 s47, s47, 131072
    s_waitcnt vmcnt(9) lgkmcnt(0)
    s_barrier
    s_add_u32 m0, s46, 0
    v_mfma_f32_32x32x16_bf16 v[16:31], v[48:51], v[80:83], v[16:31]
    buffer_load_dwordx4 v14, s[8:11], s47 offen lds
    ds_read_b64_tr_b16 v[64:65], v13 offset:8192
    ds_read_b64_tr_b16 v[66:67], v13 offset:10240
    ds_read_b64_tr_b16 v[68:69], v15 offset:8192
    v_mfma_f32_32x32x16_bf16 v[32:47], v[52:55], v[80:83], v[32:47]
    ds_read_b64_tr_b16 v[70:71], v15 offset:10240
    ds_read_b64_tr_b16 v[72:73], v13 offset:9216
    ds_read_b64_tr_b16 v[74:75], v13 offset:11264
    v_mfma_f32_32x32x16_bf16 v[16:31], v[56:59], v[84:87], v[16:31]
    buffer_load_dwordx4 v[80:83], v4, s[4:7], s32 offen sc1
    ds_read_b64_tr_b16 v[76:77], v15 offset:9216
    ds_read_b64_tr_b16 v[78:79], v15 offset:11264
    v_mfma_f32_32x32x16_bf16 v[32:47], v[60:63], v[84:87], v[32:47]
    buffer_load_dwordx4 v[84:87], v5, s[4:7], s32 offen sc1
    s_add_u32 s32, s32, 16384
    s_add_u32 s47, s47, 131072
    s_waitcnt vmcnt(9) lgkmcnt(0)
    s_barrier
    s_add_u32 m0, s46, 8192
    v_mfma_f32_32x32x16_bf16 v[16:31], v[64:67], v[88:91], v[16:31]
    buffer_load_dwordx4 v14, s[8:11], s47 offen lds
    ds_read_b64_tr_b16 v[48:49], v13 offset:16384
    ds_read_b64_tr_b16 v[50:51], v13 offset:18432
    ds_read_b64_tr_b16 v[52:53], v15 offset:16384
    v_mfma_f32_32x32x16_bf16 v[32:47], v[68:71], v[88:91], v[32:47]
    ds_read_b64_tr_b16 v[54:55], v15 offset:18432
    ds_read_b64_tr_b16 v[56:57], v13 offset:17408
    ds_read_b64_tr_b16 v[58:59], v13 offset:19456
    v_mfma_f32_32x32x16_bf16 v[16:31], v[72:75], v[92:95], v[16:31]
    buffer_load_dwordx4 v[88:91], v4, s[4:7], s32 offen sc1
    ds_read_b64_tr_b16 v[60:61], v15 offset:17408
    ds_read_b64_tr_b16 v[62:63], v15 offset:19456
    v_mfma_f32_32x32x16_bf16 v[32:47], v[76:79], v[92:95], v[32:47]
    buffer_load_dwordx4 v[92:95], v5, s[4:7], s32 offen sc1
    s_add_u32 s32, s32, 16384
    s_add_u32 s47, s47, 131072
    s_waitcnt vmcnt(9) lgkmcnt(0)
    s_barrier
    s_add_u32 m0, s46, 16384
    v_mfma_f32_32x32x16_bf16 v[16:31], v[48:51], v[96:99], v[16:31]
    buffer_load_dwordx4 v14, s[8:11], s47 offen lds
    ds_read_b64_tr_b16 v[64:65], v13 offset:24576
    ds_read_b64_tr_b16 v[66:67], v13 offset:26624
    ds_read_b64_tr_b16 v[68:69], v15 offset:24576
    v_mfma_f32_32x32x16_bf16 v[32:47], v[52:55], v[96:99], v[32:47]
    ds_read_b64_tr_b16 v[70:71], v15 offset:26624
    ds_read_b64_tr_b16 v[72:73], v13 offset:25600
    ds_read_b64_tr_b16 v[74:75], v13 offset:27648
    v_mfma_f32_32x32x16_bf16 v[16:31], v[56:59], v[100:103], v[16:31]
    buffer_load_dwordx4 v[96:99], v4, s[4:7], s32 offen sc1
    ds_read_b64_tr_b16 v[76:77], v15 offset:25600
    ds_read_b64_tr_b16 v[78:79], v15 offset:27648
    v_mfma_f32_32x32x16_bf16 v[32:47], v[60:63], v[100:103], v[32:47]
    buffer_load_dwordx4 v[100:103], v5, s[4:7], s32 offen sc1
    s_add_u32 s32, s32, 16384
    s_add_u32 s47, s47, 131072
    s_waitcnt vmcnt(9) lgkmcnt(0)
    s_barrier
    s_add_u32 m0, s46, 24576
    v_mfma_f32_32x32x16_bf16 v[16:31], v[64:67], v[104:107], v[16:31]
    buffer_load_dwordx4 v14, s[8:11], s47 offen lds
    ds_read_b64_tr_b16 v[48:49], v13 offset:32768
    ds_read_b64_tr_b16 v[50:51], v13 offset:34816
    ds_read_b64_tr_b16 v[52:53], v15 offset:32768
    v_mfma_f32_32x32x16_bf16 v[32:47], v[68:71], v[104:107], v[32:47]
    ds_read_b64_tr_b16 v[54:55], v15 offset:34816
    ds_read_b64_tr_b16 v[56:57], v13 offset:33792
    ds_read_b64_tr_b16 v[58:59], v13 offset:35840
    v_mfma_f32_32x32x16_bf16 v[16:31], v[72:75], v[108:111], v[16:31]
    buffer_load_dwordx4 v[104:107], v4, s[4:7], s32 offen sc1
    ds_read_b64_tr_b16 v[60:61], v15 offset:33792
    ds_read_b64_tr_b16 v[62:63], v15 offset:35840
    v_mfma_f32_32x32x16_bf16 v[32:47], v[76:79], v[108:111], v[32:47]
    buffer_load_dwordx4 v[108:111], v5, s[4:7], s32 offen sc1
    s_add_u32 s32, s32, 16384
    s_add_u32 s47, s47, 131072
    s_waitcnt vmcnt(9) lgkmcnt(0)
    s_barrier
    s_add_u32 m0, s46, 32768
    v_mfma_f32_32x32x16_bf16 v[16:31], v[48:51], v[80:83], v[16:31]
    buffer_load_dwordx4 v14, s[8:11], s47 offen lds
    ds_read_b64_tr_b16 v[64:65], v13 offset:40960
    ds_read_b64_tr_b16 v[66:67], v13 offset:43008
    ds_read_b64_tr_b16 v[68:69], v15 offset:40960
    v_mfma_f32_32x32x16_bf16 v[32:47], v[52:55], v[80:83], v[32:47]
    ds_read_b64_tr_b16 v[70:71], v15 offset:43008
    ds_read_b64_tr_b16 v[72:73], v13 offset:41984
    ds_read_b64_tr_b16 v[74:75], v13 offset:44032
    v_mfma_f32_32x32x16_bf16 v[16:31], v[56:59], v[84:87], v[16:31]
    buffer_load_dwordx4 v[80:83], v4, s[4:7], s32 offen sc1
    ds_read_b64_tr_b16 v[76:77], v15 offset:41984
    ds_read_b64_tr_b16 v[78:79], v15 offset:44032
    v_mfma_f32_32x32x16_bf16 v[32:47], v[60:63], v[84:87], v[32:47]
    buffer_load_dwordx4 v[84:87], v5, s[4:7], s32 offen sc1
    s_add_u32 s32, s32, 16384
    s_add_u32 s47, s47, 131072
    s_waitcnt vmcnt(9) lgkmcnt(0)
    s_barrier
    s_add_u32 m0, s46, 40960
    v_mfma_f32_32x32x16_bf16 v[16:31], v[64:67], v[88:91], v[16:31]
    buffer_load_dwordx4 v14, s[8:11], s47 offen lds
    ds_read_b64_tr_b16 v[48:49], v13 offset:49152
    ds_read_b64_tr_b16 v[50:51], v13 offset:51200
    ds_read_b64_tr_b16 v[52:53], v15 offset:49152
    v_mfma_f32_32x32x16_bf16 v[32:47], v[68:71], v[88:91], v[32:47]
    ds_read_b64_tr_b16 v[54:55], v15 offset:51200
    ds_read_b64_tr_b16 v[56:57], v13 offset:50176
    ds_read_b64_tr_b16 v[58:59], v13 offset:52224
    v_mfma_f32_32x32x16_bf16 v[16:31], v[72:75], v[92:95], v[16:31]
    buffer_load_dwordx4 v[88:91], v4, s[4:7], s32 offen sc1
    ds_read_b64_tr_b16 v[60:61], v15 offset:50176
    ds_read_b64_tr_b16 v[62:63], v15 offset:52224
    v_mfma_f32_32x32x16_bf16 v[32:47], v[76:79], v[92:95], v[32:47]
    buffer_load_dwordx4 v[92:95], v5, s[4:7], s32 offen sc1
    s_add_u32 s32, s32, 16384
    s_add_u32 s47, s47, 131072
    s_waitcnt vmcnt(9) lgkmcnt(0)
    s_barrier
    s_add_u32 m0, s46, 49152
    v_mfma_f32_32x32x16_bf16 v[16:31], v[48:51], v[96:99], v[16:31]
    buffer_load_dwordx4 v14, s[8:11], s47 offen lds
    ds_read_b64_tr_b16 v[64:65], v13 offset:57344
    ds_read_b64_tr_b16 v[66:67], v13 offset:59392
    ds_read_b64_tr_b16 v[68:69], v15 offset:57344
    v_mfma_f32_32x32x16_bf16 v[32:47], v[52:55], v[96:99], v[32:47]
    ds_read_b64_tr_b16 v[70:71], v15 offset:59392
    ds_read_b64_tr_b16 v[72:73], v13 offset:58368
    ds_read_b64_tr_b16 v[74:75], v13 offset:60416
    v_mfma_f32_32x32x16_bf16 v[16:31], v[56:59], v[100:103], v[16:31]
    buffer_load_dwordx4 v[96:99], v4, s[4:7], s32 offen sc1
    ds_read_b64_tr_b16 v[76:77], v15 offset:58368
    ds_read_b64_tr_b16 v[78:79], v15 offset:60416
    v_mfma_f32_32x32x16_bf16 v[32:47], v[60:63], v[100:103], v[32:47]
    buffer_load_dwordx4 v[100:103], v5, s[4:7], s32 offen sc1
    s_add_u32 s32, s32, 16384
    s_add_u32 s47, s47, 131072
    s_waitcnt vmcnt(9) lgkmcnt(0)
    s_barrier
    s_add_u32 m0, s46, 57344
    v_mfma_f32_32x32x16_bf16 v[16:31], v[64:67], v[104:107], v[16:31]
    buffer_load_dwordx4 v14, s[8:11], s47 offen lds
    ds_read_b64_tr_b16 v[48:49], v6 offset:0
    ds_read_b64_tr_b16 v[50:51], v6 offset:2048
    ds_read_b64_tr_b16 v[52:53], v7 offset:0
    v_mfma_f32_32x32x16_bf16 v[32:47], v[68:71], v[104:107], v[32:47]
    ds_read_b64_tr_b16 v[54:55], v7 offset:2048
    ds_read_b64_tr_b16 v[56:57], v6 offset:1024
    ds_read_b64_tr_b16 v[58:59], v6 offset:3072
    v_mfma_f32_32x32x16_bf16 v[16:31], v[72:75], v[108:111], v[16:31]
    buffer_load_dwordx4 v[104:107], v4, s[4:7], s32 offen sc1
    ds_read_b64_tr_b16 v[60:61], v7 offset:1024
    ds_read_b64_tr_b16 v[62:63], v7 offset:3072
    v_mfma_f32_32x32x16_bf16 v[32:47], v[76:79], v[108:111], v[32:47]
    buffer_load_dwordx4 v[108:111], v5, s[4:7], s32 offen sc1
    s_add_u32 s32, s32, 16384
    s_add_u32 s47, s47, 131072
    s_waitcnt vmcnt(9) lgkmcnt(0)
    s_barrier
    v_mfma_f32_32x32x16_bf16 v[16:31], v[48:51], v[80:83], v[16:31]
    ds_read_b64_tr_b16 v[64:65], v6 offset:8192
    ds_read_b64_tr_b16 v[66:67], v6 offset:10240
    ds_read_b64_tr_b16 v[68:69], v7 offset:8192
    v_mfma_f32_32x32x16_bf16 v[32:47], v[52:55], v[80:83], v[32:47]
    ds_read_b64_tr_b16 v[70:71], v7 offset:10240
    ds_read_b64_tr_b16 v[72:73], v6 offset:9216
    ds_read_b64_tr_b16 v[74:75], v6 offset:11264
    v_mfma_f32_32x32x16_bf16 v[16:31], v[56:59], v[84:87], v[16:31]
    buffer_load_dwordx4 v[80:83], v4, s[4:7], s32 offen sc1
    ds_read_b64_tr_b16 v[76:77], v7 offset:9216
    ds_read_b64_tr_b16 v[78:79], v7 offset:11264
    v_mfma_f32_32x32x16_bf16 v[32:47], v[60:63], v[84:87], v[32:47]
    buffer_load_dwordx4 v[84:87], v5, s[4:7], s32 offen sc1
    s_add_u32 s32, s32, 16384
    s_waitcnt vmcnt(8) lgkmcnt(0)
    s_barrier
    v_mfma_f32_32x32x16_bf16 v[16:31], v[64:67], v[88:91], v[16:31]
    ds_read_b64_tr_b16 v[48:49], v6 offset:16384
    ds_read_b64_tr_b16 v[50:51], v6 offset:18432
    ds_read_b64_tr_b16 v[52:53], v7 offset:16384
    v_mfma_f32_32x32x16_bf16 v[32:47], v[68:71], v[88:91], v[32:47]
    ds_read_b64_tr_b16 v[54:55], v7 offset:18432
    ds_read_b64_tr_b16 v[56:57], v6 offset:17408
    ds_read_b64_tr_b16 v[58:59], v6 offset:19456
    v_mfma_f32_32x32x16_bf16 v[16:31], v[72:75], v[92:95], v[16:31]
    buffer_load_dwordx4 v[88:91], v4, s[4:7], s32 offen sc1
    ds_read_b64_tr_b16 v[60:61], v7 offset:17408
    ds_read_b64_tr_b16 v[62:63], v7 offset:19456
    v_mfma_f32_32x32x16_bf16 v[32:47], v[76:79], v[92:95], v[32:47]
    buffer_load_dwordx4 v[92:95], v5, s[4:7], s32 offen sc1
    s_add_u32 s32, s32, 16384
    s_waitcnt vmcnt(7) lgkmcnt(0)
    s_barrier
    v_mfma_f32_32x32x16_bf16 v[16:31], v[48:51], v[96:99], v[16:31]
    ds_read_b64_tr_b16 v[64:65], v6 offset:24576
    ds_read_b64_tr_b16 v[66:67], v6 offset:26624
    ds_read_b64_tr_b16 v[68:69], v7 offset:24576
    v_mfma_f32_32x32x16_bf16 v[32:47], v[52:55], v[96:99], v[32:47]
    ds_read_b64_tr_b16 v[70:71], v7 offset:26624
    ds_read_b64_tr_b16 v[72:73], v6 offset:25600
    ds_read_b64_tr_b16 v[74:75], v6 offset:27648
    v_mfma_f32_32x32x16_bf16 v[16:31], v[56:59], v[100:103], v[16:31]
    buffer_load_dwordx4 v[96:99], v4, s[4:7], s32 offen sc1
    ds_read_b64_tr_b16 v[76:77], v7 offset:25600
    ds_read_b64_tr_b16 v[78:79], v7 offset:27648
    v_mfma_f32_32x32x16_bf16 v[32:47], v[60:63], v[100:103], v[32:47]
    buffer_load_dwordx4 v[100:103], v5, s[4:7], s32 offen sc1
    s_add_u32 s32, s32, 16384
    v_readfirstlane_b32 s30, v9
    s_nop 3
    s_cmp_ge_u32 s30, 16
    s_cbranch_scc0 L_p2_nochk
    buffer_load_dwordx4 v[240:243], v10, s[12:15], s25 offen sc1
    buffer_load_dwordx4 v[244:247], v10, s[12:15], s25 offen offset:1024 sc1
    s_mov_b32 s57, 1
L_p2_nochk:
    s_waitcnt vmcnt(6) lgkmcnt(0)
    s_barrier
    v_mfma_f32_32x32x16_bf16 v[16:31], v[64:67], v[104:107], v[16:31]
    ds_read_b64_tr_b16 v[48:49], v6 offset:32768
    ds_read_b64_tr_b16 v[50:51], v6 offset:34816
    ds_read_b64_tr_b16 v[52:53], v7 offset:32768
    v_mfma_f32_32x32x16_bf16 v[32:47], v[68:71], v[104:107], v[32:47]
    ds_read_b64_tr_b16 v[54:55], v7 offset:34816
    ds_read_b64_tr_b16 v[56:57], v6 offset:33792
    ds_read_b64_tr_b16 v[58:59], v6 offset:35840
    v_mfma_f32_32x32x16_bf16 v[16:31], v[72:75], v[108:111], v[16:31]
    buffer_load_dwordx4 v[104:107], v4, s[4:7], s32 offen sc1
    ds_read_b64_tr_b16 v[60:61], v7 offset:33792
    ds_read_b64_tr_b16 v[62:63], v7 offset:35840
    v_mfma_f32_32x32x16_bf16 v[32:47], v[76:79], v[108:111], v[32:47]
    buffer_load_dwordx4 v[108:111], v5, s[4:7], s32 offen sc1
    s_add_u32 s32, s32, 16384
    s_waitcnt vmcnt(6) lgkmcnt(0)
    s_barrier
    v_mfma_f32_32x32x16_bf16 v[16:31], v[48:51], v[80:83], v[16:31]
    ds_read_b64_tr_b16 v[64:65], v6 offset:40960
    ds_read_b64_tr_b16 v[66:67], v6 offset:43008
    ds_read_b64_tr_b16 v[68:69], v7 offset:40960
    v_mfma_f32_32x32x16_bf16 v[32:47], v[52:55], v[80:83], v[32:47]
    ds_read_b64_tr_b16 v[70:71], v7 offset:43008
    ds_read_b64_tr_b16 v[72:73], v6 offset:41984
    ds_read_b64_tr_b16 v[74:75], v6 offset:44032
    v_mfma_f32_32x32x16_bf16 v[16:31], v[56:59], v[84:87], v[16:31]
    buffer_load_dwordx4 v[80:83], v4, s[4:7], s32 offen sc1
    ds_read_b64_tr_b16 v[76:77], v7 offset:41984
    ds_read_b64_tr_b16 v[78:79], v7 offset:44032
    v_mfma_f32_32x32x16_bf16 v[32:47], v[60:63], v[84:87], v[32:47]
    buffer_load_dwordx4 v[84:87], v5, s[4:7], s32 offen sc1
    s_add_u32 s32, s32, 16384
    s_waitcnt vmcnt(6) lgkmcnt(0)
    s_barrier
    v_mfma_f32_32x32x16_bf16 v[16:31], v[64:67], v[88:91], v[16:31]
    ds_read_b64_tr_b16 v[48:49], v6 offset:49152
    ds_read_b64_tr_b16 v[50:51], v6 offset:51200
    ds_read_b64_tr_b16 v[52:53], v7 offset:49152
    v_mfma_f32_32x32x16_bf16 v[32:47], v[68:71], v[88:91], v[32:47]
    ds_read_b64_tr_b16 v[54:55], v7 offset:51200
    ds_read_b64_tr_b16 v[56:57], v6 offset:50176
    ds_read_b64_tr_b16 v[58:59], v6 offset:52224
    v_mfma_f32_32x32x16_bf16 v[16:31], v[72:75], v[92:95], v[16:31]
    buffer_load_dwordx4 v[88:91], v4, s[4:7], s32 offen sc1
    ds_read_b64_tr_b16 v[60:61], v7 offset:50176
    ds_read_b64_tr_b16 v[62:63], v7 offset:52224
    v_mfma_f32_32x32x16_bf16 v[32:47], v[76:79], v[92:95], v[32:47]
    buffer_load_dwordx4 v[92:95], v5, s[4:7], s32 offen sc1
    s_add_u32 s32, s32, 16384
    s_waitcnt vmcnt(6) lgkmcnt(0)
    s_barrier
    v_mfma_f32_32x32x16_bf16 v[16:31], v[48:51], v[96:99], v[16:31]
    ds_read_b64_tr_b16 v[64:65], v6 offset:57344
    ds_read_b64_tr_b16 v[66:67], v6 offset:59392
    ds_read_b64_tr_b16 v[68:69], v7 offset:57344
    v_mfma_f32_32x32x16_bf16 v[32:47], v[52:55], v[96:99], v[32:47]
    ds_read_b64_tr_b16 v[70:71], v7 offset:59392
    ds_read_b64_tr_b16 v[72:73], v6 offset:58368
    ds_read_b64_tr_b16 v[74:75], v6 offset:60416
    v_mfma_f32_32x32x16_bf16 v[16:31], v[56:59], v[100:103], v[16:31]
    buffer_load_dwordx4 v[96:99], v4, s[4:7], s32 offen sc1
    ds_read_b64_tr_b16 v[76:77], v7 offset:58368
    ds_read_b64_tr_b16 v[78:79], v7 offset:60416
    v_mfma_f32_32x32x16_bf16 v[32:47], v[60:63], v[100:103], v[32:47]
    buffer_load_dwordx4 v[100:103], v5, s[4:7], s32 offen sc1
    s_add_u32 s32, s32, 16384
    s_waitcnt vmcnt(6) lgkmcnt(0)
    s_barrier
    v_mfma_f32_32x32x16_bf16 v[16:31], v[64:67], v[104:107], v[16:31]
    ds_read_b64_tr_b16 v[48:49], v13 offset:0
    ds_read_b64_tr_b16 v[50:51], v13 offset:2048
    ds_read_b64_tr_b16 v[52:53], v15 offset:0
    v_mfma_f32_32x32x16_bf16 v[32:47], v[68:71], v[104:107], v[32:47]
    ds_read_b64_tr_b16 v[54:55], v15 offset:2048
    ds_read_b64_tr_b16 v[56:57], v13 offset:1024
    ds_read_b64_tr_b16 v[58:59], v13 offset:3072
    v_mfma_f32_32x32x16_bf16 v[16:31], v[72:75], v[108:111], v[16:31]
    buffer_load_dwordx4 v[104:107], v4, s[4:7], s32 offen sc1
    ds_read_b64_tr_b16 v[60:61], v15 offset:1024
    ds_read_b64_tr_b16 v[62:63], v15 offset:3072
    v_mfma_f32_32x32x16_bf16 v[32:47], v[76:79], v[108:111], v[32:47]
    buffer_load_dwordx4 v[108:111], v5, s[4:7], s32 offen sc1
    s_add_u32 s32, s32, 16384
    s_waitcnt vmcnt(6) lgkmcnt(0)
    s_barrier
    v_mfma_f32_32x32x16_bf16 v[16:31], v[48:51], v[80:83], v[16:31]
    ds_read_b64_tr_b16 v[64:65], v13 offset:8192
    ds_read_b64_tr_b16 v[66:67], v13 offset:10240
    ds_read_b64_tr_b16 v[68:69], v15 offset:8192
    v_mfma_f32_32x32x16_bf16 v[32:47], v[52:55], v[80:83], v[32:47]
    ds_read_b64_tr_b16 v[70:71], v15 offset:10240
    ds_read_b64_tr_b16 v[72:73], v13 offset:9216
    ds_read_b64_tr_b16 v[74:75], v13 offset:11264
    v_mfma_f32_32x32x16_bf16 v[16:31], v[56:59], v[84:87], v[16:31]
    buffer_load_dwordx4 v[80:83], v4, s[4:7], s32 offen sc1
    ds_read_b64_tr_b16 v[76:77], v15 offset:9216
    ds_read_b64_tr_b16 v[78:79], v15 offset:11264
    v_mfma_f32_32x32x16_bf16 v[32:47], v[60:63], v[84:87], v[32:47]
    buffer_load_dwordx4 v[84:87], v5, s[4:7], s32 offen sc1
    s_add_u32 s32, s32, 16384
    s_waitcnt vmcnt(6) lgkmcnt(0)
    s_barrier
    v_mfma_f32_32x32x16_bf16 v[16:31], v[64:67], v[88:91], v[16:31]
    ds_read_b64_tr_b16 v[48:49], v13 offset:16384
    ds_read_b64_tr_b16 v[50:51], v13 offset:18432
    ds_read_b64_tr_b16 v[52:53], v15 offset:16384
    v_mfma_f32_32x32x16_bf16 v[32:47], v[68:71], v[88:91], v[32:47]
    ds_read_b64_tr_b16 v[54:55], v15 offset:18432
    ds_read_b64_tr_b16 v[56:57], v13 offset:17408
    ds_read_b64_tr_b16 v[58:59], v13 offset:19456
    v_mfma_f32_32x32x16_bf16 v[16:31], v[72:75], v[92:95], v[16:31]
    buffer_load_dwordx4 v[88:91], v4, s[4:7], s32 offen sc1
    ds_read_b64_tr_b16 v[60:61], v15 offset:17408
    ds_read_b64_tr_b16 v[62:63], v15 offset:19456
    v_mfma_f32_32x32x16_bf16 v[32:47], v[76:79], v[92:95], v[32:47]
    buffer_load_dwordx4 v[92:95], v5, s[4:7], s32 offen sc1
    s_add_u32 s32, s32, 16384
    s_waitcnt vmcnt(6) lgkmcnt(0)
    s_barrier
    v_mfma_f32_32x32x16_bf16 v[16:31], v[48:51], v[96:99], v[16:31]
    ds_read_b64_tr_b16 v[64:65], v13 offset:24576
    ds_read_b64_tr_b16 v[66:67], v13 offset:26624
    ds_read_b64_tr_b16 v[68:69], v15 offset:24576
    v_mfma_f32_32x32x16_bf16 v[32:47], v[52:55], v[96:99], v[32:47]
    ds_read_b64_tr_b16 v[70:71], v15 offset:26624
    ds_read_b64_tr_b16 v[72:73], v13 offset:25600
    ds_read_b64_tr_b16 v[74:75], v13 offset:27648
    v_mfma_f32_32x32x16_bf16 v[16:31], v[56:59], v[100:103], v[16:31]
    buffer_load_dwordx4 v[96:99], v4, s[4:7], s32 offen sc1
    ds_read_b64_tr_b16 v[76:77], v15 offset:25600
    ds_read_b64_tr_b16 v[78:79], v15 offset:27648
    v_mfma_f32_32x32x16_bf16 v[32:47], v[60:63], v[100:103], v[32:47]
    buffer_load_dwordx4 v[100:103], v5, s[4:7], s32 offen sc1
    s_add_u32 s32, s32, 16384
    s_waitcnt vmcnt(6) lgkmcnt(0)
    s_barrier
    v_mfma_f32_32x32x16_bf16 v[16:31], v[64:67], v[104:107], v[16:31]
    ds_read_b64_tr_b16 v[48:49], v13 offset:32768
    ds_read_b64_tr_b16 v[50:51], v13 offset:34816
    ds_read_b64_tr_b16 v[52:53], v15 offset:32768
    v_mfma_f32_32x32x16_bf16 v[32:47], v[68:71], v[104:107], v[32:47]
    ds_read_b64_tr_b16 v[54:55], v15 offset:34816
    ds_read_b64_tr_b16 v[56:57], v13 offset:33792
    ds_read_b64_tr_b16 v[58:59], v13 offset:35840
    v_mfma_f32_32x32x16_bf16 v[16:31], v[72:75], v[108:111], v[16:31]
    buffer_load_dwordx4 v[104:107], v4, s[4:7], s32 offen sc1
    ds_read_b64_tr_b16 v[60:61], v15 offset:33792
    ds_read_b64_tr_b16 v[62:63], v15 offset:35840
    v_mfma_f32_32x32x16_bf16 v[32:47], v[76:79], v[108:111], v[32:47]
    buffer_load_dwordx4 v[108:111], v5, s[4:7], s32 offen sc1
    s_add_u32 s32, s32, 16384
    s_waitcnt vmcnt(6) lgkmcnt(0)
    s_barrier
    v_mfma_f32_32x32x16_bf16 v[16:31], v[48:51], v[80:83], v[16:31]
    ds_read_b64_tr_b16 v[64:65], v13 offset:40960
    ds_read_b64_tr_b16 v[66:67], v13 offset:43008
    ds_read_b64_tr_b16 v[68:69], v15 offset:40960
    v_mfma_f32_32x32x16_bf16 v[32:47], v[52:55], v[80:83], v[32:47]
    ds_read_b64_tr_b16 v[70:71], v15 offset:43008
    ds_read_b64_tr_b16 v[72:73], v13 offset:41984
    ds_read_b64_tr_b16 v[74:75], v13 offset:44032
    v_mfma_f32_32x32x16_bf16 v[16:31], v[56:59], v[84:87], v[16:31]
    ds_read_b64_tr_b16 v[76:77], v15 offset:41984
    ds_read_b64_tr_b16 v[78:79], v15 offset:44032
    v_mfma_f32_32x32x16_bf16 v[32:47], v[60:63], v[84:87], v[32:47]
    s_waitcnt vmcnt(4) lgkmcnt(0)
    s_barrier
    v_mfma_f32_32x32x16_bf16 v[16:31], v[64:67], v[88:91], v[16:31]
    ds_read_b64_tr_b16 v[48:49], v13 offset:49152
    ds_read_b64_tr_b16 v[50:51], v13 offset:51200
    ds_read_b64_tr_b16 v[52:53], v15 offset:49152
    v_mfma_f32_32x32x16_bf16 v[32:47], v[68:71], v[88:91], v[32:47]
    ds_read_b64_tr_b16 v[54:55], v15 offset:51200
    ds_read_b64_tr_b16 v[56:57], v13 offset:50176
    ds_read_b64_tr_b16 v[58:59], v13 offset:52224
    v_mfma_f32_32x32x16_bf16 v[16:31], v[72:75], v[92:95], v[16:31]
    ds_read_b64_tr_b16 v[60:61], v15 offset:50176
    ds_read_b64_tr_b16 v[62:63], v15 offset:52224
    v_mfma_f32_32x32x16_bf16 v[32:47], v[76:79], v[92:95], v[32:47]
    s_waitcnt vmcnt(2) lgkmcnt(0)
    s_barrier
    v_mfma_f32_32x32x16_bf16 v[16:31], v[48:51], v[96:99], v[16:31]
    ds_read_b64_tr_b16 v[64:65], v13 offset:57344
    ds_read_b64_tr_b16 v[66:67], v13 offset:59392
    ds_read_b64_tr_b16 v[68:69], v15 offset:57344
    v_mfma_f32_32x32x16_bf16 v[32:47], v[52:55], v[96:99], v[32:47]
    ds_read_b64_tr_b16 v[70:71], v15 offset:59392
    ds_read_b64_tr_b16 v[72:73], v13 offset:58368
    ds_read_b64_tr_b16 v[74:75], v13 offset:60416
    v_mfma_f32_32x32x16_bf16 v[16:31], v[56:59], v[100:103], v[16:31]
    ds_read_b64_tr_b16 v[76:77], v15 offset:58368
    ds_read_b64_tr_b16 v[78:79], v15 offset:60416
    v_mfma_f32_32x32x16_bf16 v[32:47], v[60:63], v[100:103], v[32:47]
    s_waitcnt vmcnt(0) lgkmcnt(0)
    v_mfma_f32_32x32x16_bf16 v[16:31], v[64:67], v[104:107], v[16:31]
    v_mfma_f32_32x32x16_bf16 v[32:47], v[68:71], v[104:107], v[32:47]
    v_mfma_f32_32x32x16_bf16 v[16:31], v[72:75], v[108:111], v[16:31]
    v_mfma_f32_32x32x16_bf16 v[32:47], v[76:79], v[108:111], v[32:47]
    s_lshl_b32 s30, s20, 12
    s_add_u32 s30, s30, 131072
    v_add_u32 v4, s30, v3
    s_xor_b32 s30, s20, 4
    s_lshl_b32 s30, s30, 12
    s_add_u32 s30, s30, 131072
    v_add_u32 v5, s30, v3
    s_cmp_eq_u32 s21, 0
    s_nop 4
    s_cbranch_scc1 L_p2_k0
    ds_write_b128 v4, v[16:19] offset:0
    ds_write_b128 v4, v[20:23] offset:1024
    ds_write_b128 v4, v[24:27] offset:2048
    ds_write_b128 v4, v[28:31] offset:3072
    s_waitcnt lgkmcnt(0)
    v_mov_b32 v16, v32
    v_mov_b32 v17, v33
    v_mov_b32 v18, v34
    v_mov_b32 v19, v35
    v_mov_b32 v20, v36
    v_mov_b32 v21, v37
    v_mov_b32 v22, v38
    v_mov_b32 v23, v39
    v_mov_b32 v24, v40
    v_mov_b32 v25, v41
    v_mov_b32 v26, v42
    v_mov_b32 v27, v43
    v_mov_b32 v28, v44
    v_mov_b32 v29, v45
    v_mov_b32 v30, v46
    v_mov_b32 v31, v47
    s_branch L_p2_kj
L_p2_k0:
    ds_write_b128 v4, v[32:35] offset:0
    ds_write_b128 v4, v[36:39] offset:1024
    ds_write_b128 v4, v[40:43] offset:2048
    ds_write_b128 v4, v[44:47] offset:3072
L_p2_kj:
    s_waitcnt lgkmcnt(0)
    s_barrier
    ds_read_b128 v[32:35], v5 offset:0
    ds_read_b128 v[36:39], v5 offset:1024
    ds_read_b128 v[40:43], v5 offset:2048
    ds_read_b128 v[44:47], v5 offset:3072
    s_cmp_eq_u32 s57, 1
    s_cbranch_scc1 L_p2_have
    s_mov_b32 s58, 0
L_py:
    buffer_load_dword v9, v12, s[48:51], 0 offen sc1
    s_waitcnt vmcnt(0)
    v_cmp_gt_u32 vcc, 16, v9
    s_nop 1
    s_cmp_eq_u64 vcc, 0
    s_cbranch_scc1 L_py_done
    s_sleep 1
    s_add_u32 s58, s58, 1
    s_cmp_lt_u32 s58, 0x80000
    s_cbranch_scc1 L_py
L_py_done:
    buffer_load_dwordx4 v[240:243], v10, s[12:15], s25 offen sc1
    buffer_load_dwordx4 v[244:247], v10, s[12:15], s25 offen offset:1024 sc1
L_p2_have:
    s_waitcnt vmcnt(0) lgkmcnt(0)
    v_add_f32 v16, v16, v32
    v_add_f32 v17, v17, v33
    v_add_f32 v18, v18, v34
    v_add_f32 v19, v19, v35
    v_add_f32 v20, v20, v36
    v_add_f32 v21, v21, v37
    v_add_f32 v22, v22, v38
    v_add_f32 v23, v23, v39
    v_add_f32 v24, v24, v40
    v_add_f32 v25, v25, v41
    v_add_f32 v26, v26, v42
    v_add_f32 v27, v27, v43
    v_add_f32 v28, v28, v44
    v_add_f32 v29, v29, v45
    v_add_f32 v30, v30, v46
    v_add_f32 v31, v31, v47
    v_lshlrev_b32 v1, 16, v240
    v_and_b32 v2, 0xffff0000, v240
    v_add_f32 v1, v1, v16
    v_add_f32 v2, v2, v17
    v_cvt_pk_bf16_f32 v240, v1, v2
    v_lshlrev_b32 v1, 16, v241
    v_and_b32 v2, 0xffff0000, v241
    v_add_f32 v1, v1, v18
    v_add_f32 v2, v2, v19
    v_cvt_pk_bf16_f32 v241, v1, v2
    v_lshlrev_b32 v1, 16, v242
    v_and_b32 v2, 0xffff0000, v242
    v_add_f32 v1, v1, v20
    v_add_f32 v2, v2, v21
    v_cvt_pk_bf16_f32 v242, v1, v2
    v_lshlrev_b32 v1, 16, v243
    v_and_b32 v2, 0xffff0000, v243
    v_add_f32 v1, v1, v22
    v_add_f32 v2, v2, v23
    v_cvt_pk_bf16_f32 v243, v1, v2
    s_nop 1
    v_permlane32_swap_b32 v240, v242
    v_permlane32_swap_b32 v241, v243
    buffer_store_dwordx4 v[240:243], v11, s[16:19], s26 offen offset:0
    v_lshlrev_b32 v1, 16, v244
    v_and_b32 v2, 0xffff0000, v244
    v_add_f32 v1, v1, v24
    v_add_f32 v2, v2, v25
    v_cvt_pk_bf16_f32 v244, v1, v2
    v_lshlrev_b32 v1, 16, v245
    v_and_b32 v2, 0xffff0000, v245
    v_add_f32 v1, v1, v26
    v_add_f32 v2, v2, v27
    v_cvt_pk_bf16_f32 v245, v1, v2
    v_lshlrev_b32 v1, 16, v246
    v_and_b32 v2, 0xffff0000, v246
    v_add_f32 v1, v1, v28
    v_add_f32 v2, v2, v29
    v_cvt_pk_bf16_f32 v246, v1, v2
    v_lshlrev_b32 v1, 16, v247
    v_and_b32 v2, 0xffff0000, v247
    v_add_f32 v1, v1, v30
    v_add_f32 v2, v2, v31
    v_cvt_pk_bf16_f32 v247, v1, v2
    s_nop 1
    v_permlane32_swap_b32 v244, v246
    v_permlane32_swap_b32 v245, v247
    buffer_store_dwordx4 v[244:247], v11, s[16:19], s26 offen offset:32
L_end:
    s_endpgm
.section .rodata,"a"
.p2align 6
.amdhsa_kernel parallel_sum__spectral_gfnet__glu_gated_geglu__prompt_kernel
  .amdhsa_next_free_vgpr 256
  .amdhsa_next_free_sgpr 100
  .amdhsa_accum_offset 256
  .amdhsa_group_segment_fixed_size 0
  .amdhsa_kernarg_size 80
  .amdhsa_user_sgpr_count 2
  .amdhsa_user_sgpr_kernarg_segment_ptr 1
  .amdhsa_system_sgpr_workgroup_id_x 1
  .amdhsa_float_denorm_mode_32 3
.end_amdhsa_kernel
```
